```python
import torch

def _softmax(x, axis=-1):
    return torch.softmax(x, dim=axis)

def _gelu(x):
    return torch.nn.functional.gelu(x, approximate='tanh')

def _silu(x):
    return torch.nn.functional.silu(x)

def _sigmoid(x):
    return torch.sigmoid(x)

def _layernorm(x, axis=-1, eps=1e-05):
    m = x.mean(dim=axis, keepdim=True)
    v = x.var(dim=axis, keepdim=True, unbiased=False)
    return (x - m) / torch.sqrt(v + eps)

def _scatter_add(tgt, idx, src, axis=0):
    return tgt.clone().index_add_(axis, idx, src)

def _segment_sum(src, seg, n):
    out = torch.zeros((n,) + src.shape[1:], dtype=src.dtype)
    return out.index_add_(0, seg, src)

def _pad(x, pw):
    flat = tuple((v for pair in reversed(pw) for v in pair))
    return torch.nn.functional.pad(x, flat)
kernel_name = 'concat_heads__memory_aug_recurrent_mem_tr__ssm_conv_h3__prompt'

def setup_inputs():

    _w = lambda a: (lambda t: t.to(torch.bfloat16) if t.is_floating_point() else t)(torch.as_tensor(a))

    def _A_setup():
        B, S, Dm = (1, 2048, 512)
        H, Dh = (32, 128)
        M, seg = (8, 32)
        seg = min(seg, S)
        S = S // seg * seg
        return {'x': _w((lambda *s: torch.randn(*s, dtype=torch.bfloat16) * 0.05)(B, S, Dm)), 'mem0': _w((lambda *s: torch.randn(*s, dtype=torch.bfloat16) * 0.4)(B, M, Dm)), 'Wq': _w((lambda *s: torch.randn(*s, dtype=torch.bfloat16) * 6.4)(Dm, H, Dh) * Dm ** (-0.5)), 'Wk': _w((lambda *s: torch.randn(*s, dtype=torch.bfloat16) * 6.4)(Dm, H, Dh) * Dm ** (-0.5)), 'Wv': _w((lambda *s: torch.randn(*s, dtype=torch.bfloat16) * 0.4)(Dm, H, Dh) * Dm ** (-0.5)), 'Wo': _w((lambda *s: torch.randn(*s, dtype=torch.bfloat16) * 0.4)(H, Dh, Dm) * (H * Dh) ** (-0.5)), 'seg_len': seg}
    _A_in = _A_setup()

    def _B_setup():
        B, S, D = (1, 2048, 512)
        ks = 4
        return {'q': _w((lambda *s: torch.randn(*s, dtype=torch.bfloat16) * 0.05)(B, S, D)), 'k': _w((lambda *s: torch.randn(*s, dtype=torch.bfloat16) * 0.4)(B, S, D)), 'v': _w((lambda *s: torch.randn(*s, dtype=torch.bfloat16) * 0.4)(B, S, D)), 'shift_k': _w((lambda *s: torch.randn(*s, dtype=torch.bfloat16) * 0.4)(D, ks) * 0.5), 'ssm_k': _w((lambda *s: torch.randn(*s, dtype=torch.bfloat16) * 0.4)(D, S) * (1.0 / S ** 0.5)), 'ssm_D': _w((lambda *s: torch.randn(*s, dtype=torch.bfloat16) * 0.4)(D))}
    _B_in = _B_setup()
    return {'A_x': _A_in['x'], 'A_mem0': _A_in['mem0'], 'A_Wq': _A_in['Wq'], 'A_Wk': _A_in['Wk'], 'A_Wv': _A_in['Wv'], 'A_Wo': _A_in['Wo'], 'A_seg_len': _A_in['seg_len'], 'B_q': _B_in['q'], 'B_k': _B_in['k'], 'B_v': _B_in['v'], 'B_shift_k': _B_in['shift_k'], 'B_ssm_k': _B_in['ssm_k'], 'B_ssm_D': _B_in['ssm_D']}

def reference(A_x, A_mem0, A_Wq, A_Wk, A_Wv, A_Wo, A_seg_len, B_q, B_k, B_v, B_shift_k, B_ssm_k, B_ssm_D):

    def _A_ref(x, mem0, Wq, Wk, Wv, Wo, seg_len):
        B, S, Dm = x.shape
        H, Dh = (Wq.shape[1], Wq.shape[2])
        M = mem0.shape[1]
        scale = Dh ** (-0.5)
        n_seg = S // seg_len
        L = M + seg_len
        idx = torch.arange(L)
        mask = (idx[:, None] < M) | (idx[:, None] >= idx[None, :])
        mem = mem0
        outs = []
        for s in range(n_seg):
            xs = x[:, s * seg_len:(s + 1) * seg_len, :].clone()
            h = torch.concatenate([mem, xs], axis=1)
            q = torch.einsum('btd,dhe->bhte', h, Wq)
            k = torch.einsum('btd,dhe->bhte', h, Wk)
            v = torch.einsum('btd,dhe->bhte', h, Wv)
            scores = torch.einsum('bhqe,bhke->bhqk', q, k) * scale
            scores = torch.where(mask[None, None], scores, -1000000000.0)
            p = _softmax(scores, axis=-1)
            o = torch.einsum('bhqk,bhke->bhqe', p, v)
            o = torch.einsum('bhte,hed->btd', o, Wo)
            mem = o[:, :M, :].clone()
            outs.append(o[:, M:, :])
        return torch.concatenate(outs, axis=1)

    def _B_ref(q, k, v, shift_k, ssm_k, ssm_D):
        B, S, D = q.shape
        ks = shift_k.shape[-1]
        k_pad = _pad(k, ((0, 0), (ks - 1, 0), (0, 0)))
        k_shift = torch.zeros_like(k)
        for t in range(ks):
            k_shift = k_shift + k_pad[:, t:t + S, :] * shift_k[:, ks - 1 - t][None, None, :]
        kv = k_shift * v
        L = 2 * S
        kv_pad = _pad(kv, ((0, 0), (0, S), (0, 0)))
        kf_pad = _pad(ssm_k, ((0, 0), (0, S)))
        kv_f = (lambda x, axes=(-2, -1): torch.fft.rfft2(x.float(), dim=axes))(kv_pad[:, None, :, :], axes=(1, 2))
        kf_f = (lambda x, axes=(-2, -1): torch.fft.rfft2(x.float(), dim=axes))(kf_pad[:, None, :], axes=(1, 2))
        kf_f = (lambda x, *d: x.permute(*d))(kf_f, 1, 2, 0)
        y_f = kv_f * kf_f[None, :, :, :]
        y = (lambda x, s, axes=(-2, -1): torch.fft.irfft2(x, s=s, dim=axes).to(torch.bfloat16))(y_f, (1, L), axes=(1, 2))[:, 0, :S, :]
        y = y + kv * ssm_D[None, None, :]
        return q * y
    a = _A_ref(A_x, A_mem0, A_Wq, A_Wk, A_Wv, A_Wo, A_seg_len)
    b = _B_ref(B_q, B_k, B_v, B_shift_k, B_ssm_k, B_ssm_D)
    return torch.concatenate([a, b], axis=-1)
```

```asm
; @launch grid=(256,1,1) block=(256,1,1) lds=163840
.amdgcn_target "amdgcn-amd-amdhsa--gfx950"
.text
.globl concat_heads__memory_aug_recurrent_mem_tr__ssm_conv_h3__prompt_kernel
.p2align 8
.type concat_heads__memory_aug_recurrent_mem_tr__ssm_conv_h3__prompt_kernel,@function
concat_heads__memory_aug_recurrent_mem_tr__ssm_conv_h3__prompt_kernel:
    s_cmp_ge_u32 s2, 256
    s_cbranch_scc1 L_exit
    s_load_dwordx2 s[4:5], s[0:1], 120
    s_mov_b32 s6, 0x10000000
    s_mov_b32 s7, 0x00020000
    s_load_dwordx2 s[8:9], s[0:1], 112
    s_mov_b32 s10, 0x100
    s_mov_b32 s11, 0x00020000
    s_getreg_b32 s31, hwreg(HW_REG_XCC_ID)
    s_and_b32 s31, s31, 7
    v_readfirstlane_b32 s29, v0
    s_lshr_b32 s29, s29, 6
    s_waitcnt lgkmcnt(0)
    s_cmp_lg_u32 s29, 0
    s_cbranch_scc1 L_role_wait
    s_mov_b64 exec, 1
    s_mov_b32 s32, 0
    v_mov_b32 v3, 0
L_role_try:
    s_add_u32 s33, s31, s32
    s_and_b32 s33, s33, 7
    s_lshl_b32 s34, s33, 2
    s_cselect_b32 s34, s34, 192
    v_mov_b32 v1, 1
    buffer_atomic_add v1, off, s[8:11], s34 sc0
    s_waitcnt vmcnt(0)
    v_readfirstlane_b32 s35, v1
    s_cmp_lt_u32 s35, 32
    s_cbranch_scc1 L_role_got
    s_add_u32 s32, s32, 1
    s_cmp_lt_u32 s32, 8
    s_cbranch_scc1 L_role_try
    s_mov_b32 s33, 8
    s_mov_b32 s35, 0
L_role_got:
    s_lshl_b32 s33, s33, 5
    s_add_u32 s33, s33, s35
    s_lshl_b32 s32, s32, 16
    s_or_b32 s33, s33, s32
    v_mov_b32 v1, s33
    ds_write_b32 v3, v1
    s_mov_b64 exec, -1
    s_waitcnt lgkmcnt(0)
L_role_wait:
    s_barrier
    v_mov_b32 v3, 0
    ds_read_b32 v1, v3
    s_waitcnt lgkmcnt(0)
    v_readfirstlane_b32 s30, v1
    s_barrier
    s_lshr_b32 s36, s30, 16
    s_and_b32 s30, s30, 0xffff
    s_cmp_ge_u32 s30, 256
    s_cbranch_scc1 L_exit
    s_cmp_ge_u32 s30, 32
    s_cbranch_scc1 L_work
    s_mov_b32 s28, s30
    s_load_dwordx2 s[12:13], s[0:1], 16
    s_mov_b32 s14, 0x400000
    s_mov_b32 s15, 0x00020000
    s_load_dwordx2 s[16:17], s[0:1], 24
    s_mov_b32 s18, 0x400000
    s_mov_b32 s19, 0x00020000
    s_load_dwordx2 s[20:21], s[0:1], 32
    s_mov_b32 s22, 0x400000
    s_mov_b32 s23, 0x00020000
    s_load_dwordx2 s[24:25], s[0:1], 40
    s_mov_b32 s26, 0x400000
    s_mov_b32 s27, 0x00020000
    s_load_dwordx2 s[40:41], s[0:1], 8
    s_mov_b32 s42, 0x2000
    s_mov_b32 s43, 0x00020000
    v_and_b32 v1, 63, v0
    v_lshlrev_b32 v121, 4, v1
    v_and_b32 v2, 15, v1
    v_lshrrev_b32 v3, 4, v1
    s_lshl_b32 s37, s29, 15
    s_add_u32 s37, s37, 32768
    v_add_u32 v122, s37, v121
    v_mov_b32 v4, 0x4444
    v_mov_b32 v5, 0xeeee
    v_and_b32 v6, 2, v2
    v_cmp_eq_u32 vcc, 0, v6
    s_nop 1
    v_cndmask_b32 v120, v5, v4, vcc
    v_and_b32 v4, 1, v3
    v_mul_u32_u24 v4, 1152, v4
    v_lshl_add_u32 v4, v2, 2, v4
    v_lshrrev_b32 v5, 1, v3
    v_mul_u32_u24 v5, 4128, v5
    v_xor_b32 v4, v4, v5
    s_lshl_b32 s37, s29, 6
    s_add_u32 s37, s37, 24576
    v_add_u32 v123, s37, v4
    v_lshrrev_b32 v4, 2, v2
    v_and_b32 v5, 1, v2
    v_lshl_add_u32 v12, v4, 1, v5
    v_and_b32 v4, 3, v12
    v_mul_u32_u24 v4, 576, v4
    v_lshl_add_u32 v4, v3, 4, v4
    v_lshrrev_b32 v5, 2, v12
    v_mul_u32_u24 v5, 4128, v5
    v_xor_b32 v4, v4, v5
    v_add_u32 v124, 24576, v4
    v_lshrrev_b32 v5, 2, v2
    v_lshl_add_u32 v4, v5, 2, v3
    v_lshlrev_b32 v4, 11, v4
    v_and_b32 v5, 3, v2
    v_lshl_add_u32 v4, v5, 4, v4
    s_lshl_b32 s37, s29, 16
    s_lshl_b32 s38, s28, 6
    s_add_u32 s37, s37, s38
    v_add_u32 v125, s37, v4
    v_lshl_add_u32 v4, v3, 2, v5
    v_lshlrev_b32 v4, 6, v4
    v_lshrrev_b32 v5, 2, v2
    v_lshl_add_u32 v4, v5, 4, v4
    s_lshl_b32 s37, s28, 2
    s_add_u32 s37, s37, s29
    s_lshl_b32 s38, s37, 11
    s_mov_b32 s74, s38
    v_add_u32 v25, s38, v4
    v_lshlrev_b32 v4, 4, v2
    v_lshl_add_u32 v4, v3, 2, v4
    s_lshl_b32 s100, s37, 6
    v_add_u32 v127, s100, v4
    v_cmp_gt_u32 s[44:45], 4, v2
    v_and_b32 v4, 1, v2
    v_lshrrev_b32 v5, 2, v2
    v_lshl_add_u32 v5, v4, 2, v5
    v_lshrrev_b32 v4, 1, v5
    v_cmp_eq_u32 s[46:47], 0, v4
    v_cmp_eq_u32 s[48:49], 1, v4
    v_cmp_eq_u32 s[50:51], 2, v4
    v_cmp_eq_u32 s[52:53], 3, v4
    v_and_b32 v4, 1, v5
    v_cmp_eq_u32 s[54:55], 1, v4
    v_mov_b32 v8, -1
    v_mov_b32 v9, -1
    v_mov_b32 v10, -1
    v_mov_b32 v11, -1
    s_mov_b32 s56, 0x4400000
    s_mov_b32 s57, 0x4440000
    s_waitcnt lgkmcnt(0)
    buffer_store_dwordx4 v[8:11], v25, s[4:7], s56 offen offset:0 sc1
    buffer_store_dwordx4 v[8:11], v25, s[4:7], s56 offen offset:1024 sc1
    buffer_store_dwordx4 v[8:11], v25, s[4:7], s57 offen offset:0 sc1
    buffer_store_dwordx4 v[8:11], v25, s[4:7], s57 offen offset:1024 sc1
    s_lshl_b32 s56, s28, 12
    s_lshl_b32 s57, s29, 10
    s_add_u32 s56, s56, s57
    s_add_u32 s57, s56, 0x38a0000
    buffer_store_dwordx4 v[8:11], v121, s[4:7], s57 offen sc1
    s_add_u32 s57, s56, 0x38c0000
    buffer_store_dwordx4 v[8:11], v121, s[4:7], s57 offen sc1
    s_add_u32 s57, s56, 0x38e0000
    buffer_store_dwordx4 v[8:11], v121, s[4:7], s57 offen sc1
    s_add_u32 s57, s56, 0x41a0000
    buffer_store_dwordx4 v[8:11], v121, s[4:7], s57 offen sc1
    s_add_u32 s57, s56, 0x41c0000
    buffer_store_dwordx4 v[8:11], v121, s[4:7], s57 offen sc1
    s_add_u32 s57, s56, 0x41e0000
    buffer_store_dwordx4 v[8:11], v121, s[4:7], s57 offen sc1
    s_mov_b64 exec, s[44:45]
    s_mov_b32 s58, 0x4500000
    buffer_store_dword v8, v127, s[4:7], s58 offen sc1
    s_mov_b32 s58, 0x4502000
    buffer_store_dword v8, v127, s[4:7], s58 offen sc1
    s_mov_b32 s58, 0x4504000
    buffer_store_dword v8, v127, s[4:7], s58 offen sc1
    s_mov_b32 s58, 0x4506000
    buffer_store_dword v8, v127, s[4:7], s58 offen sc1
    s_mov_b64 exec, 1
    v_mov_b32 v9, 0
    s_lshl_b32 s98, s28, 7
    s_add_u32 s98, s98, 0x4700000
    s_add_u32 s58, s98, 0
    buffer_store_dword v9, off, s[4:7], s58 sc1
    s_add_u32 s58, s98, 4096
    buffer_store_dword v9, off, s[4:7], s58 sc1
    s_add_u32 s58, s98, 8192
    buffer_store_dword v9, off, s[4:7], s58 sc1
    s_add_u32 s95, s98, 0x1000
    s_mov_b64 exec, -1
    s_nop 1
    s_lshl_b32 s38, s29, 2
    v_xor_b32 v6, s38, v2
    v_lshlrev_b32 v6, 4, v6
    v_lshl_add_u32 v6, v3, 13, v6
    s_and_b32 s37, s29, 1
    s_lshr_b32 s38, s29, 1
    s_lshl2_add_u32 s59, s38, s37
    s_lshl_b32 s37, s59, 15
    s_lshl_b32 s38, s28, 8
    s_add_u32 s37, s37, s38
    v_add_u32 v6, s37, v6
    s_lshl_b32 s59, s59, 10
    v_lshlrev_b32 v7, 12, v3
    v_lshl_add_u32 v7, v2, 3, v7
    s_lshl_b32 s37, s28, 17
    s_lshl_b32 s38, s29, 8
    s_add_u32 s37, s37, s38
    v_add_u32 v7, s37, v7
    v_lshrrev_b32 v4, 1, v3
    v_and_b32 v5, 1, v3
    v_lshl_add_u32 v4, v4, 2, v5
    v_lshlrev_b32 v4, 10, v4
    v_xor_b32 v5, s29, v3
    v_lshl_add_u32 v4, v5, 6, v4
    v_lshl_add_u32 v4, v2, 2, v4
    s_lshl_b32 s37, s29, 13
    v_add_u32 v8, s37, v4
    v_xor_b32 v9, 0x2000, v8
    v_xor_b32 v10, 0x4000, v8
    v_xor_b32 v11, 0x6000, v8
    s_mov_b32 s60, 0x05040100
    s_mov_b32 s61, 0x07060302
    v_mov_b32 v5, v12
    s_add_u32 m0, s59, 0
    s_mov_b32 s63, 0
    buffer_load_dwordx4 v6, s[12:15], s63 offen lds
    s_add_u32 m0, s59, 2048
    s_mov_b32 s63, 65536
    buffer_load_dwordx4 v6, s[12:15], s63 offen lds
    s_add_u32 m0, s59, 8192
    s_mov_b32 s63, 1048576
    buffer_load_dwordx4 v6, s[12:15], s63 offen lds
    s_add_u32 m0, s59, 10240
    s_mov_b32 s63, 1114112
    buffer_load_dwordx4 v6, s[12:15], s63 offen lds
    s_add_u32 m0, s59, 16384
    s_mov_b32 s63, 2097152
    buffer_load_dwordx4 v6, s[12:15], s63 offen lds
    s_add_u32 m0, s59, 18432
    s_mov_b32 s63, 2162688
    buffer_load_dwordx4 v6, s[12:15], s63 offen lds
    s_add_u32 m0, s59, 24576
    s_mov_b32 s63, 3145728
    buffer_load_dwordx4 v6, s[12:15], s63 offen lds
    s_add_u32 m0, s59, 26624
    s_mov_b32 s63, 3211264
    buffer_load_dwordx4 v6, s[12:15], s63 offen lds
    s_add_u32 m0, s59, 32768
    s_mov_b32 s63, 262144
    buffer_load_dwordx4 v6, s[12:15], s63 offen lds
    s_add_u32 m0, s59, 34816
    s_mov_b32 s63, 327680
    buffer_load_dwordx4 v6, s[12:15], s63 offen lds
    s_add_u32 m0, s59, 40960
    s_mov_b32 s63, 1310720
    buffer_load_dwordx4 v6, s[12:15], s63 offen lds
    s_add_u32 m0, s59, 43008
    s_mov_b32 s63, 1376256
    buffer_load_dwordx4 v6, s[12:15], s63 offen lds
    s_add_u32 m0, s59, 49152
    s_mov_b32 s63, 2359296
    buffer_load_dwordx4 v6, s[12:15], s63 offen lds
    s_add_u32 m0, s59, 51200
    s_mov_b32 s63, 2424832
    buffer_load_dwordx4 v6, s[12:15], s63 offen lds
    s_add_u32 m0, s59, 57344
    s_mov_b32 s63, 3407872
    buffer_load_dwordx4 v6, s[12:15], s63 offen lds
    s_add_u32 m0, s59, 59392
    s_mov_b32 s63, 3473408
    buffer_load_dwordx4 v6, s[12:15], s63 offen lds
    s_add_u32 m0, s59, 65536
    s_mov_b32 s63, 524288
    buffer_load_dwordx4 v6, s[12:15], s63 offen lds
    s_add_u32 m0, s59, 67584
    s_mov_b32 s63, 589824
    buffer_load_dwordx4 v6, s[12:15], s63 offen lds
    s_add_u32 m0, s59, 73728
    s_mov_b32 s63, 1572864
    buffer_load_dwordx4 v6, s[12:15], s63 offen lds
    s_add_u32 m0, s59, 75776
    s_mov_b32 s63, 1638400
    buffer_load_dwordx4 v6, s[12:15], s63 offen lds
    s_add_u32 m0, s59, 81920
    s_mov_b32 s63, 2621440
    buffer_load_dwordx4 v6, s[12:15], s63 offen lds
    s_add_u32 m0, s59, 83968
    s_mov_b32 s63, 2686976
    buffer_load_dwordx4 v6, s[12:15], s63 offen lds
    s_add_u32 m0, s59, 90112
    s_mov_b32 s63, 3670016
    buffer_load_dwordx4 v6, s[12:15], s63 offen lds
    s_add_u32 m0, s59, 92160
    s_mov_b32 s63, 3735552
    buffer_load_dwordx4 v6, s[12:15], s63 offen lds
    s_add_u32 m0, s59, 98304
    s_mov_b32 s63, 786432
    buffer_load_dwordx4 v6, s[12:15], s63 offen lds
    s_add_u32 m0, s59, 100352
    s_mov_b32 s63, 851968
    buffer_load_dwordx4 v6, s[12:15], s63 offen lds
    s_add_u32 m0, s59, 106496
    s_mov_b32 s63, 1835008
    buffer_load_dwordx4 v6, s[12:15], s63 offen lds
    s_add_u32 m0, s59, 108544
    s_mov_b32 s63, 1900544
    buffer_load_dwordx4 v6, s[12:15], s63 offen lds
    s_add_u32 m0, s59, 114688
    s_mov_b32 s63, 2883584
    buffer_load_dwordx4 v6, s[12:15], s63 offen lds
    s_add_u32 m0, s59, 116736
    s_mov_b32 s63, 2949120
    buffer_load_dwordx4 v6, s[12:15], s63 offen lds
    s_add_u32 m0, s59, 122880
    s_mov_b32 s63, 3932160
    buffer_load_dwordx4 v6, s[12:15], s63 offen lds
    s_add_u32 m0, s59, 124928
    s_mov_b32 s63, 3997696
    buffer_load_dwordx4 v6, s[12:15], s63 offen lds
    s_add_u32 m0, s59, 131072
    s_mov_b32 s63, 0
    buffer_load_dwordx4 v6, s[16:19], s63 offen lds
    s_add_u32 m0, s59, 133120
    s_mov_b32 s63, 65536
    buffer_load_dwordx4 v6, s[16:19], s63 offen lds
    s_add_u32 m0, s59, 139264
    s_mov_b32 s63, 1048576
    buffer_load_dwordx4 v6, s[16:19], s63 offen lds
    s_add_u32 m0, s59, 141312
    s_mov_b32 s63, 1114112
    buffer_load_dwordx4 v6, s[16:19], s63 offen lds
    s_add_u32 m0, s59, 147456
    s_mov_b32 s63, 2097152
    buffer_load_dwordx4 v6, s[16:19], s63 offen lds
    s_add_u32 m0, s59, 149504
    s_mov_b32 s63, 2162688
    buffer_load_dwordx4 v6, s[16:19], s63 offen lds
    s_add_u32 m0, s59, 155648
    s_mov_b32 s63, 3145728
    buffer_load_dwordx4 v6, s[16:19], s63 offen lds
    s_add_u32 m0, s59, 157696
    s_mov_b32 s63, 3211264
    buffer_load_dwordx4 v6, s[16:19], s63 offen lds
    s_waitcnt vmcnt(40)
    s_barrier
    s_cmp_lg_u32 s29, 0
    s_cbranch_scc1 L_ch_noinc
    s_cmp_lg_u32 s36, 0
    s_cselect_b32 s58, 0x10001, 1
    s_mov_b64 exec, 1
    v_mov_b32 v13, s58
    buffer_atomic_add v13, off, s[8:11], 0 offset:32
    s_mov_b64 exec, -1
L_ch_noinc:
    s_waitcnt vmcnt(32)
    s_barrier
    ds_read2st64_b32 v[96:97], v8 offset0:0 offset1:1
    ds_read2st64_b32 v[98:99], v8 offset0:8 offset1:9
    ds_read2st64_b32 v[100:101], v8 offset0:2 offset1:3
    ds_read2st64_b32 v[102:103], v8 offset0:10 offset1:11
    ds_read2st64_b32 v[104:105], v9 offset0:0 offset1:1
    ds_read2st64_b32 v[106:107], v9 offset0:8 offset1:9
    ds_read2st64_b32 v[108:109], v9 offset0:2 offset1:3
    ds_read2st64_b32 v[110:111], v9 offset0:10 offset1:11
    ds_read2st64_b32 v[112:113], v10 offset0:0 offset1:1
    ds_read2st64_b32 v[114:115], v10 offset0:8 offset1:9
    ds_read2st64_b32 v[116:117], v10 offset0:2 offset1:3
    ds_read2st64_b32 v[118:119], v10 offset0:10 offset1:11
    s_waitcnt lgkmcnt(11)
    v_perm_b32 v152, v97, v96, s60
    s_waitcnt lgkmcnt(10)
    v_perm_b32 v153, v99, v98, s60
    s_waitcnt lgkmcnt(9)
    v_perm_b32 v154, v101, v100, s60
    s_waitcnt lgkmcnt(8)
    v_perm_b32 v155, v103, v102, s60
    v_perm_b32 v160, v97, v96, s61
    v_perm_b32 v161, v99, v98, s61
    v_perm_b32 v162, v101, v100, s61
    v_perm_b32 v163, v103, v102, s61
    ds_read2st64_b32 v[96:97], v11 offset0:0 offset1:1
    ds_read2st64_b32 v[98:99], v11 offset0:8 offset1:9
    ds_read2st64_b32 v[100:101], v11 offset0:2 offset1:3
    ds_read2st64_b32 v[102:103], v11 offset0:10 offset1:11
    s_waitcnt lgkmcnt(11)
    v_perm_b32 v12, v105, v104, s60
    s_waitcnt lgkmcnt(10)
    v_perm_b32 v13, v107, v106, s60
    s_waitcnt lgkmcnt(9)
    v_perm_b32 v14, v109, v108, s60
    s_waitcnt lgkmcnt(8)
    v_perm_b32 v15, v111, v110, s60
    v_accvgpr_write_b32 a64, v12
    v_accvgpr_write_b32 a65, v13
    v_accvgpr_write_b32 a66, v14
    v_accvgpr_write_b32 a67, v15
    v_perm_b32 v12, v105, v104, s61
    v_perm_b32 v13, v107, v106, s61
    v_perm_b32 v14, v109, v108, s61
    v_perm_b32 v15, v111, v110, s61
    v_accvgpr_write_b32 a72, v12
    v_accvgpr_write_b32 a73, v13
    v_accvgpr_write_b32 a74, v14
    v_accvgpr_write_b32 a75, v15
    s_waitcnt lgkmcnt(7)
    v_perm_b32 v184, v113, v112, s60
    s_waitcnt lgkmcnt(6)
    v_perm_b32 v185, v115, v114, s60
    s_waitcnt lgkmcnt(5)
    v_perm_b32 v186, v117, v116, s60
    s_waitcnt lgkmcnt(4)
    v_perm_b32 v187, v119, v118, s60
    v_perm_b32 v12, v113, v112, s61
    v_perm_b32 v13, v115, v114, s61
    v_perm_b32 v14, v117, v116, s61
    v_perm_b32 v15, v119, v118, s61
    v_accvgpr_write_b32 a96, v12
    v_accvgpr_write_b32 a97, v13
    v_accvgpr_write_b32 a98, v14
    v_accvgpr_write_b32 a99, v15
    s_waitcnt lgkmcnt(3)
    v_perm_b32 v200, v97, v96, s60
    s_waitcnt lgkmcnt(2)
    v_perm_b32 v201, v99, v98, s60
    s_waitcnt lgkmcnt(1)
    v_perm_b32 v202, v101, v100, s60
    s_waitcnt lgkmcnt(0)
    v_perm_b32 v203, v103, v102, s60
    v_perm_b32 v12, v97, v96, s61
    v_perm_b32 v13, v99, v98, s61
    v_perm_b32 v14, v101, v100, s61
    v_perm_b32 v15, v103, v102, s61
    v_accvgpr_write_b32 a112, v12
    v_accvgpr_write_b32 a113, v13
    v_accvgpr_write_b32 a114, v14
    v_accvgpr_write_b32 a115, v15
    s_waitcnt vmcnt(24)
    s_barrier
    s_add_u32 m0, s59, 0
    s_mov_b32 s63, 262144
    buffer_load_dwordx4 v6, s[16:19], s63 offen lds
    s_add_u32 m0, s59, 2048
    s_mov_b32 s63, 327680
    buffer_load_dwordx4 v6, s[16:19], s63 offen lds
    s_add_u32 m0, s59, 8192
    s_mov_b32 s63, 1310720
    buffer_load_dwordx4 v6, s[16:19], s63 offen lds
    s_add_u32 m0, s59, 10240
    s_mov_b32 s63, 1376256
    buffer_load_dwordx4 v6, s[16:19], s63 offen lds
    s_add_u32 m0, s59, 16384
    s_mov_b32 s63, 2359296
    buffer_load_dwordx4 v6, s[16:19], s63 offen lds
    s_add_u32 m0, s59, 18432
    s_mov_b32 s63, 2424832
    buffer_load_dwordx4 v6, s[16:19], s63 offen lds
    s_add_u32 m0, s59, 24576
    s_mov_b32 s63, 3407872
    buffer_load_dwordx4 v6, s[16:19], s63 offen lds
    s_add_u32 m0, s59, 26624
    s_mov_b32 s63, 3473408
    buffer_load_dwordx4 v6, s[16:19], s63 offen lds
    ds_read2st64_b32 v[96:97], v8 offset0:128 offset1:129
    ds_read2st64_b32 v[98:99], v8 offset0:136 offset1:137
    ds_read2st64_b32 v[100:101], v8 offset0:130 offset1:131
    ds_read2st64_b32 v[102:103], v8 offset0:138 offset1:139
    ds_read2st64_b32 v[104:105], v9 offset0:128 offset1:129
    ds_read2st64_b32 v[106:107], v9 offset0:136 offset1:137
    ds_read2st64_b32 v[108:109], v9 offset0:130 offset1:131
    ds_read2st64_b32 v[110:111], v9 offset0:138 offset1:139
    ds_read2st64_b32 v[112:113], v10 offset0:128 offset1:129
    ds_read2st64_b32 v[114:115], v10 offset0:136 offset1:137
    ds_read2st64_b32 v[116:117], v10 offset0:130 offset1:131
    ds_read2st64_b32 v[118:119], v10 offset0:138 offset1:139
    s_waitcnt lgkmcnt(11)
    v_perm_b32 v156, v97, v96, s60
    s_waitcnt lgkmcnt(10)
    v_perm_b32 v157, v99, v98, s60
    s_waitcnt lgkmcnt(9)
    v_perm_b32 v158, v101, v100, s60
    s_waitcnt lgkmcnt(8)
    v_perm_b32 v159, v103, v102, s60
    v_perm_b32 v164, v97, v96, s61
    v_perm_b32 v165, v99, v98, s61
    v_perm_b32 v166, v101, v100, s61
    v_perm_b32 v167, v103, v102, s61
    ds_read2st64_b32 v[96:97], v11 offset0:128 offset1:129
    ds_read2st64_b32 v[98:99], v11 offset0:136 offset1:137
    ds_read2st64_b32 v[100:101], v11 offset0:130 offset1:131
    ds_read2st64_b32 v[102:103], v11 offset0:138 offset1:139
    s_waitcnt lgkmcnt(11)
    v_perm_b32 v12, v105, v104, s60
    s_waitcnt lgkmcnt(10)
    v_perm_b32 v13, v107, v106, s60
    s_waitcnt lgkmcnt(9)
    v_perm_b32 v14, v109, v108, s60
    s_waitcnt lgkmcnt(8)
    v_perm_b32 v15, v111, v110, s60
    v_accvgpr_write_b32 a68, v12
    v_accvgpr_write_b32 a69, v13
    v_accvgpr_write_b32 a70, v14
    v_accvgpr_write_b32 a71, v15
    v_perm_b32 v12, v105, v104, s61
    v_perm_b32 v13, v107, v106, s61
    v_perm_b32 v14, v109, v108, s61
    v_perm_b32 v15, v111, v110, s61
    v_accvgpr_write_b32 a76, v12
    v_accvgpr_write_b32 a77, v13
    v_accvgpr_write_b32 a78, v14
    v_accvgpr_write_b32 a79, v15
    s_waitcnt lgkmcnt(7)
    v_perm_b32 v188, v113, v112, s60
    s_waitcnt lgkmcnt(6)
    v_perm_b32 v189, v115, v114, s60
    s_waitcnt lgkmcnt(5)
    v_perm_b32 v190, v117, v116, s60
    s_waitcnt lgkmcnt(4)
    v_perm_b32 v191, v119, v118, s60
    v_perm_b32 v12, v113, v112, s61
    v_perm_b32 v13, v115, v114, s61
    v_perm_b32 v14, v117, v116, s61
    v_perm_b32 v15, v119, v118, s61
    v_accvgpr_write_b32 a100, v12
    v_accvgpr_write_b32 a101, v13
    v_accvgpr_write_b32 a102, v14
    v_accvgpr_write_b32 a103, v15
    s_waitcnt lgkmcnt(3)
    v_perm_b32 v204, v97, v96, s60
    s_waitcnt lgkmcnt(2)
    v_perm_b32 v205, v99, v98, s60
    s_waitcnt lgkmcnt(1)
    v_perm_b32 v206, v101, v100, s60
    s_waitcnt lgkmcnt(0)
    v_perm_b32 v207, v103, v102, s60
    v_perm_b32 v12, v97, v96, s61
    v_perm_b32 v13, v99, v98, s61
    v_perm_b32 v14, v101, v100, s61
    v_perm_b32 v15, v103, v102, s61
    v_accvgpr_write_b32 a116, v12
    v_accvgpr_write_b32 a117, v13
    v_accvgpr_write_b32 a118, v14
    v_accvgpr_write_b32 a119, v15
    s_waitcnt vmcnt(24)
    s_barrier
    s_add_u32 m0, s59, 32768
    s_mov_b32 s63, 524288
    buffer_load_dwordx4 v6, s[16:19], s63 offen lds
    s_add_u32 m0, s59, 34816
    s_mov_b32 s63, 589824
    buffer_load_dwordx4 v6, s[16:19], s63 offen lds
    s_add_u32 m0, s59, 40960
    s_mov_b32 s63, 1572864
    buffer_load_dwordx4 v6, s[16:19], s63 offen lds
    s_add_u32 m0, s59, 43008
    s_mov_b32 s63, 1638400
    buffer_load_dwordx4 v6, s[16:19], s63 offen lds
    s_add_u32 m0, s59, 49152
    s_mov_b32 s63, 2621440
    buffer_load_dwordx4 v6, s[16:19], s63 offen lds
    s_add_u32 m0, s59, 51200
    s_mov_b32 s63, 2686976
    buffer_load_dwordx4 v6, s[16:19], s63 offen lds
    s_add_u32 m0, s59, 57344
    s_mov_b32 s63, 3670016
    buffer_load_dwordx4 v6, s[16:19], s63 offen lds
    s_add_u32 m0, s59, 59392
    s_mov_b32 s63, 3735552
    buffer_load_dwordx4 v6, s[16:19], s63 offen lds
    v_add_u32 v8, 0x10000, v8
    v_add_u32 v9, 0x10000, v9
    v_add_u32 v10, 0x10000, v10
    v_add_u32 v11, 0x10000, v11
    ds_read2st64_b32 v[96:97], v8 offset0:0 offset1:1
    ds_read2st64_b32 v[98:99], v8 offset0:8 offset1:9
    ds_read2st64_b32 v[100:101], v8 offset0:2 offset1:3
    ds_read2st64_b32 v[102:103], v8 offset0:10 offset1:11
    ds_read2st64_b32 v[104:105], v9 offset0:0 offset1:1
    ds_read2st64_b32 v[106:107], v9 offset0:8 offset1:9
    ds_read2st64_b32 v[108:109], v9 offset0:2 offset1:3
    ds_read2st64_b32 v[110:111], v9 offset0:10 offset1:11
    ds_read2st64_b32 v[112:113], v10 offset0:0 offset1:1
    ds_read2st64_b32 v[114:115], v10 offset0:8 offset1:9
    ds_read2st64_b32 v[116:117], v10 offset0:2 offset1:3
    ds_read2st64_b32 v[118:119], v10 offset0:10 offset1:11
    s_waitcnt lgkmcnt(11)
    v_perm_b32 v168, v97, v96, s60
    s_waitcnt lgkmcnt(10)
    v_perm_b32 v169, v99, v98, s60
    s_waitcnt lgkmcnt(9)
    v_perm_b32 v170, v101, v100, s60
    s_waitcnt lgkmcnt(8)
    v_perm_b32 v171, v103, v102, s60
    v_perm_b32 v176, v97, v96, s61
    v_perm_b32 v177, v99, v98, s61
    v_perm_b32 v178, v101, v100, s61
    v_perm_b32 v179, v103, v102, s61
    ds_read2st64_b32 v[96:97], v11 offset0:0 offset1:1
    ds_read2st64_b32 v[98:99], v11 offset0:8 offset1:9
    ds_read2st64_b32 v[100:101], v11 offset0:2 offset1:3
    ds_read2st64_b32 v[102:103], v11 offset0:10 offset1:11
    s_waitcnt lgkmcnt(11)
    v_perm_b32 v12, v105, v104, s60
    s_waitcnt lgkmcnt(10)
    v_perm_b32 v13, v107, v106, s60
    s_waitcnt lgkmcnt(9)
    v_perm_b32 v14, v109, v108, s60
    s_waitcnt lgkmcnt(8)
    v_perm_b32 v15, v111, v110, s60
    v_accvgpr_write_b32 a80, v12
    v_accvgpr_write_b32 a81, v13
    v_accvgpr_write_b32 a82, v14
    v_accvgpr_write_b32 a83, v15
    v_perm_b32 v12, v105, v104, s61
    v_perm_b32 v13, v107, v106, s61
    v_perm_b32 v14, v109, v108, s61
    v_perm_b32 v15, v111, v110, s61
    v_accvgpr_write_b32 a88, v12
    v_accvgpr_write_b32 a89, v13
    v_accvgpr_write_b32 a90, v14
    v_accvgpr_write_b32 a91, v15
    s_waitcnt lgkmcnt(7)
    v_perm_b32 v192, v113, v112, s60
    s_waitcnt lgkmcnt(6)
    v_perm_b32 v193, v115, v114, s60
    s_waitcnt lgkmcnt(5)
    v_perm_b32 v194, v117, v116, s60
    s_waitcnt lgkmcnt(4)
    v_perm_b32 v195, v119, v118, s60
    v_perm_b32 v12, v113, v112, s61
    v_perm_b32 v13, v115, v114, s61
    v_perm_b32 v14, v117, v116, s61
    v_perm_b32 v15, v119, v118, s61
    v_accvgpr_write_b32 a104, v12
    v_accvgpr_write_b32 a105, v13
    v_accvgpr_write_b32 a106, v14
    v_accvgpr_write_b32 a107, v15
    s_waitcnt lgkmcnt(3)
    v_perm_b32 v12, v97, v96, s60
    s_waitcnt lgkmcnt(2)
    v_perm_b32 v13, v99, v98, s60
    s_waitcnt lgkmcnt(1)
    v_perm_b32 v14, v101, v100, s60
    s_waitcnt lgkmcnt(0)
    v_perm_b32 v15, v103, v102, s60
    v_accvgpr_write_b32 a120, v12
    v_accvgpr_write_b32 a121, v13
    v_accvgpr_write_b32 a122, v14
    v_accvgpr_write_b32 a123, v15
    v_perm_b32 v12, v97, v96, s61
    v_perm_b32 v13, v99, v98, s61
    v_perm_b32 v14, v101, v100, s61
    v_perm_b32 v15, v103, v102, s61
    v_accvgpr_write_b32 a128, v12
    v_accvgpr_write_b32 a129, v13
    v_accvgpr_write_b32 a130, v14
    v_accvgpr_write_b32 a131, v15
    s_waitcnt vmcnt(24)
    s_barrier
    s_add_u32 m0, s59, 65536
    s_mov_b32 s63, 786432
    buffer_load_dwordx4 v6, s[16:19], s63 offen lds
    s_add_u32 m0, s59, 67584
    s_mov_b32 s63, 851968
    buffer_load_dwordx4 v6, s[16:19], s63 offen lds
    s_add_u32 m0, s59, 73728
    s_mov_b32 s63, 1835008
    buffer_load_dwordx4 v6, s[16:19], s63 offen lds
    s_add_u32 m0, s59, 75776
    s_mov_b32 s63, 1900544
    buffer_load_dwordx4 v6, s[16:19], s63 offen lds
    s_add_u32 m0, s59, 81920
    s_mov_b32 s63, 2883584
    buffer_load_dwordx4 v6, s[16:19], s63 offen lds
    s_add_u32 m0, s59, 83968
    s_mov_b32 s63, 2949120
    buffer_load_dwordx4 v6, s[16:19], s63 offen lds
    s_add_u32 m0, s59, 90112
    s_mov_b32 s63, 3932160
    buffer_load_dwordx4 v6, s[16:19], s63 offen lds
    s_add_u32 m0, s59, 92160
    s_mov_b32 s63, 3997696
    buffer_load_dwordx4 v6, s[16:19], s63 offen lds
    ds_read2st64_b32 v[96:97], v8 offset0:128 offset1:129
    ds_read2st64_b32 v[98:99], v8 offset0:136 offset1:137
    ds_read2st64_b32 v[100:101], v8 offset0:130 offset1:131
    ds_read2st64_b32 v[102:103], v8 offset0:138 offset1:139
    ds_read2st64_b32 v[104:105], v9 offset0:128 offset1:129
    ds_read2st64_b32 v[106:107], v9 offset0:136 offset1:137
    ds_read2st64_b32 v[108:109], v9 offset0:130 offset1:131
    ds_read2st64_b32 v[110:111], v9 offset0:138 offset1:139
    ds_read2st64_b32 v[112:113], v10 offset0:128 offset1:129
    ds_read2st64_b32 v[114:115], v10 offset0:136 offset1:137
    ds_read2st64_b32 v[116:117], v10 offset0:130 offset1:131
    ds_read2st64_b32 v[118:119], v10 offset0:138 offset1:139
    s_waitcnt lgkmcnt(11)
    v_perm_b32 v172, v97, v96, s60
    s_waitcnt lgkmcnt(10)
    v_perm_b32 v173, v99, v98, s60
    s_waitcnt lgkmcnt(9)
    v_perm_b32 v174, v101, v100, s60
    s_waitcnt lgkmcnt(8)
    v_perm_b32 v175, v103, v102, s60
    v_perm_b32 v180, v97, v96, s61
    v_perm_b32 v181, v99, v98, s61
    v_perm_b32 v182, v101, v100, s61
    v_perm_b32 v183, v103, v102, s61
    ds_read2st64_b32 v[96:97], v11 offset0:128 offset1:129
    ds_read2st64_b32 v[98:99], v11 offset0:136 offset1:137
    ds_read2st64_b32 v[100:101], v11 offset0:130 offset1:131
    ds_read2st64_b32 v[102:103], v11 offset0:138 offset1:139
    s_waitcnt lgkmcnt(11)
    v_perm_b32 v12, v105, v104, s60
    s_waitcnt lgkmcnt(10)
    v_perm_b32 v13, v107, v106, s60
    s_waitcnt lgkmcnt(9)
    v_perm_b32 v14, v109, v108, s60
    s_waitcnt lgkmcnt(8)
    v_perm_b32 v15, v111, v110, s60
    v_accvgpr_write_b32 a84, v12
    v_accvgpr_write_b32 a85, v13
    v_accvgpr_write_b32 a86, v14
    v_accvgpr_write_b32 a87, v15
    v_perm_b32 v12, v105, v104, s61
    v_perm_b32 v13, v107, v106, s61
    v_perm_b32 v14, v109, v108, s61
    v_perm_b32 v15, v111, v110, s61
    v_accvgpr_write_b32 a92, v12
    v_accvgpr_write_b32 a93, v13
    v_accvgpr_write_b32 a94, v14
    v_accvgpr_write_b32 a95, v15
    s_waitcnt lgkmcnt(7)
    v_perm_b32 v196, v113, v112, s60
    s_waitcnt lgkmcnt(6)
    v_perm_b32 v197, v115, v114, s60
    s_waitcnt lgkmcnt(5)
    v_perm_b32 v198, v117, v116, s60
    s_waitcnt lgkmcnt(4)
    v_perm_b32 v199, v119, v118, s60
    v_perm_b32 v12, v113, v112, s61
    v_perm_b32 v13, v115, v114, s61
    v_perm_b32 v14, v117, v116, s61
    v_perm_b32 v15, v119, v118, s61
    v_accvgpr_write_b32 a108, v12
    v_accvgpr_write_b32 a109, v13
    v_accvgpr_write_b32 a110, v14
    v_accvgpr_write_b32 a111, v15
    s_waitcnt lgkmcnt(3)
    v_perm_b32 v12, v97, v96, s60
    s_waitcnt lgkmcnt(2)
    v_perm_b32 v13, v99, v98, s60
    s_waitcnt lgkmcnt(1)
    v_perm_b32 v14, v101, v100, s60
    s_waitcnt lgkmcnt(0)
    v_perm_b32 v15, v103, v102, s60
    v_accvgpr_write_b32 a124, v12
    v_accvgpr_write_b32 a125, v13
    v_accvgpr_write_b32 a126, v14
    v_accvgpr_write_b32 a127, v15
    v_perm_b32 v12, v97, v96, s61
    v_perm_b32 v13, v99, v98, s61
    v_perm_b32 v14, v101, v100, s61
    v_perm_b32 v15, v103, v102, s61
    v_accvgpr_write_b32 a132, v12
    v_accvgpr_write_b32 a133, v13
    v_accvgpr_write_b32 a134, v14
    v_accvgpr_write_b32 a135, v15
    s_waitcnt vmcnt(24)
    s_barrier
    s_add_u32 m0, s59, 98304
    s_mov_b32 s63, 0
    buffer_load_dwordx4 v6, s[20:23], s63 offen lds
    s_add_u32 m0, s59, 100352
    s_mov_b32 s63, 65536
    buffer_load_dwordx4 v6, s[20:23], s63 offen lds
    s_add_u32 m0, s59, 106496
    s_mov_b32 s63, 1048576
    buffer_load_dwordx4 v6, s[20:23], s63 offen lds
    s_add_u32 m0, s59, 108544
    s_mov_b32 s63, 1114112
    buffer_load_dwordx4 v6, s[20:23], s63 offen lds
    s_add_u32 m0, s59, 114688
    s_mov_b32 s63, 2097152
    buffer_load_dwordx4 v6, s[20:23], s63 offen lds
    s_add_u32 m0, s59, 116736
    s_mov_b32 s63, 2162688
    buffer_load_dwordx4 v6, s[20:23], s63 offen lds
    s_add_u32 m0, s59, 122880
    s_mov_b32 s63, 3145728
    buffer_load_dwordx4 v6, s[20:23], s63 offen lds
    s_add_u32 m0, s59, 124928
    s_mov_b32 s63, 3211264
    buffer_load_dwordx4 v6, s[20:23], s63 offen lds
    v_add_u32 v8, 0x10000, v8
    v_add_u32 v9, 0x10000, v9
    v_add_u32 v10, 0x10000, v10
    v_add_u32 v11, 0x10000, v11
    ds_read2st64_b32 v[96:97], v8 offset0:0 offset1:1
    ds_read2st64_b32 v[98:99], v8 offset0:8 offset1:9
    ds_read2st64_b32 v[100:101], v8 offset0:2 offset1:3
    ds_read2st64_b32 v[102:103], v8 offset0:10 offset1:11
    ds_read2st64_b32 v[104:105], v9 offset0:0 offset1:1
    ds_read2st64_b32 v[106:107], v9 offset0:8 offset1:9
    ds_read2st64_b32 v[108:109], v9 offset0:2 offset1:3
    ds_read2st64_b32 v[110:111], v9 offset0:10 offset1:11
    ds_read2st64_b32 v[112:113], v10 offset0:0 offset1:1
    ds_read2st64_b32 v[114:115], v10 offset0:8 offset1:9
    ds_read2st64_b32 v[116:117], v10 offset0:2 offset1:3
    ds_read2st64_b32 v[118:119], v10 offset0:10 offset1:11
    s_waitcnt lgkmcnt(11)
    v_perm_b32 v12, v97, v96, s60
    s_waitcnt lgkmcnt(10)
    v_perm_b32 v13, v99, v98, s60
    s_waitcnt lgkmcnt(9)
    v_perm_b32 v14, v101, v100, s60
    s_waitcnt lgkmcnt(8)
    v_perm_b32 v15, v103, v102, s60
    v_accvgpr_write_b32 a0, v12
    v_accvgpr_write_b32 a1, v13
    v_accvgpr_write_b32 a2, v14
    v_accvgpr_write_b32 a3, v15
    v_perm_b32 v12, v97, v96, s61
    v_perm_b32 v13, v99, v98, s61
    v_perm_b32 v14, v101, v100, s61
    v_perm_b32 v15, v103, v102, s61
    v_accvgpr_write_b32 a8, v12
    v_accvgpr_write_b32 a9, v13
    v_accvgpr_write_b32 a10, v14
    v_accvgpr_write_b32 a11, v15
    ds_read2st64_b32 v[96:97], v11 offset0:0 offset1:1
    ds_read2st64_b32 v[98:99], v11 offset0:8 offset1:9
    ds_read2st64_b32 v[100:101], v11 offset0:2 offset1:3
    ds_read2st64_b32 v[102:103], v11 offset0:10 offset1:11
    s_waitcnt lgkmcnt(11)
    v_perm_b32 v208, v105, v104, s60
    s_waitcnt lgkmcnt(10)
    v_perm_b32 v209, v107, v106, s60
    s_waitcnt lgkmcnt(9)
    v_perm_b32 v210, v109, v108, s60
    s_waitcnt lgkmcnt(8)
    v_perm_b32 v211, v111, v110, s60
    v_perm_b32 v12, v105, v104, s61
    v_perm_b32 v13, v107, v106, s61
    v_perm_b32 v14, v109, v108, s61
    v_perm_b32 v15, v111, v110, s61
    v_accvgpr_write_b32 a136, v12
    v_accvgpr_write_b32 a137, v13
    v_accvgpr_write_b32 a138, v14
    v_accvgpr_write_b32 a139, v15
    s_waitcnt lgkmcnt(7)
    v_perm_b32 v224, v113, v112, s60
    s_waitcnt lgkmcnt(6)
    v_perm_b32 v225, v115, v114, s60
    s_waitcnt lgkmcnt(5)
    v_perm_b32 v226, v117, v116, s60
    s_waitcnt lgkmcnt(4)
    v_perm_b32 v227, v119, v118, s60
    v_perm_b32 v12, v113, v112, s61
    v_perm_b32 v13, v115, v114, s61
    v_perm_b32 v14, v117, v116, s61
    v_perm_b32 v15, v119, v118, s61
    v_accvgpr_write_b32 a152, v12
    v_accvgpr_write_b32 a153, v13
    v_accvgpr_write_b32 a154, v14
    v_accvgpr_write_b32 a155, v15
    s_waitcnt lgkmcnt(3)
    v_perm_b32 v232, v97, v96, s60
    s_waitcnt lgkmcnt(2)
    v_perm_b32 v233, v99, v98, s60
    s_waitcnt lgkmcnt(1)
    v_perm_b32 v234, v101, v100, s60
    s_waitcnt lgkmcnt(0)
    v_perm_b32 v235, v103, v102, s60
    v_perm_b32 v12, v97, v96, s61
    v_perm_b32 v13, v99, v98, s61
    v_perm_b32 v14, v101, v100, s61
    v_perm_b32 v15, v103, v102, s61
    v_accvgpr_write_b32 a176, v12
    v_accvgpr_write_b32 a177, v13
    v_accvgpr_write_b32 a178, v14
    v_accvgpr_write_b32 a179, v15
    s_waitcnt vmcnt(24)
    s_barrier
    s_add_u32 m0, s59, 131072
    s_mov_b32 s63, 262144
    buffer_load_dwordx4 v6, s[20:23], s63 offen lds
    s_add_u32 m0, s59, 133120
    s_mov_b32 s63, 327680
    buffer_load_dwordx4 v6, s[20:23], s63 offen lds
    s_add_u32 m0, s59, 139264
    s_mov_b32 s63, 1310720
    buffer_load_dwordx4 v6, s[20:23], s63 offen lds
    s_add_u32 m0, s59, 141312
    s_mov_b32 s63, 1376256
    buffer_load_dwordx4 v6, s[20:23], s63 offen lds
    s_add_u32 m0, s59, 147456
    s_mov_b32 s63, 2359296
    buffer_load_dwordx4 v6, s[20:23], s63 offen lds
    s_add_u32 m0, s59, 149504
    s_mov_b32 s63, 2424832
    buffer_load_dwordx4 v6, s[20:23], s63 offen lds
    s_add_u32 m0, s59, 155648
    s_mov_b32 s63, 3407872
    buffer_load_dwordx4 v6, s[20:23], s63 offen lds
    s_add_u32 m0, s59, 157696
    s_mov_b32 s63, 3473408
    buffer_load_dwordx4 v6, s[20:23], s63 offen lds
    v_add_u32 v8, 0xfffe0000, v8
    v_add_u32 v9, 0xfffe0000, v9
    v_add_u32 v10, 0xfffe0000, v10
    v_add_u32 v11, 0xfffe0000, v11
    ds_read2st64_b32 v[96:97], v8 offset0:0 offset1:1
    ds_read2st64_b32 v[98:99], v8 offset0:8 offset1:9
    ds_read2st64_b32 v[100:101], v8 offset0:2 offset1:3
    ds_read2st64_b32 v[102:103], v8 offset0:10 offset1:11
    ds_read2st64_b32 v[104:105], v9 offset0:0 offset1:1
    ds_read2st64_b32 v[106:107], v9 offset0:8 offset1:9
    ds_read2st64_b32 v[108:109], v9 offset0:2 offset1:3
    ds_read2st64_b32 v[110:111], v9 offset0:10 offset1:11
    ds_read2st64_b32 v[112:113], v10 offset0:0 offset1:1
    ds_read2st64_b32 v[114:115], v10 offset0:8 offset1:9
    ds_read2st64_b32 v[116:117], v10 offset0:2 offset1:3
    ds_read2st64_b32 v[118:119], v10 offset0:10 offset1:11
    s_waitcnt lgkmcnt(11)
    v_perm_b32 v12, v97, v96, s60
    s_waitcnt lgkmcnt(10)
    v_perm_b32 v13, v99, v98, s60
    s_waitcnt lgkmcnt(9)
    v_perm_b32 v14, v101, v100, s60
    s_waitcnt lgkmcnt(8)
    v_perm_b32 v15, v103, v102, s60
    v_accvgpr_write_b32 a4, v12
    v_accvgpr_write_b32 a5, v13
    v_accvgpr_write_b32 a6, v14
    v_accvgpr_write_b32 a7, v15
    v_perm_b32 v12, v97, v96, s61
    v_perm_b32 v13, v99, v98, s61
    v_perm_b32 v14, v101, v100, s61
    v_perm_b32 v15, v103, v102, s61
    v_accvgpr_write_b32 a12, v12
    v_accvgpr_write_b32 a13, v13
    v_accvgpr_write_b32 a14, v14
    v_accvgpr_write_b32 a15, v15
    ds_read2st64_b32 v[96:97], v11 offset0:0 offset1:1
    ds_read2st64_b32 v[98:99], v11 offset0:8 offset1:9
    ds_read2st64_b32 v[100:101], v11 offset0:2 offset1:3
    ds_read2st64_b32 v[102:103], v11 offset0:10 offset1:11
    s_waitcnt lgkmcnt(11)
    v_perm_b32 v212, v105, v104, s60
    s_waitcnt lgkmcnt(10)
    v_perm_b32 v213, v107, v106, s60
    s_waitcnt lgkmcnt(9)
    v_perm_b32 v214, v109, v108, s60
    s_waitcnt lgkmcnt(8)
    v_perm_b32 v215, v111, v110, s60
    v_perm_b32 v12, v105, v104, s61
    v_perm_b32 v13, v107, v106, s61
    v_perm_b32 v14, v109, v108, s61
    v_perm_b32 v15, v111, v110, s61
    v_accvgpr_write_b32 a140, v12
    v_accvgpr_write_b32 a141, v13
    v_accvgpr_write_b32 a142, v14
    v_accvgpr_write_b32 a143, v15
    s_waitcnt lgkmcnt(7)
    v_perm_b32 v228, v113, v112, s60
    s_waitcnt lgkmcnt(6)
    v_perm_b32 v229, v115, v114, s60
    s_waitcnt lgkmcnt(5)
    v_perm_b32 v230, v117, v116, s60
    s_waitcnt lgkmcnt(4)
    v_perm_b32 v231, v119, v118, s60
    v_perm_b32 v12, v113, v112, s61
    v_perm_b32 v13, v115, v114, s61
    v_perm_b32 v14, v117, v116, s61
    v_perm_b32 v15, v119, v118, s61
    v_accvgpr_write_b32 a156, v12
    v_accvgpr_write_b32 a157, v13
    v_accvgpr_write_b32 a158, v14
    v_accvgpr_write_b32 a159, v15
    s_waitcnt lgkmcnt(3)
    v_perm_b32 v236, v97, v96, s60
    s_waitcnt lgkmcnt(2)
    v_perm_b32 v237, v99, v98, s60
    s_waitcnt lgkmcnt(1)
    v_perm_b32 v238, v101, v100, s60
    s_waitcnt lgkmcnt(0)
    v_perm_b32 v239, v103, v102, s60
    v_perm_b32 v12, v97, v96, s61
    v_perm_b32 v13, v99, v98, s61
    v_perm_b32 v14, v101, v100, s61
    v_perm_b32 v15, v103, v102, s61
    v_accvgpr_write_b32 a180, v12
    v_accvgpr_write_b32 a181, v13
    v_accvgpr_write_b32 a182, v14
    v_accvgpr_write_b32 a183, v15
    s_waitcnt vmcnt(24)
    s_barrier
    s_add_u32 m0, s59, 0
    s_mov_b32 s63, 524288
    buffer_load_dwordx4 v6, s[20:23], s63 offen lds
    s_add_u32 m0, s59, 2048
    s_mov_b32 s63, 589824
    buffer_load_dwordx4 v6, s[20:23], s63 offen lds
    s_add_u32 m0, s59, 8192
    s_mov_b32 s63, 1572864
    buffer_load_dwordx4 v6, s[20:23], s63 offen lds
    s_add_u32 m0, s59, 10240
    s_mov_b32 s63, 1638400
    buffer_load_dwordx4 v6, s[20:23], s63 offen lds
    s_add_u32 m0, s59, 16384
    s_mov_b32 s63, 2621440
    buffer_load_dwordx4 v6, s[20:23], s63 offen lds
    s_add_u32 m0, s59, 18432
    s_mov_b32 s63, 2686976
    buffer_load_dwordx4 v6, s[20:23], s63 offen lds
    s_add_u32 m0, s59, 24576
    s_mov_b32 s63, 3670016
    buffer_load_dwordx4 v6, s[20:23], s63 offen lds
    s_add_u32 m0, s59, 26624
    s_mov_b32 s63, 3735552
    buffer_load_dwordx4 v6, s[20:23], s63 offen lds
    ds_read2st64_b32 v[96:97], v8 offset0:128 offset1:129
    ds_read2st64_b32 v[98:99], v8 offset0:136 offset1:137
    ds_read2st64_b32 v[100:101], v8 offset0:130 offset1:131
    ds_read2st64_b32 v[102:103], v8 offset0:138 offset1:139
    ds_read2st64_b32 v[104:105], v9 offset0:128 offset1:129
    ds_read2st64_b32 v[106:107], v9 offset0:136 offset1:137
    ds_read2st64_b32 v[108:109], v9 offset0:130 offset1:131
    ds_read2st64_b32 v[110:111], v9 offset0:138 offset1:139
    ds_read2st64_b32 v[112:113], v10 offset0:128 offset1:129
    ds_read2st64_b32 v[114:115], v10 offset0:136 offset1:137
    ds_read2st64_b32 v[116:117], v10 offset0:130 offset1:131
    ds_read2st64_b32 v[118:119], v10 offset0:138 offset1:139
    s_waitcnt lgkmcnt(11)
    v_perm_b32 v12, v97, v96, s60
    s_waitcnt lgkmcnt(10)
    v_perm_b32 v13, v99, v98, s60
    s_waitcnt lgkmcnt(9)
    v_perm_b32 v14, v101, v100, s60
    s_waitcnt lgkmcnt(8)
    v_perm_b32 v15, v103, v102, s60
    v_accvgpr_write_b32 a16, v12
    v_accvgpr_write_b32 a17, v13
    v_accvgpr_write_b32 a18, v14
    v_accvgpr_write_b32 a19, v15
    v_perm_b32 v12, v97, v96, s61
    v_perm_b32 v13, v99, v98, s61
    v_perm_b32 v14, v101, v100, s61
    v_perm_b32 v15, v103, v102, s61
    v_accvgpr_write_b32 a24, v12
    v_accvgpr_write_b32 a25, v13
    v_accvgpr_write_b32 a26, v14
    v_accvgpr_write_b32 a27, v15
    ds_read2st64_b32 v[96:97], v11 offset0:128 offset1:129
    ds_read2st64_b32 v[98:99], v11 offset0:136 offset1:137
    ds_read2st64_b32 v[100:101], v11 offset0:130 offset1:131
    ds_read2st64_b32 v[102:103], v11 offset0:138 offset1:139
    s_waitcnt lgkmcnt(11)
    v_perm_b32 v216, v105, v104, s60
    s_waitcnt lgkmcnt(10)
    v_perm_b32 v217, v107, v106, s60
    s_waitcnt lgkmcnt(9)
    v_perm_b32 v218, v109, v108, s60
    s_waitcnt lgkmcnt(8)
    v_perm_b32 v219, v111, v110, s60
    v_perm_b32 v12, v105, v104, s61
    v_perm_b32 v13, v107, v106, s61
    v_perm_b32 v14, v109, v108, s61
    v_perm_b32 v15, v111, v110, s61
    v_accvgpr_write_b32 a144, v12
    v_accvgpr_write_b32 a145, v13
    v_accvgpr_write_b32 a146, v14
    v_accvgpr_write_b32 a147, v15
    s_waitcnt lgkmcnt(7)
    v_perm_b32 v12, v113, v112, s60
    s_waitcnt lgkmcnt(6)
    v_perm_b32 v13, v115, v114, s60
    s_waitcnt lgkmcnt(5)
    v_perm_b32 v14, v117, v116, s60
    s_waitcnt lgkmcnt(4)
    v_perm_b32 v15, v119, v118, s60
    v_accvgpr_write_b32 a160, v12
    v_accvgpr_write_b32 a161, v13
    v_accvgpr_write_b32 a162, v14
    v_accvgpr_write_b32 a163, v15
    v_perm_b32 v12, v113, v112, s61
    v_perm_b32 v13, v115, v114, s61
    v_perm_b32 v14, v117, v116, s61
    v_perm_b32 v15, v119, v118, s61
    v_accvgpr_write_b32 a168, v12
    v_accvgpr_write_b32 a169, v13
    v_accvgpr_write_b32 a170, v14
    v_accvgpr_write_b32 a171, v15
    s_waitcnt lgkmcnt(3)
    v_perm_b32 v240, v97, v96, s60
    s_waitcnt lgkmcnt(2)
    v_perm_b32 v241, v99, v98, s60
    s_waitcnt lgkmcnt(1)
    v_perm_b32 v242, v101, v100, s60
    s_waitcnt lgkmcnt(0)
    v_perm_b32 v243, v103, v102, s60
    v_perm_b32 v12, v97, v96, s61
    v_perm_b32 v13, v99, v98, s61
    v_perm_b32 v14, v101, v100, s61
    v_perm_b32 v15, v103, v102, s61
    v_accvgpr_write_b32 a184, v12
    v_accvgpr_write_b32 a185, v13
    v_accvgpr_write_b32 a186, v14
    v_accvgpr_write_b32 a187, v15
    s_waitcnt vmcnt(24)
    s_barrier
    s_add_u32 m0, s59, 32768
    s_mov_b32 s63, 786432
    buffer_load_dwordx4 v6, s[20:23], s63 offen lds
    s_add_u32 m0, s59, 34816
    s_mov_b32 s63, 851968
    buffer_load_dwordx4 v6, s[20:23], s63 offen lds
    s_add_u32 m0, s59, 40960
    s_mov_b32 s63, 1835008
    buffer_load_dwordx4 v6, s[20:23], s63 offen lds
    s_add_u32 m0, s59, 43008
    s_mov_b32 s63, 1900544
    buffer_load_dwordx4 v6, s[20:23], s63 offen lds
    s_add_u32 m0, s59, 49152
    s_mov_b32 s63, 2883584
    buffer_load_dwordx4 v6, s[20:23], s63 offen lds
    s_add_u32 m0, s59, 51200
    s_mov_b32 s63, 2949120
    buffer_load_dwordx4 v6, s[20:23], s63 offen lds
    s_add_u32 m0, s59, 57344
    s_mov_b32 s63, 3932160
    buffer_load_dwordx4 v6, s[20:23], s63 offen lds
    s_add_u32 m0, s59, 59392
    s_mov_b32 s63, 3997696
    buffer_load_dwordx4 v6, s[20:23], s63 offen lds
    s_xor_b32 s62, s29, 0
    s_lshl_b32 s62, s62, 15
    s_add_u32 s63, s62, 0
    buffer_load_dwordx2 v[16:17], v7, s[24:27], s63 offen
    s_add_u32 s63, s62, 1024
    buffer_load_dwordx2 v[18:19], v7, s[24:27], s63 offen
    s_add_u32 s63, s62, 2048
    buffer_load_dwordx2 v[20:21], v7, s[24:27], s63 offen
    s_add_u32 s63, s62, 3072
    buffer_load_dwordx2 v[22:23], v7, s[24:27], s63 offen
    s_add_u32 s63, s62, 16384
    buffer_load_dwordx2 v[24:25], v7, s[24:27], s63 offen
    s_add_u32 s63, s62, 17408
    buffer_load_dwordx2 v[26:27], v7, s[24:27], s63 offen
    s_add_u32 s63, s62, 18432
    buffer_load_dwordx2 v[28:29], v7, s[24:27], s63 offen
    s_add_u32 s63, s62, 19456
    buffer_load_dwordx2 v[30:31], v7, s[24:27], s63 offen
    v_add_u32 v8, 0x10000, v8
    v_add_u32 v9, 0x10000, v9
    v_add_u32 v10, 0x10000, v10
    v_add_u32 v11, 0x10000, v11
    ds_read2st64_b32 v[96:97], v8 offset0:0 offset1:1
    ds_read2st64_b32 v[98:99], v8 offset0:8 offset1:9
    ds_read2st64_b32 v[100:101], v8 offset0:2 offset1:3
    ds_read2st64_b32 v[102:103], v8 offset0:10 offset1:11
    ds_read2st64_b32 v[104:105], v9 offset0:0 offset1:1
    ds_read2st64_b32 v[106:107], v9 offset0:8 offset1:9
    ds_read2st64_b32 v[108:109], v9 offset0:2 offset1:3
    ds_read2st64_b32 v[110:111], v9 offset0:10 offset1:11
    ds_read2st64_b32 v[112:113], v10 offset0:0 offset1:1
    ds_read2st64_b32 v[114:115], v10 offset0:8 offset1:9
    ds_read2st64_b32 v[116:117], v10 offset0:2 offset1:3
    ds_read2st64_b32 v[118:119], v10 offset0:10 offset1:11
    s_waitcnt lgkmcnt(11)
    v_perm_b32 v12, v97, v96, s60
    s_waitcnt lgkmcnt(10)
    v_perm_b32 v13, v99, v98, s60
    s_waitcnt lgkmcnt(9)
    v_perm_b32 v14, v101, v100, s60
    s_waitcnt lgkmcnt(8)
    v_perm_b32 v15, v103, v102, s60
    v_accvgpr_write_b32 a20, v12
    v_accvgpr_write_b32 a21, v13
    v_accvgpr_write_b32 a22, v14
    v_accvgpr_write_b32 a23, v15
    v_perm_b32 v12, v97, v96, s61
    v_perm_b32 v13, v99, v98, s61
    v_perm_b32 v14, v101, v100, s61
    v_perm_b32 v15, v103, v102, s61
    v_accvgpr_write_b32 a28, v12
    v_accvgpr_write_b32 a29, v13
    v_accvgpr_write_b32 a30, v14
    v_accvgpr_write_b32 a31, v15
    ds_read2st64_b32 v[96:97], v11 offset0:0 offset1:1
    ds_read2st64_b32 v[98:99], v11 offset0:8 offset1:9
    ds_read2st64_b32 v[100:101], v11 offset0:2 offset1:3
    ds_read2st64_b32 v[102:103], v11 offset0:10 offset1:11
    s_waitcnt lgkmcnt(11)
    v_perm_b32 v220, v105, v104, s60
    s_waitcnt lgkmcnt(10)
    v_perm_b32 v221, v107, v106, s60
    s_waitcnt lgkmcnt(9)
    v_perm_b32 v222, v109, v108, s60
    s_waitcnt lgkmcnt(8)
    v_perm_b32 v223, v111, v110, s60
    v_perm_b32 v12, v105, v104, s61
    v_perm_b32 v13, v107, v106, s61
    v_perm_b32 v14, v109, v108, s61
    v_perm_b32 v15, v111, v110, s61
    v_accvgpr_write_b32 a148, v12
    v_accvgpr_write_b32 a149, v13
    v_accvgpr_write_b32 a150, v14
    v_accvgpr_write_b32 a151, v15
    s_waitcnt lgkmcnt(7)
    v_perm_b32 v12, v113, v112, s60
    s_waitcnt lgkmcnt(6)
    v_perm_b32 v13, v115, v114, s60
    s_waitcnt lgkmcnt(5)
    v_perm_b32 v14, v117, v116, s60
    s_waitcnt lgkmcnt(4)
    v_perm_b32 v15, v119, v118, s60
    v_accvgpr_write_b32 a164, v12
    v_accvgpr_write_b32 a165, v13
    v_accvgpr_write_b32 a166, v14
    v_accvgpr_write_b32 a167, v15
    v_perm_b32 v12, v113, v112, s61
    v_perm_b32 v13, v115, v114, s61
    v_perm_b32 v14, v117, v116, s61
    v_perm_b32 v15, v119, v118, s61
    v_accvgpr_write_b32 a172, v12
    v_accvgpr_write_b32 a173, v13
    v_accvgpr_write_b32 a174, v14
    v_accvgpr_write_b32 a175, v15
    s_waitcnt lgkmcnt(3)
    v_perm_b32 v244, v97, v96, s60
    s_waitcnt lgkmcnt(2)
    v_perm_b32 v245, v99, v98, s60
    s_waitcnt lgkmcnt(1)
    v_perm_b32 v246, v101, v100, s60
    s_waitcnt lgkmcnt(0)
    v_perm_b32 v247, v103, v102, s60
    v_perm_b32 v12, v97, v96, s61
    v_perm_b32 v13, v99, v98, s61
    v_perm_b32 v14, v101, v100, s61
    v_perm_b32 v15, v103, v102, s61
    v_accvgpr_write_b32 a188, v12
    v_accvgpr_write_b32 a189, v13
    v_accvgpr_write_b32 a190, v14
    v_accvgpr_write_b32 a191, v15
    s_waitcnt vmcnt(32)
    s_barrier
    s_xor_b32 s62, s29, 0
    s_lshl_b32 s62, s62, 15
    s_add_u32 s63, s62, 128
    buffer_load_dwordx2 v[32:33], v7, s[24:27], s63 offen
    s_add_u32 s63, s62, 1152
    buffer_load_dwordx2 v[34:35], v7, s[24:27], s63 offen
    s_add_u32 s63, s62, 2176
    buffer_load_dwordx2 v[36:37], v7, s[24:27], s63 offen
    s_add_u32 s63, s62, 3200
    buffer_load_dwordx2 v[38:39], v7, s[24:27], s63 offen
    s_add_u32 s63, s62, 16512
    buffer_load_dwordx2 v[40:41], v7, s[24:27], s63 offen
    s_add_u32 s63, s62, 17536
    buffer_load_dwordx2 v[42:43], v7, s[24:27], s63 offen
    s_add_u32 s63, s62, 18560
    buffer_load_dwordx2 v[44:45], v7, s[24:27], s63 offen
    s_add_u32 s63, s62, 19584
    buffer_load_dwordx2 v[46:47], v7, s[24:27], s63 offen
    ds_read2st64_b32 v[96:97], v8 offset0:128 offset1:129
    ds_read2st64_b32 v[98:99], v8 offset0:136 offset1:137
    ds_read2st64_b32 v[100:101], v8 offset0:130 offset1:131
    ds_read2st64_b32 v[102:103], v8 offset0:138 offset1:139
    ds_read2st64_b32 v[104:105], v9 offset0:128 offset1:129
    ds_read2st64_b32 v[106:107], v9 offset0:136 offset1:137
    ds_read2st64_b32 v[108:109], v9 offset0:130 offset1:131
    ds_read2st64_b32 v[110:111], v9 offset0:138 offset1:139
    ds_read2st64_b32 v[112:113], v10 offset0:128 offset1:129
    ds_read2st64_b32 v[114:115], v10 offset0:136 offset1:137
    ds_read2st64_b32 v[116:117], v10 offset0:130 offset1:131
    ds_read2st64_b32 v[118:119], v10 offset0:138 offset1:139
    s_waitcnt lgkmcnt(11)
    v_perm_b32 v12, v97, v96, s60
    s_waitcnt lgkmcnt(10)
    v_perm_b32 v13, v99, v98, s60
    s_waitcnt lgkmcnt(9)
    v_perm_b32 v14, v101, v100, s60
    s_waitcnt lgkmcnt(8)
    v_perm_b32 v15, v103, v102, s60
    v_accvgpr_write_b32 a32, v12
    v_accvgpr_write_b32 a33, v13
    v_accvgpr_write_b32 a34, v14
    v_accvgpr_write_b32 a35, v15
    v_perm_b32 v12, v97, v96, s61
    v_perm_b32 v13, v99, v98, s61
    v_perm_b32 v14, v101, v100, s61
    v_perm_b32 v15, v103, v102, s61
    v_accvgpr_write_b32 a40, v12
    v_accvgpr_write_b32 a41, v13
    v_accvgpr_write_b32 a42, v14
    v_accvgpr_write_b32 a43, v15
    ds_read2st64_b32 v[96:97], v11 offset0:128 offset1:129
    ds_read2st64_b32 v[98:99], v11 offset0:136 offset1:137
    ds_read2st64_b32 v[100:101], v11 offset0:130 offset1:131
    ds_read2st64_b32 v[102:103], v11 offset0:138 offset1:139
    s_waitcnt lgkmcnt(11)
    v_perm_b32 v248, v105, v104, s60
    s_waitcnt lgkmcnt(10)
    v_perm_b32 v249, v107, v106, s60
    s_waitcnt lgkmcnt(9)
    v_perm_b32 v250, v109, v108, s60
    s_waitcnt lgkmcnt(8)
    v_perm_b32 v251, v111, v110, s60
    v_perm_b32 v12, v105, v104, s61
    v_perm_b32 v13, v107, v106, s61
    v_perm_b32 v14, v109, v108, s61
    v_perm_b32 v15, v111, v110, s61
    v_accvgpr_write_b32 a192, v12
    v_accvgpr_write_b32 a193, v13
    v_accvgpr_write_b32 a194, v14
    v_accvgpr_write_b32 a195, v15
    s_waitcnt lgkmcnt(7)
    v_perm_b32 v12, v113, v112, s60
    s_waitcnt lgkmcnt(6)
    v_perm_b32 v13, v115, v114, s60
    s_waitcnt lgkmcnt(5)
    v_perm_b32 v14, v117, v116, s60
    s_waitcnt lgkmcnt(4)
    v_perm_b32 v15, v119, v118, s60
    v_accvgpr_write_b32 a216, v12
    v_accvgpr_write_b32 a217, v13
    v_accvgpr_write_b32 a218, v14
    v_accvgpr_write_b32 a219, v15
    v_perm_b32 v12, v113, v112, s61
    v_perm_b32 v13, v115, v114, s61
    v_perm_b32 v14, v117, v116, s61
    v_perm_b32 v15, v119, v118, s61
    v_accvgpr_write_b32 a224, v12
    v_accvgpr_write_b32 a225, v13
    v_accvgpr_write_b32 a226, v14
    v_accvgpr_write_b32 a227, v15
    s_waitcnt lgkmcnt(3)
    v_perm_b32 v12, v97, v96, s60
    s_waitcnt lgkmcnt(2)
    v_perm_b32 v13, v99, v98, s60
    s_waitcnt lgkmcnt(1)
    v_perm_b32 v14, v101, v100, s60
    s_waitcnt lgkmcnt(0)
    v_perm_b32 v15, v103, v102, s60
    v_accvgpr_write_b32 a248, v12
    v_accvgpr_write_b32 a249, v13
    v_accvgpr_write_b32 a250, v14
    v_accvgpr_write_b32 a251, v15
    v_perm_b32 v128, v97, v96, s61
    v_perm_b32 v129, v99, v98, s61
    v_perm_b32 v130, v101, v100, s61
    v_perm_b32 v131, v103, v102, s61
    s_waitcnt vmcnt(32)
    s_barrier
    s_xor_b32 s62, s29, 1
    s_lshl_b32 s62, s62, 15
    s_add_u32 s63, s62, 0
    buffer_load_dwordx2 v[48:49], v7, s[24:27], s63 offen
    s_add_u32 s63, s62, 1024
    buffer_load_dwordx2 v[50:51], v7, s[24:27], s63 offen
    s_add_u32 s63, s62, 2048
    buffer_load_dwordx2 v[52:53], v7, s[24:27], s63 offen
    s_add_u32 s63, s62, 3072
    buffer_load_dwordx2 v[54:55], v7, s[24:27], s63 offen
    s_add_u32 s63, s62, 16384
    buffer_load_dwordx2 v[56:57], v7, s[24:27], s63 offen
    s_add_u32 s63, s62, 17408
    buffer_load_dwordx2 v[58:59], v7, s[24:27], s63 offen
    s_add_u32 s63, s62, 18432
    buffer_load_dwordx2 v[60:61], v7, s[24:27], s63 offen
    s_add_u32 s63, s62, 19456
    buffer_load_dwordx2 v[62:63], v7, s[24:27], s63 offen
    v_add_u32 v8, 0x10000, v8
    v_add_u32 v9, 0x10000, v9
    v_add_u32 v10, 0x10000, v10
    v_add_u32 v11, 0x10000, v11
    ds_read2st64_b32 v[96:97], v8 offset0:0 offset1:1
    ds_read2st64_b32 v[98:99], v8 offset0:8 offset1:9
    ds_read2st64_b32 v[100:101], v8 offset0:2 offset1:3
    ds_read2st64_b32 v[102:103], v8 offset0:10 offset1:11
    ds_read2st64_b32 v[104:105], v9 offset0:0 offset1:1
    ds_read2st64_b32 v[106:107], v9 offset0:8 offset1:9
    ds_read2st64_b32 v[108:109], v9 offset0:2 offset1:3
    ds_read2st64_b32 v[110:111], v9 offset0:10 offset1:11
    ds_read2st64_b32 v[112:113], v10 offset0:0 offset1:1
    ds_read2st64_b32 v[114:115], v10 offset0:8 offset1:9
    ds_read2st64_b32 v[116:117], v10 offset0:2 offset1:3
    ds_read2st64_b32 v[118:119], v10 offset0:10 offset1:11
    s_waitcnt lgkmcnt(11)
    v_perm_b32 v12, v97, v96, s60
    s_waitcnt lgkmcnt(10)
    v_perm_b32 v13, v99, v98, s60
    s_waitcnt lgkmcnt(9)
    v_perm_b32 v14, v101, v100, s60
    s_waitcnt lgkmcnt(8)
    v_perm_b32 v15, v103, v102, s60
    v_accvgpr_write_b32 a36, v12
    v_accvgpr_write_b32 a37, v13
    v_accvgpr_write_b32 a38, v14
    v_accvgpr_write_b32 a39, v15
    v_perm_b32 v12, v97, v96, s61
    v_perm_b32 v13, v99, v98, s61
    v_perm_b32 v14, v101, v100, s61
    v_perm_b32 v15, v103, v102, s61
    v_accvgpr_write_b32 a44, v12
    v_accvgpr_write_b32 a45, v13
    v_accvgpr_write_b32 a46, v14
    v_accvgpr_write_b32 a47, v15
    ds_read2st64_b32 v[96:97], v11 offset0:0 offset1:1
    ds_read2st64_b32 v[98:99], v11 offset0:8 offset1:9
    ds_read2st64_b32 v[100:101], v11 offset0:2 offset1:3
    ds_read2st64_b32 v[102:103], v11 offset0:10 offset1:11
    s_waitcnt lgkmcnt(11)
    v_perm_b32 v252, v105, v104, s60
    s_waitcnt lgkmcnt(10)
    v_perm_b32 v253, v107, v106, s60
    s_waitcnt lgkmcnt(9)
    v_perm_b32 v254, v109, v108, s60
    s_waitcnt lgkmcnt(8)
    v_perm_b32 v255, v111, v110, s60
    v_perm_b32 v12, v105, v104, s61
    v_perm_b32 v13, v107, v106, s61
    v_perm_b32 v14, v109, v108, s61
    v_perm_b32 v15, v111, v110, s61
    v_accvgpr_write_b32 a196, v12
    v_accvgpr_write_b32 a197, v13
    v_accvgpr_write_b32 a198, v14
    v_accvgpr_write_b32 a199, v15
    s_waitcnt lgkmcnt(7)
    v_perm_b32 v12, v113, v112, s60
    s_waitcnt lgkmcnt(6)
    v_perm_b32 v13, v115, v114, s60
    s_waitcnt lgkmcnt(5)
    v_perm_b32 v14, v117, v116, s60
    s_waitcnt lgkmcnt(4)
    v_perm_b32 v15, v119, v118, s60
    v_accvgpr_write_b32 a220, v12
    v_accvgpr_write_b32 a221, v13
    v_accvgpr_write_b32 a222, v14
    v_accvgpr_write_b32 a223, v15
    v_perm_b32 v12, v113, v112, s61
    v_perm_b32 v13, v115, v114, s61
    v_perm_b32 v14, v117, v116, s61
    v_perm_b32 v15, v119, v118, s61
    v_accvgpr_write_b32 a228, v12
    v_accvgpr_write_b32 a229, v13
    v_accvgpr_write_b32 a230, v14
    v_accvgpr_write_b32 a231, v15
    s_waitcnt lgkmcnt(3)
    v_perm_b32 v12, v97, v96, s60
    s_waitcnt lgkmcnt(2)
    v_perm_b32 v13, v99, v98, s60
    s_waitcnt lgkmcnt(1)
    v_perm_b32 v14, v101, v100, s60
    s_waitcnt lgkmcnt(0)
    v_perm_b32 v15, v103, v102, s60
    v_accvgpr_write_b32 a252, v12
    v_accvgpr_write_b32 a253, v13
    v_accvgpr_write_b32 a254, v14
    v_accvgpr_write_b32 a255, v15
    v_perm_b32 v132, v97, v96, s61
    v_perm_b32 v133, v99, v98, s61
    v_perm_b32 v134, v101, v100, s61
    v_perm_b32 v135, v103, v102, s61
    s_waitcnt vmcnt(32)
    s_barrier
    s_xor_b32 s62, s29, 1
    s_lshl_b32 s62, s62, 15
    s_add_u32 s63, s62, 128
    buffer_load_dwordx2 v[64:65], v7, s[24:27], s63 offen
    s_add_u32 s63, s62, 1152
    buffer_load_dwordx2 v[66:67], v7, s[24:27], s63 offen
    s_add_u32 s63, s62, 2176
    buffer_load_dwordx2 v[68:69], v7, s[24:27], s63 offen
    s_add_u32 s63, s62, 3200
    buffer_load_dwordx2 v[70:71], v7, s[24:27], s63 offen
    s_add_u32 s63, s62, 16512
    buffer_load_dwordx2 v[72:73], v7, s[24:27], s63 offen
    s_add_u32 s63, s62, 17536
    buffer_load_dwordx2 v[74:75], v7, s[24:27], s63 offen
    s_add_u32 s63, s62, 18560
    buffer_load_dwordx2 v[76:77], v7, s[24:27], s63 offen
    s_add_u32 s63, s62, 19584
    buffer_load_dwordx2 v[78:79], v7, s[24:27], s63 offen
    v_add_u32 v8, 0xfffe0000, v8
    v_add_u32 v9, 0xfffe0000, v9
    v_add_u32 v10, 0xfffe0000, v10
    v_add_u32 v11, 0xfffe0000, v11
    ds_read2st64_b32 v[96:97], v8 offset0:0 offset1:1
    ds_read2st64_b32 v[98:99], v8 offset0:8 offset1:9
    ds_read2st64_b32 v[100:101], v8 offset0:2 offset1:3
    ds_read2st64_b32 v[102:103], v8 offset0:10 offset1:11
    ds_read2st64_b32 v[104:105], v9 offset0:0 offset1:1
    ds_read2st64_b32 v[106:107], v9 offset0:8 offset1:9
    ds_read2st64_b32 v[108:109], v9 offset0:2 offset1:3
    ds_read2st64_b32 v[110:111], v9 offset0:10 offset1:11
    ds_read2st64_b32 v[112:113], v10 offset0:0 offset1:1
    ds_read2st64_b32 v[114:115], v10 offset0:8 offset1:9
    ds_read2st64_b32 v[116:117], v10 offset0:2 offset1:3
    ds_read2st64_b32 v[118:119], v10 offset0:10 offset1:11
    s_waitcnt lgkmcnt(11)
    v_perm_b32 v12, v97, v96, s60
    s_waitcnt lgkmcnt(10)
    v_perm_b32 v13, v99, v98, s60
    s_waitcnt lgkmcnt(9)
    v_perm_b32 v14, v101, v100, s60
    s_waitcnt lgkmcnt(8)
    v_perm_b32 v15, v103, v102, s60
    v_accvgpr_write_b32 a48, v12
    v_accvgpr_write_b32 a49, v13
    v_accvgpr_write_b32 a50, v14
    v_accvgpr_write_b32 a51, v15
    v_perm_b32 v12, v97, v96, s61
    v_perm_b32 v13, v99, v98, s61
    v_perm_b32 v14, v101, v100, s61
    v_perm_b32 v15, v103, v102, s61
    v_accvgpr_write_b32 a56, v12
    v_accvgpr_write_b32 a57, v13
    v_accvgpr_write_b32 a58, v14
    v_accvgpr_write_b32 a59, v15
    ds_read2st64_b32 v[96:97], v11 offset0:0 offset1:1
    ds_read2st64_b32 v[98:99], v11 offset0:8 offset1:9
    ds_read2st64_b32 v[100:101], v11 offset0:2 offset1:3
    ds_read2st64_b32 v[102:103], v11 offset0:10 offset1:11
    s_waitcnt lgkmcnt(11)
    v_perm_b32 v12, v105, v104, s60
    s_waitcnt lgkmcnt(10)
    v_perm_b32 v13, v107, v106, s60
    s_waitcnt lgkmcnt(9)
    v_perm_b32 v14, v109, v108, s60
    s_waitcnt lgkmcnt(8)
    v_perm_b32 v15, v111, v110, s60
    v_accvgpr_write_b32 a200, v12
    v_accvgpr_write_b32 a201, v13
    v_accvgpr_write_b32 a202, v14
    v_accvgpr_write_b32 a203, v15
    v_perm_b32 v12, v105, v104, s61
    v_perm_b32 v13, v107, v106, s61
    v_perm_b32 v14, v109, v108, s61
    v_perm_b32 v15, v111, v110, s61
    v_accvgpr_write_b32 a208, v12
    v_accvgpr_write_b32 a209, v13
    v_accvgpr_write_b32 a210, v14
    v_accvgpr_write_b32 a211, v15
    s_waitcnt lgkmcnt(7)
    v_perm_b32 v12, v113, v112, s60
    s_waitcnt lgkmcnt(6)
    v_perm_b32 v13, v115, v114, s60
    s_waitcnt lgkmcnt(5)
    v_perm_b32 v14, v117, v116, s60
    s_waitcnt lgkmcnt(4)
    v_perm_b32 v15, v119, v118, s60
    v_accvgpr_write_b32 a232, v12
    v_accvgpr_write_b32 a233, v13
    v_accvgpr_write_b32 a234, v14
    v_accvgpr_write_b32 a235, v15
    v_perm_b32 v12, v113, v112, s61
    v_perm_b32 v13, v115, v114, s61
    v_perm_b32 v14, v117, v116, s61
    v_perm_b32 v15, v119, v118, s61
    v_accvgpr_write_b32 a240, v12
    v_accvgpr_write_b32 a241, v13
    v_accvgpr_write_b32 a242, v14
    v_accvgpr_write_b32 a243, v15
    s_waitcnt lgkmcnt(3)
    v_perm_b32 v136, v97, v96, s60
    s_waitcnt lgkmcnt(2)
    v_perm_b32 v137, v99, v98, s60
    s_waitcnt lgkmcnt(1)
    v_perm_b32 v138, v101, v100, s60
    s_waitcnt lgkmcnt(0)
    v_perm_b32 v139, v103, v102, s60
    v_perm_b32 v144, v97, v96, s61
    v_perm_b32 v145, v99, v98, s61
    v_perm_b32 v146, v101, v100, s61
    v_perm_b32 v147, v103, v102, s61
    s_waitcnt vmcnt(32)
    s_barrier
    s_xor_b32 s62, s29, 2
    s_lshl_b32 s62, s62, 15
    s_add_u32 s63, s62, 0
    buffer_load_dwordx2 v[80:81], v7, s[24:27], s63 offen
    s_add_u32 s63, s62, 1024
    buffer_load_dwordx2 v[82:83], v7, s[24:27], s63 offen
    s_add_u32 s63, s62, 2048
    buffer_load_dwordx2 v[84:85], v7, s[24:27], s63 offen
    s_add_u32 s63, s62, 3072
    buffer_load_dwordx2 v[86:87], v7, s[24:27], s63 offen
    s_add_u32 s63, s62, 16384
    buffer_load_dwordx2 v[88:89], v7, s[24:27], s63 offen
    s_add_u32 s63, s62, 17408
    buffer_load_dwordx2 v[90:91], v7, s[24:27], s63 offen
    s_add_u32 s63, s62, 18432
    buffer_load_dwordx2 v[92:93], v7, s[24:27], s63 offen
    s_add_u32 s63, s62, 19456
    buffer_load_dwordx2 v[94:95], v7, s[24:27], s63 offen
    ds_read2st64_b32 v[96:97], v8 offset0:128 offset1:129
    ds_read2st64_b32 v[98:99], v8 offset0:136 offset1:137
    ds_read2st64_b32 v[100:101], v8 offset0:130 offset1:131
    ds_read2st64_b32 v[102:103], v8 offset0:138 offset1:139
    ds_read2st64_b32 v[104:105], v9 offset0:128 offset1:129
    ds_read2st64_b32 v[106:107], v9 offset0:136 offset1:137
    ds_read2st64_b32 v[108:109], v9 offset0:130 offset1:131
    ds_read2st64_b32 v[110:111], v9 offset0:138 offset1:139
    ds_read2st64_b32 v[112:113], v10 offset0:128 offset1:129
    ds_read2st64_b32 v[114:115], v10 offset0:136 offset1:137
    ds_read2st64_b32 v[116:117], v10 offset0:130 offset1:131
    ds_read2st64_b32 v[118:119], v10 offset0:138 offset1:139
    s_waitcnt lgkmcnt(11)
    v_perm_b32 v12, v97, v96, s60
    s_waitcnt lgkmcnt(10)
    v_perm_b32 v13, v99, v98, s60
    s_waitcnt lgkmcnt(9)
    v_perm_b32 v14, v101, v100, s60
    s_waitcnt lgkmcnt(8)
    v_perm_b32 v15, v103, v102, s60
    v_accvgpr_write_b32 a52, v12
    v_accvgpr_write_b32 a53, v13
    v_accvgpr_write_b32 a54, v14
    v_accvgpr_write_b32 a55, v15
    v_perm_b32 v12, v97, v96, s61
    v_perm_b32 v13, v99, v98, s61
    v_perm_b32 v14, v101, v100, s61
    v_perm_b32 v15, v103, v102, s61
    v_accvgpr_write_b32 a60, v12
    v_accvgpr_write_b32 a61, v13
    v_accvgpr_write_b32 a62, v14
    v_accvgpr_write_b32 a63, v15
    ds_read2st64_b32 v[96:97], v11 offset0:128 offset1:129
    ds_read2st64_b32 v[98:99], v11 offset0:136 offset1:137
    ds_read2st64_b32 v[100:101], v11 offset0:130 offset1:131
    ds_read2st64_b32 v[102:103], v11 offset0:138 offset1:139
    s_waitcnt lgkmcnt(11)
    v_perm_b32 v12, v105, v104, s60
    s_waitcnt lgkmcnt(10)
    v_perm_b32 v13, v107, v106, s60
    s_waitcnt lgkmcnt(9)
    v_perm_b32 v14, v109, v108, s60
    s_waitcnt lgkmcnt(8)
    v_perm_b32 v15, v111, v110, s60
    v_accvgpr_write_b32 a204, v12
    v_accvgpr_write_b32 a205, v13
    v_accvgpr_write_b32 a206, v14
    v_accvgpr_write_b32 a207, v15
    v_perm_b32 v12, v105, v104, s61
    v_perm_b32 v13, v107, v106, s61
    v_perm_b32 v14, v109, v108, s61
    v_perm_b32 v15, v111, v110, s61
    v_accvgpr_write_b32 a212, v12
    v_accvgpr_write_b32 a213, v13
    v_accvgpr_write_b32 a214, v14
    v_accvgpr_write_b32 a215, v15
    s_waitcnt lgkmcnt(7)
    v_perm_b32 v12, v113, v112, s60
    s_waitcnt lgkmcnt(6)
    v_perm_b32 v13, v115, v114, s60
    s_waitcnt lgkmcnt(5)
    v_perm_b32 v14, v117, v116, s60
    s_waitcnt lgkmcnt(4)
    v_perm_b32 v15, v119, v118, s60
    v_accvgpr_write_b32 a236, v12
    v_accvgpr_write_b32 a237, v13
    v_accvgpr_write_b32 a238, v14
    v_accvgpr_write_b32 a239, v15
    v_perm_b32 v12, v113, v112, s61
    v_perm_b32 v13, v115, v114, s61
    v_perm_b32 v14, v117, v116, s61
    v_perm_b32 v15, v119, v118, s61
    v_accvgpr_write_b32 a244, v12
    v_accvgpr_write_b32 a245, v13
    v_accvgpr_write_b32 a246, v14
    v_accvgpr_write_b32 a247, v15
    s_waitcnt lgkmcnt(3)
    v_perm_b32 v140, v97, v96, s60
    s_waitcnt lgkmcnt(2)
    v_perm_b32 v141, v99, v98, s60
    s_waitcnt lgkmcnt(1)
    v_perm_b32 v142, v101, v100, s60
    s_waitcnt lgkmcnt(0)
    v_perm_b32 v143, v103, v102, s60
    v_perm_b32 v148, v97, v96, s61
    v_perm_b32 v149, v99, v98, s61
    v_perm_b32 v150, v101, v100, s61
    v_perm_b32 v151, v103, v102, s61
    s_barrier
    v_mov_b32 v12, v5
    ds_write_b128 v122, v[152:155] offset:0
    ds_write_b128 v122, v[156:159] offset:1024
    ds_write_b128 v122, v[160:163] offset:2048
    ds_write_b128 v122, v[164:167] offset:3072
    ds_write_b128 v122, v[168:171] offset:4096
    ds_write_b128 v122, v[172:175] offset:5120
    ds_write_b128 v122, v[176:179] offset:6144
    ds_write_b128 v122, v[180:183] offset:7168
    ds_write_b128 v122, v[184:187] offset:8192
    ds_write_b128 v122, v[188:191] offset:9216
    ds_write_b128 v122, v[192:195] offset:10240
    ds_write_b128 v122, v[196:199] offset:11264
    ds_write_b128 v122, v[200:203] offset:12288
    ds_write_b128 v122, v[204:207] offset:13312
    ds_write_b128 v122, v[208:211] offset:14336
    ds_write_b128 v122, v[212:215] offset:15360
    ds_write_b128 v122, v[216:219] offset:16384
    ds_write_b128 v122, v[220:223] offset:17408
    ds_write_b128 v122, v[224:227] offset:18432
    ds_write_b128 v122, v[228:231] offset:19456
    ds_write_b128 v122, v[232:235] offset:20480
    ds_write_b128 v122, v[236:239] offset:21504
    ds_write_b128 v122, v[240:243] offset:22528
    ds_write_b128 v122, v[244:247] offset:23552
    ds_write_b128 v122, v[248:251] offset:24576
    ds_write_b128 v122, v[252:255] offset:25600
    s_waitcnt lgkmcnt(0)
    s_waitcnt vmcnt(32)
    v_perm_b32 v96, v18, v16, s60
    v_perm_b32 v97, v19, v17, s60
    v_perm_b32 v98, v22, v20, s60
    v_perm_b32 v99, v23, v21, s60
    v_perm_b32 v100, v26, v24, s60
    v_perm_b32 v101, v27, v25, s60
    v_perm_b32 v102, v30, v28, s60
    v_perm_b32 v103, v31, v29, s60
    ds_write_b128 v122, v[96:99] offset:26624
    ds_write_b128 v122, v[100:103] offset:27648
    s_waitcnt lgkmcnt(0)
    v_perm_b32 v104, v18, v16, s61
    v_perm_b32 v105, v19, v17, s61
    v_perm_b32 v106, v22, v20, s61
    v_perm_b32 v107, v23, v21, s61
    v_perm_b32 v108, v26, v24, s61
    v_perm_b32 v109, v27, v25, s61
    v_perm_b32 v110, v30, v28, s61
    v_perm_b32 v111, v31, v29, s61
    ds_write_b128 v122, v[104:107] offset:28672
    ds_write_b128 v122, v[108:111] offset:29696
    s_waitcnt lgkmcnt(0)
    s_xor_b32 s62, s29, 2
    s_lshl_b32 s62, s62, 15
    s_add_u32 s63, s62, 128
    buffer_load_dwordx2 v[16:17], v7, s[24:27], s63 offen
    s_add_u32 s63, s62, 1152
    buffer_load_dwordx2 v[18:19], v7, s[24:27], s63 offen
    s_add_u32 s63, s62, 2176
    buffer_load_dwordx2 v[20:21], v7, s[24:27], s63 offen
    s_add_u32 s63, s62, 3200
    buffer_load_dwordx2 v[22:23], v7, s[24:27], s63 offen
    s_add_u32 s63, s62, 16512
    buffer_load_dwordx2 v[24:25], v7, s[24:27], s63 offen
    s_add_u32 s63, s62, 17536
    buffer_load_dwordx2 v[26:27], v7, s[24:27], s63 offen
    s_add_u32 s63, s62, 18560
    buffer_load_dwordx2 v[28:29], v7, s[24:27], s63 offen
    s_add_u32 s63, s62, 19584
    buffer_load_dwordx2 v[30:31], v7, s[24:27], s63 offen
    s_waitcnt vmcnt(32)
    v_perm_b32 v96, v34, v32, s60
    v_perm_b32 v97, v35, v33, s60
    v_perm_b32 v98, v38, v36, s60
    v_perm_b32 v99, v39, v37, s60
    v_perm_b32 v100, v42, v40, s60
    v_perm_b32 v101, v43, v41, s60
    v_perm_b32 v102, v46, v44, s60
    v_perm_b32 v103, v47, v45, s60
    ds_write_b128 v122, v[96:99] offset:30720
    ds_write_b128 v122, v[100:103] offset:31744
    s_waitcnt lgkmcnt(0)
    v_perm_b32 v152, v34, v32, s61
    v_perm_b32 v153, v35, v33, s61
    v_perm_b32 v154, v38, v36, s61
    v_perm_b32 v155, v39, v37, s61
    v_perm_b32 v156, v42, v40, s61
    v_perm_b32 v157, v43, v41, s61
    v_perm_b32 v158, v46, v44, s61
    v_perm_b32 v159, v47, v45, s61
    s_xor_b32 s62, s29, 3
    s_lshl_b32 s62, s62, 15
    s_add_u32 s63, s62, 0
    buffer_load_dwordx2 v[32:33], v7, s[24:27], s63 offen
    s_add_u32 s63, s62, 1024
    buffer_load_dwordx2 v[34:35], v7, s[24:27], s63 offen
    s_add_u32 s63, s62, 2048
    buffer_load_dwordx2 v[36:37], v7, s[24:27], s63 offen
    s_add_u32 s63, s62, 3072
    buffer_load_dwordx2 v[38:39], v7, s[24:27], s63 offen
    s_add_u32 s63, s62, 16384
    buffer_load_dwordx2 v[40:41], v7, s[24:27], s63 offen
    s_add_u32 s63, s62, 17408
    buffer_load_dwordx2 v[42:43], v7, s[24:27], s63 offen
    s_add_u32 s63, s62, 18432
    buffer_load_dwordx2 v[44:45], v7, s[24:27], s63 offen
    s_add_u32 s63, s62, 19456
    buffer_load_dwordx2 v[46:47], v7, s[24:27], s63 offen
    s_waitcnt vmcnt(32)
    v_perm_b32 v160, v50, v48, s60
    v_perm_b32 v161, v51, v49, s60
    v_perm_b32 v162, v54, v52, s60
    v_perm_b32 v163, v55, v53, s60
    v_perm_b32 v164, v58, v56, s60
    v_perm_b32 v165, v59, v57, s60
    v_perm_b32 v166, v62, v60, s60
    v_perm_b32 v167, v63, v61, s60
    v_perm_b32 v168, v50, v48, s61
    v_perm_b32 v169, v51, v49, s61
    v_perm_b32 v170, v54, v52, s61
    v_perm_b32 v171, v55, v53, s61
    v_perm_b32 v172, v58, v56, s61
    v_perm_b32 v173, v59, v57, s61
    v_perm_b32 v174, v62, v60, s61
    v_perm_b32 v175, v63, v61, s61
    s_xor_b32 s62, s29, 3
    s_lshl_b32 s62, s62, 15
    s_add_u32 s63, s62, 128
    buffer_load_dwordx2 v[48:49], v7, s[24:27], s63 offen
    s_add_u32 s63, s62, 1152
    buffer_load_dwordx2 v[50:51], v7, s[24:27], s63 offen
    s_add_u32 s63, s62, 2176
    buffer_load_dwordx2 v[52:53], v7, s[24:27], s63 offen
    s_add_u32 s63, s62, 3200
    buffer_load_dwordx2 v[54:55], v7, s[24:27], s63 offen
    s_add_u32 s63, s62, 16512
    buffer_load_dwordx2 v[56:57], v7, s[24:27], s63 offen
    s_add_u32 s63, s62, 17536
    buffer_load_dwordx2 v[58:59], v7, s[24:27], s63 offen
    s_add_u32 s63, s62, 18560
    buffer_load_dwordx2 v[60:61], v7, s[24:27], s63 offen
    s_add_u32 s63, s62, 19584
    buffer_load_dwordx2 v[62:63], v7, s[24:27], s63 offen
    s_waitcnt vmcnt(32)
    v_perm_b32 v176, v66, v64, s60
    v_perm_b32 v177, v67, v65, s60
    v_perm_b32 v178, v70, v68, s60
    v_perm_b32 v179, v71, v69, s60
    v_perm_b32 v180, v74, v72, s60
    v_perm_b32 v181, v75, v73, s60
    v_perm_b32 v182, v78, v76, s60
    v_perm_b32 v183, v79, v77, s60
    v_perm_b32 v184, v66, v64, s61
    v_perm_b32 v185, v67, v65, s61
    v_perm_b32 v186, v70, v68, s61
    v_perm_b32 v187, v71, v69, s61
    v_perm_b32 v188, v74, v72, s61
    v_perm_b32 v189, v75, v73, s61
    v_perm_b32 v190, v78, v76, s61
    v_perm_b32 v191, v79, v77, s61
    s_waitcnt vmcnt(24)
    v_perm_b32 v192, v82, v80, s60
    v_perm_b32 v193, v83, v81, s60
    v_perm_b32 v194, v86, v84, s60
    v_perm_b32 v195, v87, v85, s60
    v_perm_b32 v196, v90, v88, s60
    v_perm_b32 v197, v91, v89, s60
    v_perm_b32 v198, v94, v92, s60
    v_perm_b32 v199, v95, v93, s60
    v_perm_b32 v200, v82, v80, s61
    v_perm_b32 v201, v83, v81, s61
    v_perm_b32 v202, v86, v84, s61
    v_perm_b32 v203, v87, v85, s61
    v_perm_b32 v204, v90, v88, s61
    v_perm_b32 v205, v91, v89, s61
    v_perm_b32 v206, v94, v92, s61
    v_perm_b32 v207, v95, v93, s61
    s_waitcnt vmcnt(16)
    v_perm_b32 v208, v18, v16, s60
    v_perm_b32 v209, v19, v17, s60
    v_perm_b32 v210, v22, v20, s60
    v_perm_b32 v211, v23, v21, s60
    v_perm_b32 v212, v26, v24, s60
    v_perm_b32 v213, v27, v25, s60
    v_perm_b32 v214, v30, v28, s60
    v_perm_b32 v215, v31, v29, s60
    v_perm_b32 v216, v18, v16, s61
    v_perm_b32 v217, v19, v17, s61
    v_perm_b32 v218, v22, v20, s61
    v_perm_b32 v219, v23, v21, s61
    v_perm_b32 v220, v26, v24, s61
    v_perm_b32 v221, v27, v25, s61
    v_perm_b32 v222, v30, v28, s61
    v_perm_b32 v223, v31, v29, s61
    s_waitcnt vmcnt(8)
    v_perm_b32 v224, v34, v32, s60
    v_perm_b32 v225, v35, v33, s60
    v_perm_b32 v226, v38, v36, s60
    v_perm_b32 v227, v39, v37, s60
    v_perm_b32 v228, v42, v40, s60
    v_perm_b32 v229, v43, v41, s60
    v_perm_b32 v230, v46, v44, s60
    v_perm_b32 v231, v47, v45, s60
    v_perm_b32 v232, v34, v32, s61
    v_perm_b32 v233, v35, v33, s61
    v_perm_b32 v234, v38, v36, s61
    v_perm_b32 v235, v39, v37, s61
    v_perm_b32 v236, v42, v40, s61
    v_perm_b32 v237, v43, v41, s61
    v_perm_b32 v238, v46, v44, s61
    v_perm_b32 v239, v47, v45, s61
    s_waitcnt vmcnt(0)
    v_perm_b32 v240, v50, v48, s60
    v_perm_b32 v241, v51, v49, s60
    v_perm_b32 v242, v54, v52, s60
    v_perm_b32 v243, v55, v53, s60
    v_perm_b32 v244, v58, v56, s60
    v_perm_b32 v245, v59, v57, s60
    v_perm_b32 v246, v62, v60, s60
    v_perm_b32 v247, v63, v61, s60
    v_perm_b32 v248, v50, v48, s61
    v_perm_b32 v249, v51, v49, s61
    v_perm_b32 v250, v54, v52, s61
    v_perm_b32 v251, v55, v53, s61
    v_perm_b32 v252, v58, v56, s61
    v_perm_b32 v253, v59, v57, s61
    v_perm_b32 v254, v62, v60, s61
    v_perm_b32 v255, v63, v61, s61
    s_lshl_b32 s37, s28, 13
    s_lshl_b32 s38, s29, 11
    s_add_u32 s37, s37, s38
    s_add_u32 s65, s37, 0x1000000
    s_add_u32 s66, s37, 0x1fff800
    s_lshr_b32 s37, s37, 1
    s_add_u32 s67, s37, 0x3100000
    s_add_u32 s68, s37, 0x3a00000
    s_lshl_b32 s73, s38, 1
    s_mov_b32 m0, s73
    s_mov_b32 s64, 0
    s_mov_b32 s72, 0x4400000
    s_mov_b32 s57, 400000
L_ch_wp1:
    buffer_load_dword v8, off, s[4:7], s95 sc1
    s_waitcnt vmcnt(0)
    v_readfirstlane_b32 s56, v8
    s_and_b32 s99, s56, 0xff
    s_bfe_u32 s97, s56, 0x80010
    s_min_u32 s99, s99, s97
    s_bfe_u32 s97, s56, 0x80008
    s_lshr_b32 s56, s56, 24
    s_min_u32 s97, s97, s56
    s_lshl_b32 s99, s99, 1
    s_lshl1_add_u32 s97, s97, 1
    s_min_u32 s99, s99, s97
    s_cmp_gt_u32 s99, 1
    s_cbranch_scc1 L_ch_wp1_ok
    s_sleep 1
    s_sub_u32 s57, s57, 1
    s_cbranch_scc0 L_ch_wp1
L_ch_wp1_ok:
    s_sub_u32 s67, s67, 131072
    s_sub_u32 s68, s68, 131072
    buffer_load_dwordx4 v121, s[4:7], s65 offen offset:0 sc1 lds
    buffer_load_dwordx4 v121, s[4:7], s65 offen offset:1024 sc1 lds
    buffer_load_dwordx4 v121, s[4:7], s66 offen offset:2048 sc1 lds
    buffer_load_dwordx4 v121, s[4:7], s66 offen offset:3072 sc1 lds
    s_add_u32 s65, s65, 262144
    s_add_u32 s66, s66, 262144
    v_lshlrev_b32 v4, 10, v12
    v_lshl_add_u32 v4, v3, 5, v4
    v_and_b32 v5, 2, v2
    v_cmp_ne_u32 s[12:13], 0, v5
    v_lshl_add_u32 v4, v5, 3, v4
    s_lshl_b32 s37, s29, 8
    buffer_load_dwordx4 v[8:11], v4, s[40:43], s37 offen
    buffer_load_dwordx4 v[12:15], v4, s[40:43], s37 offen offset:128
    s_add_u32 s37, s74, 0x4400000
    buffer_load_dwordx4 v[16:19], v121, s[4:7], s37 offen offset:0
    buffer_load_dwordx4 v[16:19], v121, s[4:7], s37 offen offset:1024
    s_add_u32 s37, s74, 0x4440000
    buffer_load_dwordx4 v[16:19], v121, s[4:7], s37 offen offset:0
    buffer_load_dwordx4 v[16:19], v121, s[4:7], s37 offen offset:1024
    s_lshl_b32 s38, s29, 11
    s_add_u32 s37, s38, 0x4500000
    buffer_load_dwordx4 v[16:19], v121, s[4:7], s37 offen offset:0
    buffer_load_dwordx4 v[16:19], v121, s[4:7], s37 offen offset:1024
    s_add_u32 s37, s38, 0x4502000
    buffer_load_dwordx4 v[16:19], v121, s[4:7], s37 offen offset:0
    buffer_load_dwordx4 v[16:19], v121, s[4:7], s37 offen offset:1024
    s_add_u32 s37, s38, 0x4504000
    buffer_load_dwordx4 v[16:19], v121, s[4:7], s37 offen offset:0
    buffer_load_dwordx4 v[16:19], v121, s[4:7], s37 offen offset:1024
    s_add_u32 s37, s38, 0x4506000
    buffer_load_dwordx4 v[16:19], v121, s[4:7], s37 offen offset:0
    buffer_load_dwordx4 v[16:19], v121, s[4:7], s37 offen offset:1024
    s_mov_b32 s75, 200000
L_ch_rdy:
    buffer_load_dword v16, off, s[8:11], 0 offset:32 sc1
    s_waitcnt vmcnt(0)
    v_readfirstlane_b32 s37, v16
    s_and_b32 s38, s37, 0xffff
    s_sub_u32 s75, s75, 1
    s_cselect_b32 s38, 32, s38
    s_cmp_lt_u32 s38, 32
    s_cbranch_scc1 L_ch_rdy
    s_barrier
    v_mov_b32 v0, v8
    v_mov_b32 v1, v9
    v_mov_b32 v2, v10
    v_mov_b32 v3, v11
    v_mov_b32 v4, v12
    v_mov_b32 v5, v13
    v_mov_b32 v6, v14
    v_mov_b32 v7, v15
    s_lshl_b32 s76, s29, 11
    s_add_u32 s77, s76, 16384
    s_mov_b32 s78, 0x3e0293ee
    s_lshl_b32 s79, s29, 6
    s_lshr_b32 s38, s29, 1
    s_lshl_b32 s38, s38, 7
    s_and_b32 s94, s29, 1
    s_add_u32 s38, s38, s94
    s_lshl_b32 s38, s38, 5
    s_add_u32 s38, s38, 27648
    s_mov_b32 s94, 100000
    v_and_b32 v126, 0x3df, v121
    v_add_u32 v126, s38, v126
    s_not_b64 s[14:15], s[12:13]
    s_mov_b32 s101, 0
    s_mov_b32 s39, 0
    s_lshr_b32 s37, s37, 16
    s_cmp_lg_u32 s37, 0
    s_cbranch_scc1 L_slow_entry
    v_add_u32 v28, s77, v121
    v_add_u32 v26, s73, v121
    v_add_u32 v24, s79, v124
    ds_read_b128 v[112:115], v24 offset:256
    ds_read_b128 v[56:59], v121 offset:0
    ds_read_b128 v[60:63], v121 offset:1024
    ds_read_b128 v[64:67], v121 offset:4096
    ds_read_b128 v[68:71], v121 offset:5120
    ds_read_b128 v[72:75], v121 offset:8192
    ds_read_b128 v[76:79], v121 offset:9216
    ds_read_b128 v[80:83], v121 offset:12288
    ds_read_b128 v[84:87], v121 offset:13312
    ds_read_b128 v[104:107], v26 offset:2048
    ds_read_b128 v[108:111], v26 offset:3072
    ds_read_b128 v[8:11], v122 offset:0
    ds_read_b128 v[12:15], v122 offset:1024
    ds_read_b128 v[16:19], v122 offset:2048
    ds_read_b128 v[20:23], v122 offset:3072
    ds_read_b128 v[88:91], v122 offset:4096
    ds_read_b128 v[92:95], v122 offset:5120
    ds_read_b128 v[96:99], v122 offset:6144
    ds_read_b128 v[100:103], v122 offset:7168
    v_mov_b32 v116, v48
    v_mov_b32 v117, v49
    v_mov_b32 v118, v50
    v_mov_b32 v119, v51
    v_mov_b32 v48, 0
    v_mov_b32 v49, 0
    v_mov_b32 v50, 0
    v_mov_b32 v51, 0
    v_mov_b32 v52, 0
    v_mov_b32 v53, 0
    v_mov_b32 v54, 0
    v_mov_b32 v55, 0
    v_xor_b32 v29, 2048, v28
    v_xor_b32 v30, 4096, v28
    v_xor_b32 v31, 6144, v28
    v_mov_b32 v27, s101
    s_waitcnt lgkmcnt(0)
    s_barrier
    v_mov_b32 v44, -1
    v_mov_b32 v45, -1
    v_mov_b32 v46, -1
    v_mov_b32 v47, -1
    ds_write_b128 v126, v[44:47]
    v_mov_b32 v32, 0
    v_mov_b32 v33, 0
    v_mov_b32 v34, 0
    v_mov_b32 v35, 0
    v_mov_b32 v36, 0
    v_mov_b32 v37, 0
    v_mov_b32 v38, 0
    v_mov_b32 v39, 0
    v_mov_b32 v40, 0
    v_mov_b32 v41, 0
    v_mov_b32 v42, 0
    v_mov_b32 v43, 0
    v_mov_b32 v44, 0
    v_mov_b32 v45, 0
    v_mov_b32 v46, 0
    v_mov_b32 v47, 0
    s_mov_b64 s[56:57], 0
    s_branch Lf_ent
.p2align 6
    s_nop 0
    s_nop 0
    s_nop 0
    s_nop 0
    s_nop 0
    s_nop 0
    s_nop 0
    s_nop 0
Lf_p2:
    s_mov_b64 exec, s[58:59]
    buffer_load_dwordx4 v[0:3], v121, s[4:7], s69 offen sc1
    s_mov_b64 exec, s[62:63]
    buffer_load_dwordx4 v[4:7], v121, s[4:7], s69 offen offset:1024 sc1
    s_mov_b64 exec, -1
    s_sub_u32 s75, s75, 1
    s_cselect_b64 s[56:57], 0, -1
    s_waitcnt vmcnt(2)
    v_cmp_eq_u32 s[58:59], -1, v0
    v_cmp_eq_u32 s[62:63], -1, v4
Lf_ent:
    s_or_b64 vcc, s[58:59], s[62:63]
    s_and_b64 vcc, vcc, s[56:57]
    s_cbranch_vccnz Lf_p2
Lf_body:
    v_smfmac_f32_16x16x64_bf16 v[32:35], v[0:3], v[8:15], v120
    ds_write_b128 v28, v[0:3]
    ds_write_b128 v28, v[4:7] offset:1024
    v_smfmac_f32_16x16x64_bf16 v[36:39], v[0:3], v[16:23], v120
    buffer_load_dwordx4 v121, s[4:7], s65 offen offset:0 sc1 lds
    v_smfmac_f32_16x16x64_bf16 v[32:35], v[4:7], v[88:95], v120
    buffer_load_dwordx4 v121, s[4:7], s65 offen offset:1024 sc1 lds
    v_smfmac_f32_16x16x64_bf16 v[36:39], v[4:7], v[96:103], v120
    buffer_load_dwordx4 v121, s[4:7], s66 offen offset:2048 sc1 lds
    buffer_load_dwordx4 v121, s[4:7], s66 offen offset:3072 sc1 lds
    v_smfmac_f32_16x16x64_bf16 v[40:43], v[0:3], a[0:7], v120
    buffer_load_dword v127, off, s[4:7], s95 sc1
    s_waitcnt lgkmcnt(0)
    s_barrier
    ds_read_b128 v[8:11], v29 offset:0
    ds_read_b128 v[12:15], v29 offset:1024
    v_smfmac_f32_16x16x64_bf16 v[44:47], v[0:3], a[8:15], v120
    ds_read_b128 v[16:19], v30 offset:0
    ds_read_b128 v[20:23], v30 offset:1024
    s_mov_b64 exec, 1
    buffer_store_byte v27, off, s[4:7], s98 sc1
    s_mov_b64 exec, -1
    v_smfmac_f32_16x16x64_bf16 v[40:43], v[4:7], a[16:23], v120
    ds_read_b128 v[24:27], v31 offset:0
    ds_read_b128 v[28:31], v31 offset:1024
    v_smfmac_f32_16x16x64_bf16 v[44:47], v[4:7], a[24:31], v120
    buffer_store_dwordx4 v[112:115], v121, s[4:7], s67 offen sc1
    v_smfmac_f32_16x16x64_bf16 v[48:51], v[0:3], a[32:39], v120
    buffer_store_dwordx4 v[116:119], v121, s[4:7], s68 offen sc1
    ds_read_b128 v[88:91], v122 offset:8192
    v_smfmac_f32_16x16x64_bf16 v[52:55], v[0:3], a[40:47], v120
    ds_read_b128 v[92:95], v122 offset:9216
    v_smfmac_f32_16x16x64_bf16 v[48:51], v[4:7], a[48:55], v120
    ds_read_b128 v[96:99], v122 offset:10240
    v_smfmac_f32_16x16x64_bf16 v[52:55], v[4:7], a[56:63], v120
    ds_read_b128 v[100:103], v122 offset:11264
    s_waitcnt lgkmcnt(9)
    v_smfmac_f32_16x16x64_bf16 v[32:35], v[8:11], a[64:71], v120
    ds_read_b128 v[112:115], v122 offset:12288
    v_smfmac_f32_16x16x64_bf16 v[36:39], v[8:11], a[72:79], v120
    ds_read_b128 v[116:119], v122 offset:13312
    s_waitcnt lgkmcnt(10)
    v_smfmac_f32_16x16x64_bf16 v[32:35], v[12:15], a[80:87], v120
    v_smfmac_f32_16x16x64_bf16 v[36:39], v[12:15], a[88:95], v120
    s_waitcnt lgkmcnt(4)
    v_smfmac_f32_16x16x64_bf16 v[32:35], v[16:19], v[88:95], v120
    ds_read_b128 v[88:91], v122 offset:14336
    v_smfmac_f32_16x16x64_bf16 v[36:39], v[16:19], a[96:103], v120
    ds_read_b128 v[92:95], v122 offset:15360
    s_waitcnt lgkmcnt(4)
    v_smfmac_f32_16x16x64_bf16 v[32:35], v[20:23], v[96:103], v120
    ds_read_b128 v[96:99], v122 offset:16384
    v_smfmac_f32_16x16x64_bf16 v[36:39], v[20:23], a[104:111], v120
    ds_read_b128 v[100:103], v122 offset:17408
    s_waitcnt lgkmcnt(4)
    v_smfmac_f32_16x16x64_bf16 v[32:35], v[24:27], v[112:119], v120
    ds_read_b128 v[112:115], v122 offset:18432
    v_smfmac_f32_16x16x64_bf16 v[36:39], v[24:27], a[112:119], v120
    ds_read_b128 v[116:119], v122 offset:19456
    v_smfmac_f32_16x16x64_bf16 v[32:35], v[28:31], a[120:127], v120
    s_add_u32 s65, s65, 262144
    s_add_u32 s66, s66, 262144
    v_smfmac_f32_16x16x64_bf16 v[36:39], v[28:31], a[128:135], v120
    s_waitcnt lgkmcnt(4)
    v_smfmac_f32_16x16x64_bf16 v[40:43], v[8:11], v[88:95], v120
    ds_read_b128 v[88:91], v122 offset:20480
    v_smfmac_f32_16x16x64_bf16 v[44:47], v[8:11], a[136:143], v120
    ds_read_b128 v[92:95], v122 offset:21504
    s_waitcnt lgkmcnt(4)
    v_add_f32 v32, v32, v34
    v_smfmac_f32_16x16x64_bf16 v[40:43], v[12:15], v[96:103], v120
    ds_read_b128 v[96:99], v122 offset:22528
    v_add_f32 v33, v33, v35
    v_smfmac_f32_16x16x64_bf16 v[44:47], v[12:15], a[144:151], v120
    ds_read_b128 v[100:103], v122 offset:23552
    s_waitcnt lgkmcnt(4)
    v_add_f32 v36, v36, v38
    v_smfmac_f32_16x16x64_bf16 v[40:43], v[16:19], v[112:119], v120
    ds_read_b128 v[112:115], v122 offset:24576
    v_add_f32 v37, v37, v39
    v_smfmac_f32_16x16x64_bf16 v[44:47], v[16:19], a[152:159], v120
    ds_read_b128 v[116:119], v122 offset:25600
    v_cvt_pk_bf16_f32 v32, v32, v36
    v_smfmac_f32_16x16x64_bf16 v[40:43], v[20:23], a[160:167], v120
    s_add_u32 s67, s67, 131072
    s_add_u32 s68, s68, 131072
    v_cvt_pk_bf16_f32 v33, v33, v37
    v_smfmac_f32_16x16x64_bf16 v[44:47], v[20:23], a[168:175], v120
    ds_write2_b32 v123, v32, v33 offset0:0 offset1:144
    s_waitcnt lgkmcnt(5)
    v_mov_b32 v39, 0
    v_smfmac_f32_16x16x64_bf16 v[40:43], v[24:27], v[88:95], v120
    v_mov_b32 v38, 0
    v_smfmac_f32_16x16x64_bf16 v[44:47], v[24:27], a[176:183], v120
    s_waitcnt lgkmcnt(3)
    v_mov_b32 v37, 0
    v_smfmac_f32_16x16x64_bf16 v[40:43], v[28:31], v[96:103], v120
    v_mov_b32 v36, 0
    v_smfmac_f32_16x16x64_bf16 v[44:47], v[28:31], a[184:191], v120
    s_waitcnt lgkmcnt(0)
    s_barrier
    ds_read_b128 v[88:91], v124 offset:0
    ds_read_b128 v[92:95], v124 offset:64
    v_mov_b32 v35, 0
    v_smfmac_f32_16x16x64_bf16 v[48:51], v[8:11], v[112:119], v120
    ds_read_b128 v[96:99], v124 offset:128
    ds_read_b128 v[100:103], v124 offset:192
    v_add_f32 v40, v40, v42
    v_smfmac_f32_16x16x64_bf16 v[52:55], v[8:11], a[192:199], v120
    v_add_f32 v41, v41, v43
    v_smfmac_f32_16x16x64_bf16 v[48:51], v[12:15], a[200:207], v120
    v_add_f32 v44, v44, v46
    v_smfmac_f32_16x16x64_bf16 v[52:55], v[12:15], a[208:215], v120
    v_add_f32 v45, v45, v47
    v_smfmac_f32_16x16x64_bf16 v[48:51], v[16:19], a[216:223], v120
    ds_read_b128 v[8:11], v122 offset:26624
    v_cvt_pk_bf16_f32 v40, v40, v44
    v_smfmac_f32_16x16x64_bf16 v[52:55], v[16:19], a[224:231], v120
    s_waitcnt vmcnt(8)
    ds_read_b128 v[12:15], v122 offset:27648
    s_waitcnt lgkmcnt(5)
    v_cvt_pk_bf16_f32 v41, v41, v45
    v_mfma_f32_16x16x32_bf16 v[112:115], v[56:59], v[88:91], 0
    ds_write2_b32 v123, v40, v41 offset0:64 offset1:208
    v_xor_b32 v47, 4128, v124
    v_cndmask_b32 v47, v124, v47, s[12:13]
    v_mfma_f32_16x16x32_bf16 v[116:119], v[72:75], v[88:91], 0
    s_waitcnt lgkmcnt(5)
    v_mov_b32 v34, 0
    v_mov_b32 v33, 0
    v_mfma_f32_16x16x32_bf16 v[112:115], v[60:63], v[92:95], v[112:115]
    v_mov_b32 v16, 0x3f803f80
    v_mov_b32 v17, 0x3f803f80
    v_mfma_f32_16x16x32_bf16 v[116:119], v[76:79], v[92:95], v[116:119]
    s_waitcnt lgkmcnt(4)
    v_mov_b32 v3, 0
    v_mov_b32 v7, 0
    v_mfma_f32_16x16x32_bf16 v[112:115], v[64:67], v[96:99], v[112:115]
    v_mov_b32 v32, 0
    v_mov_b32 v18, 0x3f803f80
    v_mfma_f32_16x16x32_bf16 v[116:119], v[80:83], v[96:99], v[116:119]
    s_waitcnt lgkmcnt(0)
    s_barrier
    ds_read_b128 v[56:59], v47 offset:256
    ds_read_b128 v[60:63], v47 offset:320
    v_mov_b32 v0, 0
    v_mov_b32 v4, 0
    v_mfma_f32_16x16x32_bf16 v[112:115], v[68:71], v[100:103], v[112:115]
    ds_read_b128 v[72:75], v47 offset:384
    ds_read_b128 v[76:79], v47 offset:448
    v_mov_b32 v1, 0
    v_mov_b32 v5, 0
    v_mfma_f32_16x16x32_bf16 v[116:119], v[84:87], v[100:103], v[116:119]
    v_mov_b32 v2, 0
    v_mov_b32 v6, 0
    v_smfmac_f32_16x16x64_bf16 v[48:51], v[20:23], a[232:239], v120
    ds_read_b128 v[64:67], v122 offset:28672
    v_mov_b32 v19, 0x3f803f80
    v_smfmac_f32_16x16x64_bf16 v[52:55], v[20:23], a[240:247], v120
    ds_read_b128 v[68:71], v122 offset:29696
    v_cndmask_b32 v112, v112, v116, s[12:13]
    v_smfmac_f32_16x16x64_bf16 v[48:51], v[24:27], a[248:255], v120
    ds_read_b128 v[80:83], v122 offset:30720
    v_cndmask_b32 v113, v113, v117, s[12:13]
    v_smfmac_f32_16x16x64_bf16 v[52:55], v[24:27], v[128:135], v120
    ds_read_b128 v[84:87], v122 offset:31744
    v_cndmask_b32 v114, v114, v118, s[12:13]
    v_smfmac_f32_16x16x64_bf16 v[48:51], v[28:31], v[136:143], v120
    v_cndmask_b32 v115, v115, v119, s[12:13]
    v_smfmac_f32_16x16x64_bf16 v[52:55], v[28:31], v[144:151], v120
    s_waitcnt lgkmcnt(7)
    v_max3_f32 v46, v112, v113, v114
    v_mfma_f32_16x16x32_bf16 v[40:43], v[56:59], v[88:91], 0
    s_waitcnt lgkmcnt(6)
    v_max_f32 v46, v46, v115
    v_cvt_pk_bf16_f32 v48, v48, v49
    v_mfma_f32_16x16x32_bf16 v[40:43], v[60:63], v[92:95], v[40:43]
    s_waitcnt lgkmcnt(5)
    v_max_f32_dpp v47, v46, v46 quad_perm:[2,3,0,1] row_mask:0xf bank_mask:0xf
    v_max_f32_dpp v46, v46, v46 quad_perm:[2,3,0,1] row_mask:0xf bank_mask:0xf
    v_mfma_f32_16x16x32_bf16 v[40:43], v[72:75], v[96:99], v[40:43]
    s_waitcnt lgkmcnt(4)
    v_cvt_pk_bf16_f32 v49, v50, v51
    v_permlane32_swap_b32 v46, v47
    v_mfma_f32_16x16x32_bf16 v[40:43], v[76:79], v[100:103], v[40:43]
    v_cvt_pk_bf16_f32 v50, v52, v53
    v_cvt_pk_bf16_f32 v51, v54, v55
    v_max_f32 v46, v46, v47
    v_mov_b32 v44, 0x3f003f00
    v_mov_b32 v45, 0x3f003f00
    s_cmp_eq_u32 s64, 63
    s_cbranch_scc1 Lf_end
    s_nop 0
    v_max3_f32 v46, v46, v40, v41
    v_max3_f32 v47, v46, v42, v43
    v_max3_f32 v46, v46, v42, v43
    s_nop 1
    v_permlane16_swap_b32 v46, v47
    v_max_f32 v46, v46, v47
    v_mul_f32 v47, s78, v46
    v_fma_f32 v40, v40, s78, -v47
    v_fma_f32 v41, v41, s78, -v47
    v_exp_f32 v40, v40
    v_exp_f32 v41, v41
    v_fma_f32 v112, v112, s78, -v47
    v_fma_f32 v113, v113, s78, -v47
    v_cvt_pk_bf16_f32 v42, v40, v41
    v_cvt_pk_bf16_f32 v43, v40, v41
    v_fma_f32 v114, v114, s78, -v47
    v_fma_f32 v115, v115, s78, -v47
    v_mfma_f32_16x16x16_bf16 v[20:23], v[44:45], v[42:43], 0
    v_exp_f32 v112, v112
    v_mfma_f32_16x16x16_bf16 v[24:27], v[48:49], v[42:43], 0
    v_exp_f32 v113, v113
    v_mfma_f32_16x16x16_bf16 v[28:31], v[50:51], v[42:43], 0
    v_exp_f32 v114, v114
    v_exp_f32 v115, v115
    v_cvt_pk_bf16_f32 v116, v112, v113
    v_cvt_pk_bf16_f32 v117, v114, v115
    s_nop 0
    v_mov_b32_dpp v112, v116 quad_perm:[0,1,0,1] row_mask:0xf bank_mask:0xf
    v_mov_b32_dpp v114, v116 quad_perm:[2,3,2,3] row_mask:0xf bank_mask:0xf
    v_mov_b32_dpp v113, v117 quad_perm:[0,1,0,1] row_mask:0xf bank_mask:0xf
    v_mov_b32_dpp v115, v117 quad_perm:[2,3,2,3] row_mask:0xf bank_mask:0xf
    s_nop 1
    v_mfma_f32_16x16x32_bf16 v[20:23], v[16:19], v[112:115], v[20:23]
    v_xor_b32 v101, 32, v126
    v_xor_b32 v102, 4096, v126
    v_mfma_f32_16x16x32_bf16 v[24:27], v[104:107], v[112:115], v[24:27]
    v_xor_b32 v103, 4128, v126
    v_mfma_f32_16x16x32_bf16 v[28:31], v[108:111], v[112:115], v[28:31]
    v_rcp_f32 v20, v20
    s_nop 2
    v_mul_f32 v24, v24, v20
    v_mul_f32 v25, v25, v20
    v_mul_f32 v26, v26, v20
    v_mul_f32 v27, v27, v20
    v_mul_f32 v28, v28, v20
    v_mul_f32 v29, v29, v20
    v_mul_f32 v30, v30, v20
    v_mul_f32 v31, v31, v20
    v_cvt_pk_bf16_f32 v24, v24, v28
    v_cvt_pk_bf16_f32 v25, v25, v29
    v_cvt_pk_bf16_f32 v26, v26, v30
    v_cvt_pk_bf16_f32 v27, v27, v31
    s_mov_b64 exec, s[14:15]
    ds_write_b128 v126, v[24:27]
    s_mov_b64 exec, -1
    s_waitcnt vmcnt(3) lgkmcnt(1)
    s_barrier
Lf_wo:
    v_smfmac_f32_16x16x64_bf16 v[0:3], v[24:27], v[8:15], v120
    ds_read_b128 v[88:91], v101
    ds_read_b128 v[92:95], v102
    ds_read_b128 v[96:99], v103
    v_smfmac_f32_16x16x64_bf16 v[4:7], v[24:27], v[64:71], v120
    v_smfmac_f32_16x16x64_bf16 v[32:35], v[24:27], v[80:87], v120
    v_smfmac_f32_16x16x64_bf16 v[36:39], v[24:27], v[152:159], v120
    s_waitcnt lgkmcnt(2)
    v_smfmac_f32_16x16x64_bf16 v[0:3], v[88:91], v[160:167], v120
    v_max3_u32 v17, v88, v89, v90
    v_smfmac_f32_16x16x64_bf16 v[4:7], v[88:91], v[168:175], v120
    s_waitcnt lgkmcnt(1)
    v_readfirstlane_b32 s56, v127
    v_smfmac_f32_16x16x64_bf16 v[0:3], v[92:95], v[192:199], v120
    v_max3_u32 v17, v17, v91, v92
    v_smfmac_f32_16x16x64_bf16 v[4:7], v[92:95], v[200:207], v120
    s_waitcnt lgkmcnt(0)
    v_max3_u32 v17, v17, v93, v94
    v_smfmac_f32_16x16x64_bf16 v[0:3], v[96:99], v[224:231], v120
    v_max3_u32 v17, v17, v95, v96
    v_smfmac_f32_16x16x64_bf16 v[4:7], v[96:99], v[232:239], v120
    v_max3_u32 v17, v17, v97, v98
    v_max_u32 v17, v17, v99
    v_smfmac_f32_16x16x64_bf16 v[32:35], v[88:91], v[176:183], v120
    v_cvt_pk_bf16_f32 v40, v0, v1
    v_cmp_eq_u32 vcc, -1, v17
    v_smfmac_f32_16x16x64_bf16 v[36:39], v[88:91], v[184:191], v120
    v_and_or_b32 v40, v40, -2, s39
    v_cvt_pk_bf16_f32 v41, v2, v3
    v_smfmac_f32_16x16x64_bf16 v[32:35], v[92:95], v[208:215], v120
    s_add_u32 s58, s72, s74
    s_mov_b32 s75, 20000
    v_cvt_pk_bf16_f32 v42, v4, v5
    v_smfmac_f32_16x16x64_bf16 v[32:35], v[96:99], v[240:247], v120
    s_add_u32 s37, s72, 0x8000
    s_cbranch_vccnz Lf_redo
Lf_cont:
    v_cvt_pk_bf16_f32 v43, v6, v7
    v_smfmac_f32_16x16x64_bf16 v[36:39], v[92:95], v[216:223], v120
    buffer_store_dwordx4 v[40:43], v125, s[4:7], s72 offen
    v_smfmac_f32_16x16x64_bf16 v[36:39], v[96:99], v[248:255], v120
    v_cvt_pk_bf16_f32 v44, v32, v33
    v_and_or_b32 v44, v44, -2, s39
    v_cvt_pk_bf16_f32 v45, v34, v35
    s_nop 2
    v_cvt_pk_bf16_f32 v46, v36, v37
    v_cvt_pk_bf16_f32 v47, v38, v39
    buffer_store_dwordx4 v[44:47], v125, s[4:7], s37 offen
    v_add_u32 v28, s77, v121
    v_add_u32 v26, s73, v121
    v_add_u32 v24, s79, v124
    ds_read_b128 v[112:115], v24 offset:256
    ds_read_b128 v[56:59], v121 offset:0
    ds_read_b128 v[60:63], v121 offset:1024
    ds_read_b128 v[64:67], v121 offset:4096
    s_mov_b64 s[60:61], -1
    s_mov_b64 s[62:63], -1
    v_mov_b32 v4, 0x3f80
    v_mov_b32 v5, 0x3f800000
    v_cndmask_b32 v4, v4, v5, s[54:55]
    v_cndmask_b32 v0, 0, v4, s[46:47]
    v_cndmask_b32 v1, 0, v4, s[48:49]
    v_cndmask_b32 v2, 0, v4, s[50:51]
    v_cndmask_b32 v3, 0, v4, s[52:53]
    v_mov_b32 v35, -1
    ds_read_b128 v[68:71], v121 offset:5120
    ds_read_b128 v[72:75], v121 offset:8192
    ds_read_b128 v[76:79], v121 offset:9216
    ds_read_b128 v[80:83], v121 offset:12288
    v_bfe_u32 v32, v121, 8, 1
    v_and_b32 v127, 0x20, v121
    v_lshl_add_u32 v127, v32, 4, v127
    v_bfe_u32 v32, v121, 4, 1
    v_lshl_add_u32 v127, v32, 3, v127
    v_bfe_u32 v32, v121, 9, 1
    v_lshl_add_u32 v127, v32, 2, v127
    s_mov_b32 s101, s64
    s_add_u32 s64, s64, 1
    s_and_b32 s37, s64, 3
    ds_read_b128 v[84:87], v121 offset:13312
    ds_read_b128 v[104:107], v26 offset:2048
    ds_read_b128 v[108:111], v26 offset:3072
    ds_read_b128 v[8:11], v122 offset:0
    s_lshl_b32 s37, s37, 13
    s_add_u32 s70, s37, 0x4500000
    s_add_u32 s69, s70, s76
    s_add_u32 s70, s70, s100
    s_xor_b32 s71, s70, 0x4000
    s_and_b32 s99, s56, 0xff
    s_bfe_u32 s97, s56, 0x80010
    s_min_u32 s99, s99, s97
    s_bfe_u32 s97, s56, 0x80008
    s_lshr_b32 s56, s56, 24
    ds_read_b128 v[12:15], v122 offset:1024
    ds_read_b128 v[16:19], v122 offset:2048
    ds_read_b128 v[20:23], v122 offset:3072
    ds_read_b128 v[88:91], v122 offset:4096
    s_min_u32 s97, s97, s56
    s_lshl_b32 s99, s99, 1
    s_lshl1_add_u32 s97, s97, 1
    s_min_u32 s99, s99, s97
    v_mov_b32 v116, v48
    v_mov_b32 v117, v49
    v_mov_b32 v118, v50
    v_mov_b32 v119, v51
    v_mov_b32 v48, 0
    v_mov_b32 v49, 0
    ds_read_b128 v[92:95], v122 offset:5120
    ds_read_b128 v[96:99], v122 offset:6144
    ds_read_b128 v[100:103], v122 offset:7168
    v_mov_b32 v50, 0
    v_mov_b32 v51, 0
    v_mov_b32 v52, 0
    v_mov_b32 v53, 0
    v_mov_b32 v54, 0
    v_mov_b32 v55, 0
    v_xor_b32 v29, 2048, v28
    v_xor_b32 v30, 4096, v28
    v_xor_b32 v31, 6144, v28
    v_mov_b32 v27, s101
    buffer_load_dwordx4 v[40:43], v121, s[4:7], s58 offen sc1
    buffer_load_dwordx4 v[44:47], v121, s[4:7], s58 offen offset:1024 sc1
    s_waitcnt lgkmcnt(0)
    s_barrier
    s_branch Lf_p1w
.p2align 5
    s_nop 0
    s_nop 0
    s_nop 0
    s_nop 0
    s_nop 0
    s_nop 0
Lf_p1:
    s_mov_b64 exec, s[60:61]
    buffer_load_dwordx4 v[40:43], v121, s[4:7], s58 offen sc1
    s_mov_b64 exec, s[62:63]
    buffer_load_dwordx4 v[44:47], v121, s[4:7], s58 offen offset:1024 sc1
    s_mov_b64 exec, -1
Lf_p1w:
    s_sub_u32 s75, s75, 1
    s_cselect_b64 s[56:57], 0, -1
    s_waitcnt vmcnt(0)
    v_and_b32 v32, 1, v40
    v_and_b32 v33, 1, v44
    v_mfma_f32_16x16x32_bf16 v[4:7], v[0:3], v[40:43], 0
    v_cmp_ne_u32 s[60:61], s39, v32
    v_cmp_ne_u32 s[62:63], s39, v33
    v_mfma_f32_16x16x32_bf16 v[4:7], v[0:3], v[44:47], v[4:7]
    s_or_b64 vcc, s[60:61], s[62:63]
    s_and_b64 vcc, vcc, s[56:57]
    s_cbranch_vccnz Lf_p1
    s_nop 4
    v_add_f32_dpp v4, v4, v4 row_ror:4 row_mask:0xf bank_mask:0xf
    v_add_f32_dpp v5, v5, v5 row_ror:4 row_mask:0xf bank_mask:0xf
    s_nop 0
    v_add_f32_dpp v4, v4, v4 row_ror:8 row_mask:0xf bank_mask:0xf
    v_add_f32_dpp v5, v5, v5 row_ror:8 row_mask:0xf bank_mask:0xf
    s_mov_b64 exec, s[44:45]
    v_cvt_pk_bf16_f32 v34, v4, v5
    buffer_store_dword v34, v127, s[4:7], s70 offen
    buffer_store_dword v35, v127, s[4:7], s71 offen
    s_mov_b64 exec, -1
    s_xor_b32 s72, s72, 0x40000
    s_lshr_b32 s39, s64, 1
    s_and_b32 s39, s39, 1
    s_mov_b32 s75, 20000
    s_mov_b64 s[58:59], -1
    s_mov_b64 s[62:63], -1
    v_mov_b32 v44, -1
    v_mov_b32 v45, -1
    v_mov_b32 v46, -1
    v_mov_b32 v47, -1
    ds_write_b128 v126, v[44:47]
    v_mov_b32 v32, 0
    v_mov_b32 v33, 0
    v_mov_b32 v34, 0
    v_mov_b32 v35, 0
    v_mov_b32 v36, 0
    v_mov_b32 v37, 0
    v_mov_b32 v38, 0
    v_mov_b32 v39, 0
    v_mov_b32 v40, 0
    v_mov_b32 v41, 0
    v_mov_b32 v42, 0
    v_mov_b32 v43, 0
    v_mov_b32 v44, 0
    v_mov_b32 v45, 0
    v_mov_b32 v46, 0
    v_mov_b32 v47, 0
    s_add_u32 s96, s64, 1
    s_min_u32 s96, s96, 63
    s_cmp_le_u32 s99, s96
    s_cbranch_scc1 Lf_wp
Lf_wpr:
    s_nop 15
    buffer_load_dwordx4 v[0:3], v121, s[4:7], s69 offen sc1
    buffer_load_dwordx4 v[4:7], v121, s[4:7], s69 offen offset:1024 sc1
    s_nop 15
    s_nop 15
    s_branch Lf_p2
Lf_redo:
    s_sub_u32 s94, s94, 1
    s_cbranch_scc1 Lf_cont
    s_nop 15
    v_mov_b32 v0, 0
    v_mov_b32 v1, 0
    v_mov_b32 v2, 0
    v_mov_b32 v3, 0
    v_mov_b32 v4, 0
    v_mov_b32 v5, 0
    v_mov_b32 v6, 0
    v_mov_b32 v7, 0
    v_mov_b32 v32, 0
    v_mov_b32 v33, 0
    v_mov_b32 v34, 0
    v_mov_b32 v35, 0
    v_mov_b32 v36, 0
    v_mov_b32 v37, 0
    v_mov_b32 v38, 0
    v_mov_b32 v39, 0
    s_nop 1
    s_branch Lf_wo
Lf_end:
    v_add_u32 v24, s79, v124
    ds_read_b128 v[112:115], v24 offset:256
    buffer_store_dwordx4 v[48:51], v121, s[4:7], s68 offen sc1
    s_waitcnt lgkmcnt(0)
    buffer_store_dwordx4 v[112:115], v121, s[4:7], s67 offen sc1
    s_waitcnt vmcnt(0)
    s_barrier
    s_cmp_lg_u32 s29, 0
    s_cbranch_scc1 Lf_fin
    s_mov_b64 exec, 1
    v_mov_b32 v8, 64
    buffer_store_byte v8, off, s[4:7], s98 sc1
    s_waitcnt vmcnt(0)
Lf_fin:
    s_endpgm
Lf_wp:
    s_mov_b32 s57, 400000
Lf_wp2:
    buffer_load_dword v127, off, s[4:7], s95 sc1
    s_waitcnt vmcnt(0)
    v_readfirstlane_b32 s56, v127
    s_and_b32 s99, s56, 0xff
    s_bfe_u32 s97, s56, 0x80010
    s_min_u32 s99, s99, s97
    s_bfe_u32 s97, s56, 0x80008
    s_lshr_b32 s56, s56, 24
    s_min_u32 s97, s97, s56
    s_lshl_b32 s99, s99, 1
    s_lshl1_add_u32 s97, s97, 1
    s_min_u32 s99, s99, s97
    s_cmp_gt_u32 s99, s96
    s_cbranch_scc1 Lf_wpr
    s_sub_u32 s57, s57, 1
    s_cbranch_scc0 Lf_wp2
    s_branch Lf_wpr
L_slow_entry:
    v_add_u32 v28, s77, v121
    v_add_u32 v26, s73, v121
    v_add_u32 v24, s79, v124
    ds_read_b128 v[112:115], v24 offset:256
    ds_read_b128 v[56:59], v121 offset:0
    ds_read_b128 v[60:63], v121 offset:1024
    ds_read_b128 v[64:67], v121 offset:4096
    ds_read_b128 v[68:71], v121 offset:5120
    ds_read_b128 v[72:75], v121 offset:8192
    ds_read_b128 v[76:79], v121 offset:9216
    ds_read_b128 v[80:83], v121 offset:12288
    ds_read_b128 v[84:87], v121 offset:13312
    ds_read_b128 v[104:107], v26 offset:2048
    ds_read_b128 v[108:111], v26 offset:3072
    ds_read_b128 v[8:11], v122 offset:0
    ds_read_b128 v[12:15], v122 offset:1024
    ds_read_b128 v[16:19], v122 offset:2048
    ds_read_b128 v[20:23], v122 offset:3072
    ds_read_b128 v[88:91], v122 offset:4096
    ds_read_b128 v[92:95], v122 offset:5120
    ds_read_b128 v[96:99], v122 offset:6144
    ds_read_b128 v[100:103], v122 offset:7168
    v_mov_b32 v116, v48
    v_mov_b32 v117, v49
    v_mov_b32 v118, v50
    v_mov_b32 v119, v51
    v_mov_b32 v48, 0
    v_mov_b32 v49, 0
    v_mov_b32 v50, 0
    v_mov_b32 v51, 0
    v_mov_b32 v52, 0
    v_mov_b32 v53, 0
    v_mov_b32 v54, 0
    v_mov_b32 v55, 0
    v_xor_b32 v29, 2048, v28
    v_xor_b32 v30, 4096, v28
    v_xor_b32 v31, 6144, v28
    v_mov_b32 v27, s101
    s_waitcnt lgkmcnt(0)
    s_barrier
    v_mov_b32 v44, -1
    v_mov_b32 v45, -1
    v_mov_b32 v46, -1
    v_mov_b32 v47, -1
    ds_write_b128 v126, v[44:47]
    v_mov_b32 v32, 0
    v_mov_b32 v33, 0
    v_mov_b32 v34, 0
    v_mov_b32 v35, 0
    v_mov_b32 v36, 0
    v_mov_b32 v37, 0
    v_mov_b32 v38, 0
    v_mov_b32 v39, 0
    v_mov_b32 v40, 0
    v_mov_b32 v41, 0
    v_mov_b32 v42, 0
    v_mov_b32 v43, 0
    v_mov_b32 v44, 0
    v_mov_b32 v45, 0
    v_mov_b32 v46, 0
    v_mov_b32 v47, 0
    s_mov_b64 s[56:57], 0
    s_branch Ls_ent
.p2align 6
    s_nop 0
    s_nop 0
    s_nop 0
    s_nop 0
    s_nop 0
    s_nop 0
    s_nop 0
    s_nop 0
Ls_p2:
    s_mov_b64 exec, s[58:59]
    buffer_load_dwordx4 v[0:3], v121, s[4:7], s69 offen sc1
    s_mov_b64 exec, s[62:63]
    buffer_load_dwordx4 v[4:7], v121, s[4:7], s69 offen offset:1024 sc1
    s_mov_b64 exec, -1
    s_sub_u32 s75, s75, 1
    s_cselect_b64 s[56:57], 0, -1
    s_waitcnt vmcnt(2)
    v_cmp_eq_u32 s[58:59], -1, v0
    v_cmp_eq_u32 s[62:63], -1, v4
Ls_ent:
    s_or_b64 vcc, s[58:59], s[62:63]
    s_and_b64 vcc, vcc, s[56:57]
    s_cbranch_vccnz Ls_p2
Ls_body:
    v_smfmac_f32_16x16x64_bf16 v[32:35], v[0:3], v[8:15], v120
    ds_write_b128 v28, v[0:3]
    ds_write_b128 v28, v[4:7] offset:1024
    v_smfmac_f32_16x16x64_bf16 v[36:39], v[0:3], v[16:23], v120
    buffer_load_dwordx4 v121, s[4:7], s65 offen offset:0 sc1 lds
    v_smfmac_f32_16x16x64_bf16 v[32:35], v[4:7], v[88:95], v120
    buffer_load_dwordx4 v121, s[4:7], s65 offen offset:1024 sc1 lds
    v_smfmac_f32_16x16x64_bf16 v[36:39], v[4:7], v[96:103], v120
    buffer_load_dwordx4 v121, s[4:7], s66 offen offset:2048 sc1 lds
    buffer_load_dwordx4 v121, s[4:7], s66 offen offset:3072 sc1 lds
    v_smfmac_f32_16x16x64_bf16 v[40:43], v[0:3], a[0:7], v120
    buffer_load_dword v127, off, s[4:7], s95 sc1
    s_waitcnt lgkmcnt(0)
    s_barrier
    ds_read_b128 v[8:11], v29 offset:0
    ds_read_b128 v[12:15], v29 offset:1024
    v_smfmac_f32_16x16x64_bf16 v[44:47], v[0:3], a[8:15], v120
    ds_read_b128 v[16:19], v30 offset:0
    ds_read_b128 v[20:23], v30 offset:1024
    s_mov_b64 exec, 1
    buffer_store_byte v27, off, s[4:7], s98 sc1
    s_mov_b64 exec, -1
    v_smfmac_f32_16x16x64_bf16 v[40:43], v[4:7], a[16:23], v120
    ds_read_b128 v[24:27], v31 offset:0
    ds_read_b128 v[28:31], v31 offset:1024
    v_smfmac_f32_16x16x64_bf16 v[44:47], v[4:7], a[24:31], v120
    buffer_store_dwordx4 v[112:115], v121, s[4:7], s67 offen sc1
    v_smfmac_f32_16x16x64_bf16 v[48:51], v[0:3], a[32:39], v120
    buffer_store_dwordx4 v[116:119], v121, s[4:7], s68 offen sc1
    ds_read_b128 v[88:91], v122 offset:8192
    v_smfmac_f32_16x16x64_bf16 v[52:55], v[0:3], a[40:47], v120
    ds_read_b128 v[92:95], v122 offset:9216
    v_smfmac_f32_16x16x64_bf16 v[48:51], v[4:7], a[48:55], v120
    ds_read_b128 v[96:99], v122 offset:10240
    v_smfmac_f32_16x16x64_bf16 v[52:55], v[4:7], a[56:63], v120
    ds_read_b128 v[100:103], v122 offset:11264
    s_waitcnt lgkmcnt(9)
    v_smfmac_f32_16x16x64_bf16 v[32:35], v[8:11], a[64:71], v120
    ds_read_b128 v[112:115], v122 offset:12288
    v_smfmac_f32_16x16x64_bf16 v[36:39], v[8:11], a[72:79], v120
    ds_read_b128 v[116:119], v122 offset:13312
    s_waitcnt lgkmcnt(10)
    v_smfmac_f32_16x16x64_bf16 v[32:35], v[12:15], a[80:87], v120
    v_smfmac_f32_16x16x64_bf16 v[36:39], v[12:15], a[88:95], v120
    s_waitcnt lgkmcnt(4)
    v_smfmac_f32_16x16x64_bf16 v[32:35], v[16:19], v[88:95], v120
    ds_read_b128 v[88:91], v122 offset:14336
    v_smfmac_f32_16x16x64_bf16 v[36:39], v[16:19], a[96:103], v120
    ds_read_b128 v[92:95], v122 offset:15360
    s_waitcnt lgkmcnt(4)
    v_smfmac_f32_16x16x64_bf16 v[32:35], v[20:23], v[96:103], v120
    ds_read_b128 v[96:99], v122 offset:16384
    v_smfmac_f32_16x16x64_bf16 v[36:39], v[20:23], a[104:111], v120
    ds_read_b128 v[100:103], v122 offset:17408
    s_waitcnt lgkmcnt(4)
    v_smfmac_f32_16x16x64_bf16 v[32:35], v[24:27], v[112:119], v120
    ds_read_b128 v[112:115], v122 offset:18432
    v_smfmac_f32_16x16x64_bf16 v[36:39], v[24:27], a[112:119], v120
    ds_read_b128 v[116:119], v122 offset:19456
    v_smfmac_f32_16x16x64_bf16 v[32:35], v[28:31], a[120:127], v120
    s_add_u32 s65, s65, 262144
    s_add_u32 s66, s66, 262144
    v_smfmac_f32_16x16x64_bf16 v[36:39], v[28:31], a[128:135], v120
    s_waitcnt lgkmcnt(4)
    v_smfmac_f32_16x16x64_bf16 v[40:43], v[8:11], v[88:95], v120
    ds_read_b128 v[88:91], v122 offset:20480
    v_smfmac_f32_16x16x64_bf16 v[44:47], v[8:11], a[136:143], v120
    ds_read_b128 v[92:95], v122 offset:21504
    s_waitcnt lgkmcnt(4)
    v_add_f32 v32, v32, v34
    v_smfmac_f32_16x16x64_bf16 v[40:43], v[12:15], v[96:103], v120
    ds_read_b128 v[96:99], v122 offset:22528
    v_add_f32 v33, v33, v35
    v_smfmac_f32_16x16x64_bf16 v[44:47], v[12:15], a[144:151], v120
    ds_read_b128 v[100:103], v122 offset:23552
    s_waitcnt lgkmcnt(4)
    v_add_f32 v36, v36, v38
    v_smfmac_f32_16x16x64_bf16 v[40:43], v[16:19], v[112:119], v120
    ds_read_b128 v[112:115], v122 offset:24576
    v_add_f32 v37, v37, v39
    v_smfmac_f32_16x16x64_bf16 v[44:47], v[16:19], a[152:159], v120
    ds_read_b128 v[116:119], v122 offset:25600
    v_cvt_pk_bf16_f32 v32, v32, v36
    v_smfmac_f32_16x16x64_bf16 v[40:43], v[20:23], a[160:167], v120
    s_add_u32 s67, s67, 131072
    s_add_u32 s68, s68, 131072
    v_cvt_pk_bf16_f32 v33, v33, v37
    v_smfmac_f32_16x16x64_bf16 v[44:47], v[20:23], a[168:175], v120
    ds_write2_b32 v123, v32, v33 offset0:0 offset1:144
    s_waitcnt lgkmcnt(5)
    v_mov_b32 v39, 0
    v_smfmac_f32_16x16x64_bf16 v[40:43], v[24:27], v[88:95], v120
    v_mov_b32 v38, 0
    v_smfmac_f32_16x16x64_bf16 v[44:47], v[24:27], a[176:183], v120
    s_waitcnt lgkmcnt(3)
    v_mov_b32 v37, 0
    v_smfmac_f32_16x16x64_bf16 v[40:43], v[28:31], v[96:103], v120
    v_mov_b32 v36, 0
    v_smfmac_f32_16x16x64_bf16 v[44:47], v[28:31], a[184:191], v120
    s_waitcnt lgkmcnt(0)
    s_barrier
    ds_read_b128 v[88:91], v124 offset:0
    ds_read_b128 v[92:95], v124 offset:64
    v_mov_b32 v35, 0
    v_smfmac_f32_16x16x64_bf16 v[48:51], v[8:11], v[112:119], v120
    ds_read_b128 v[96:99], v124 offset:128
    ds_read_b128 v[100:103], v124 offset:192
    v_add_f32 v40, v40, v42
    v_smfmac_f32_16x16x64_bf16 v[52:55], v[8:11], a[192:199], v120
    v_add_f32 v41, v41, v43
    v_smfmac_f32_16x16x64_bf16 v[48:51], v[12:15], a[200:207], v120
    v_add_f32 v44, v44, v46
    v_smfmac_f32_16x16x64_bf16 v[52:55], v[12:15], a[208:215], v120
    v_add_f32 v45, v45, v47
    v_smfmac_f32_16x16x64_bf16 v[48:51], v[16:19], a[216:223], v120
    ds_read_b128 v[8:11], v122 offset:26624
    v_cvt_pk_bf16_f32 v40, v40, v44
    v_smfmac_f32_16x16x64_bf16 v[52:55], v[16:19], a[224:231], v120
    s_waitcnt vmcnt(8)
    ds_read_b128 v[12:15], v122 offset:27648
    s_waitcnt lgkmcnt(5)
    v_cvt_pk_bf16_f32 v41, v41, v45
    v_mfma_f32_16x16x32_bf16 v[112:115], v[56:59], v[88:91], 0
    ds_write2_b32 v123, v40, v41 offset0:64 offset1:208
    v_xor_b32 v47, 4128, v124
    v_cndmask_b32 v47, v124, v47, s[12:13]
    v_mfma_f32_16x16x32_bf16 v[116:119], v[72:75], v[88:91], 0
    s_waitcnt lgkmcnt(5)
    v_mov_b32 v34, 0
    v_mov_b32 v33, 0
    v_mfma_f32_16x16x32_bf16 v[112:115], v[60:63], v[92:95], v[112:115]
    v_mov_b32 v16, 0x3f803f80
    v_mov_b32 v17, 0x3f803f80
    v_mfma_f32_16x16x32_bf16 v[116:119], v[76:79], v[92:95], v[116:119]
    s_waitcnt lgkmcnt(4)
    v_mov_b32 v3, 0
    v_mov_b32 v7, 0
    v_mfma_f32_16x16x32_bf16 v[112:115], v[64:67], v[96:99], v[112:115]
    v_mov_b32 v32, 0
    v_mov_b32 v18, 0x3f803f80
    v_mfma_f32_16x16x32_bf16 v[116:119], v[80:83], v[96:99], v[116:119]
    s_waitcnt lgkmcnt(0)
    s_barrier
    ds_read_b128 v[56:59], v47 offset:256
    ds_read_b128 v[60:63], v47 offset:320
    v_mov_b32 v0, 0
    v_mov_b32 v4, 0
    v_mfma_f32_16x16x32_bf16 v[112:115], v[68:71], v[100:103], v[112:115]
    ds_read_b128 v[72:75], v47 offset:384
    ds_read_b128 v[76:79], v47 offset:448
    v_mov_b32 v1, 0
    v_mov_b32 v5, 0
    v_mfma_f32_16x16x32_bf16 v[116:119], v[84:87], v[100:103], v[116:119]
    v_mov_b32 v2, 0
    v_mov_b32 v6, 0
    v_smfmac_f32_16x16x64_bf16 v[48:51], v[20:23], a[232:239], v120
    ds_read_b128 v[64:67], v122 offset:28672
    v_mov_b32 v19, 0x3f803f80
    v_smfmac_f32_16x16x64_bf16 v[52:55], v[20:23], a[240:247], v120
    ds_read_b128 v[68:71], v122 offset:29696
    v_cndmask_b32 v112, v112, v116, s[12:13]
    v_smfmac_f32_16x16x64_bf16 v[48:51], v[24:27], a[248:255], v120
    ds_read_b128 v[80:83], v122 offset:30720
    v_cndmask_b32 v113, v113, v117, s[12:13]
    v_smfmac_f32_16x16x64_bf16 v[52:55], v[24:27], v[128:135], v120
    ds_read_b128 v[84:87], v122 offset:31744
    v_cndmask_b32 v114, v114, v118, s[12:13]
    v_smfmac_f32_16x16x64_bf16 v[48:51], v[28:31], v[136:143], v120
    v_cndmask_b32 v115, v115, v119, s[12:13]
    v_smfmac_f32_16x16x64_bf16 v[52:55], v[28:31], v[144:151], v120
    s_waitcnt lgkmcnt(7)
    v_max3_f32 v46, v112, v113, v114
    v_mfma_f32_16x16x32_bf16 v[40:43], v[56:59], v[88:91], 0
    s_waitcnt lgkmcnt(6)
    v_max_f32 v46, v46, v115
    v_cvt_pk_bf16_f32 v48, v48, v49
    v_mfma_f32_16x16x32_bf16 v[40:43], v[60:63], v[92:95], v[40:43]
    s_waitcnt lgkmcnt(5)
    v_max_f32_dpp v47, v46, v46 quad_perm:[2,3,0,1] row_mask:0xf bank_mask:0xf
    v_max_f32_dpp v46, v46, v46 quad_perm:[2,3,0,1] row_mask:0xf bank_mask:0xf
    v_mfma_f32_16x16x32_bf16 v[40:43], v[72:75], v[96:99], v[40:43]
    s_waitcnt lgkmcnt(4)
    v_cvt_pk_bf16_f32 v49, v50, v51
    v_permlane32_swap_b32 v46, v47
    v_mfma_f32_16x16x32_bf16 v[40:43], v[76:79], v[100:103], v[40:43]
    v_cvt_pk_bf16_f32 v50, v52, v53
    v_cvt_pk_bf16_f32 v51, v54, v55
    v_max_f32 v46, v46, v47
    v_mov_b32 v44, 0x3f003f00
    v_mov_b32 v45, 0x3f003f00
    s_cmp_eq_u32 s64, 63
    s_cbranch_scc1 Ls_end
    s_nop 0
    v_max3_f32 v46, v46, v40, v41
    v_max3_f32 v47, v46, v42, v43
    v_max3_f32 v46, v46, v42, v43
    s_nop 1
    v_permlane16_swap_b32 v46, v47
    v_max_f32 v46, v46, v47
    v_mul_f32 v47, s78, v46
    v_fma_f32 v40, v40, s78, -v47
    v_fma_f32 v41, v41, s78, -v47
    v_exp_f32 v40, v40
    v_exp_f32 v41, v41
    v_fma_f32 v112, v112, s78, -v47
    v_fma_f32 v113, v113, s78, -v47
    v_cvt_pk_bf16_f32 v42, v40, v41
    v_cvt_pk_bf16_f32 v43, v40, v41
    v_fma_f32 v114, v114, s78, -v47
    v_fma_f32 v115, v115, s78, -v47
    v_mfma_f32_16x16x16_bf16 v[20:23], v[44:45], v[42:43], 0
    v_exp_f32 v112, v112
    v_mfma_f32_16x16x16_bf16 v[24:27], v[48:49], v[42:43], 0
    v_exp_f32 v113, v113
    v_mfma_f32_16x16x16_bf16 v[28:31], v[50:51], v[42:43], 0
    v_exp_f32 v114, v114
    v_exp_f32 v115, v115
    v_cvt_pk_bf16_f32 v116, v112, v113
    v_cvt_pk_bf16_f32 v117, v114, v115
    s_nop 0
    v_mov_b32_dpp v112, v116 quad_perm:[0,1,0,1] row_mask:0xf bank_mask:0xf
    v_mov_b32_dpp v114, v116 quad_perm:[2,3,2,3] row_mask:0xf bank_mask:0xf
    v_mov_b32_dpp v113, v117 quad_perm:[0,1,0,1] row_mask:0xf bank_mask:0xf
    v_mov_b32_dpp v115, v117 quad_perm:[2,3,2,3] row_mask:0xf bank_mask:0xf
    s_nop 1
    v_mfma_f32_16x16x32_bf16 v[20:23], v[16:19], v[112:115], v[20:23]
    v_xor_b32 v101, 32, v126
    v_xor_b32 v102, 4096, v126
    v_mfma_f32_16x16x32_bf16 v[24:27], v[104:107], v[112:115], v[24:27]
    v_xor_b32 v103, 4128, v126
    v_mfma_f32_16x16x32_bf16 v[28:31], v[108:111], v[112:115], v[28:31]
    v_rcp_f32 v20, v20
    s_nop 2
    v_mul_f32 v24, v24, v20
    v_mul_f32 v25, v25, v20
    v_mul_f32 v26, v26, v20
    v_mul_f32 v27, v27, v20
    v_mul_f32 v28, v28, v20
    v_mul_f32 v29, v29, v20
    v_mul_f32 v30, v30, v20
    v_mul_f32 v31, v31, v20
    v_cvt_pk_bf16_f32 v24, v24, v28
    v_cvt_pk_bf16_f32 v25, v25, v29
    v_cvt_pk_bf16_f32 v26, v26, v30
    v_cvt_pk_bf16_f32 v27, v27, v31
    s_mov_b64 exec, s[14:15]
    ds_write_b128 v126, v[24:27]
    s_mov_b64 exec, -1
    s_waitcnt vmcnt(3) lgkmcnt(1)
    s_barrier
Ls_wo:
    v_smfmac_f32_16x16x64_bf16 v[0:3], v[24:27], v[8:15], v120
    ds_read_b128 v[88:91], v101
    ds_read_b128 v[92:95], v102
    ds_read_b128 v[96:99], v103
    v_smfmac_f32_16x16x64_bf16 v[4:7], v[24:27], v[64:71], v120
    v_smfmac_f32_16x16x64_bf16 v[32:35], v[24:27], v[80:87], v120
    v_smfmac_f32_16x16x64_bf16 v[36:39], v[24:27], v[152:159], v120
    s_waitcnt lgkmcnt(2)
    v_smfmac_f32_16x16x64_bf16 v[0:3], v[88:91], v[160:167], v120
    v_max3_u32 v17, v88, v89, v90
    v_smfmac_f32_16x16x64_bf16 v[4:7], v[88:91], v[168:175], v120
    s_waitcnt lgkmcnt(1)
    v_readfirstlane_b32 s56, v127
    v_smfmac_f32_16x16x64_bf16 v[0:3], v[92:95], v[192:199], v120
    v_max3_u32 v17, v17, v91, v92
    v_smfmac_f32_16x16x64_bf16 v[4:7], v[92:95], v[200:207], v120
    s_waitcnt lgkmcnt(0)
    v_max3_u32 v17, v17, v93, v94
    v_smfmac_f32_16x16x64_bf16 v[0:3], v[96:99], v[224:231], v120
    v_max3_u32 v17, v17, v95, v96
    v_smfmac_f32_16x16x64_bf16 v[4:7], v[96:99], v[232:239], v120
    v_max3_u32 v17, v17, v97, v98
    v_max_u32 v17, v17, v99
    v_smfmac_f32_16x16x64_bf16 v[32:35], v[88:91], v[176:183], v120
    v_cvt_pk_bf16_f32 v40, v0, v1
    v_cmp_eq_u32 vcc, -1, v17
    v_smfmac_f32_16x16x64_bf16 v[36:39], v[88:91], v[184:191], v120
    v_and_or_b32 v40, v40, -2, s39
    v_cvt_pk_bf16_f32 v41, v2, v3
    v_smfmac_f32_16x16x64_bf16 v[32:35], v[92:95], v[208:215], v120
    s_add_u32 s58, s72, s74
    s_mov_b32 s75, 20000
    v_cvt_pk_bf16_f32 v42, v4, v5
    v_smfmac_f32_16x16x64_bf16 v[32:35], v[96:99], v[240:247], v120
    s_add_u32 s37, s72, 0x8000
    s_cbranch_vccnz Ls_redo
Ls_cont:
    v_cvt_pk_bf16_f32 v43, v6, v7
    v_smfmac_f32_16x16x64_bf16 v[36:39], v[92:95], v[216:223], v120
    buffer_store_dwordx4 v[40:43], v125, s[4:7], s72 offen sc1
    v_smfmac_f32_16x16x64_bf16 v[36:39], v[96:99], v[248:255], v120
    v_cvt_pk_bf16_f32 v44, v32, v33
    v_and_or_b32 v44, v44, -2, s39
    v_cvt_pk_bf16_f32 v45, v34, v35
    s_nop 2
    v_cvt_pk_bf16_f32 v46, v36, v37
    v_cvt_pk_bf16_f32 v47, v38, v39
    buffer_store_dwordx4 v[44:47], v125, s[4:7], s37 offen sc1
    v_add_u32 v28, s77, v121
    v_add_u32 v26, s73, v121
    v_add_u32 v24, s79, v124
    ds_read_b128 v[112:115], v24 offset:256
    ds_read_b128 v[56:59], v121 offset:0
    ds_read_b128 v[60:63], v121 offset:1024
    ds_read_b128 v[64:67], v121 offset:4096
    s_mov_b64 s[60:61], -1
    s_mov_b64 s[62:63], -1
    v_mov_b32 v4, 0x3f80
    v_mov_b32 v5, 0x3f800000
    v_cndmask_b32 v4, v4, v5, s[54:55]
    v_cndmask_b32 v0, 0, v4, s[46:47]
    v_cndmask_b32 v1, 0, v4, s[48:49]
    v_cndmask_b32 v2, 0, v4, s[50:51]
    v_cndmask_b32 v3, 0, v4, s[52:53]
    v_mov_b32 v35, -1
    ds_read_b128 v[68:71], v121 offset:5120
    ds_read_b128 v[72:75], v121 offset:8192
    ds_read_b128 v[76:79], v121 offset:9216
    ds_read_b128 v[80:83], v121 offset:12288
    v_bfe_u32 v32, v121, 8, 1
    v_and_b32 v127, 0x20, v121
    v_lshl_add_u32 v127, v32, 4, v127
    v_bfe_u32 v32, v121, 4, 1
    v_lshl_add_u32 v127, v32, 3, v127
    v_bfe_u32 v32, v121, 9, 1
    v_lshl_add_u32 v127, v32, 2, v127
    s_mov_b32 s101, s64
    s_add_u32 s64, s64, 1
    s_and_b32 s37, s64, 3
    ds_read_b128 v[84:87], v121 offset:13312
    ds_read_b128 v[104:107], v26 offset:2048
    ds_read_b128 v[108:111], v26 offset:3072
    ds_read_b128 v[8:11], v122 offset:0
    s_lshl_b32 s37, s37, 13
    s_add_u32 s70, s37, 0x4500000
    s_add_u32 s69, s70, s76
    s_add_u32 s70, s70, s100
    s_xor_b32 s71, s70, 0x4000
    s_and_b32 s99, s56, 0xff
    s_bfe_u32 s97, s56, 0x80010
    s_min_u32 s99, s99, s97
    s_bfe_u32 s97, s56, 0x80008
    s_lshr_b32 s56, s56, 24
    ds_read_b128 v[12:15], v122 offset:1024
    ds_read_b128 v[16:19], v122 offset:2048
    ds_read_b128 v[20:23], v122 offset:3072
    ds_read_b128 v[88:91], v122 offset:4096
    s_min_u32 s97, s97, s56
    s_lshl_b32 s99, s99, 1
    s_lshl1_add_u32 s97, s97, 1
    s_min_u32 s99, s99, s97
    v_mov_b32 v116, v48
    v_mov_b32 v117, v49
    v_mov_b32 v118, v50
    v_mov_b32 v119, v51
    v_mov_b32 v48, 0
    v_mov_b32 v49, 0
    ds_read_b128 v[92:95], v122 offset:5120
    ds_read_b128 v[96:99], v122 offset:6144
    ds_read_b128 v[100:103], v122 offset:7168
    v_mov_b32 v50, 0
    v_mov_b32 v51, 0
    v_mov_b32 v52, 0
    v_mov_b32 v53, 0
    v_mov_b32 v54, 0
    v_mov_b32 v55, 0
    v_xor_b32 v29, 2048, v28
    v_xor_b32 v30, 4096, v28
    v_xor_b32 v31, 6144, v28
    v_mov_b32 v27, s101
    buffer_load_dwordx4 v[40:43], v121, s[4:7], s58 offen sc1
    buffer_load_dwordx4 v[44:47], v121, s[4:7], s58 offen offset:1024 sc1
    s_waitcnt lgkmcnt(0)
    s_barrier
    s_branch Ls_p1w
.p2align 5
    s_nop 0
    s_nop 0
    s_nop 0
    s_nop 0
    s_nop 0
    s_nop 0
Ls_p1:
    s_mov_b64 exec, s[60:61]
    buffer_load_dwordx4 v[40:43], v121, s[4:7], s58 offen sc1
    s_mov_b64 exec, s[62:63]
    buffer_load_dwordx4 v[44:47], v121, s[4:7], s58 offen offset:1024 sc1
    s_mov_b64 exec, -1
Ls_p1w:
    s_sub_u32 s75, s75, 1
    s_cselect_b64 s[56:57], 0, -1
    s_waitcnt vmcnt(0)
    v_and_b32 v32, 1, v40
    v_and_b32 v33, 1, v44
    v_mfma_f32_16x16x32_bf16 v[4:7], v[0:3], v[40:43], 0
    v_cmp_ne_u32 s[60:61], s39, v32
    v_cmp_ne_u32 s[62:63], s39, v33
    v_mfma_f32_16x16x32_bf16 v[4:7], v[0:3], v[44:47], v[4:7]
    s_or_b64 vcc, s[60:61], s[62:63]
    s_and_b64 vcc, vcc, s[56:57]
    s_cbranch_vccnz Ls_p1
    s_nop 4
    v_add_f32_dpp v4, v4, v4 row_ror:4 row_mask:0xf bank_mask:0xf
    v_add_f32_dpp v5, v5, v5 row_ror:4 row_mask:0xf bank_mask:0xf
    s_nop 0
    v_add_f32_dpp v4, v4, v4 row_ror:8 row_mask:0xf bank_mask:0xf
    v_add_f32_dpp v5, v5, v5 row_ror:8 row_mask:0xf bank_mask:0xf
    s_mov_b64 exec, s[44:45]
    v_cvt_pk_bf16_f32 v34, v4, v5
    buffer_store_dword v34, v127, s[4:7], s70 offen sc1
    buffer_store_dword v35, v127, s[4:7], s71 offen sc1
    s_mov_b64 exec, -1
    s_xor_b32 s72, s72, 0x40000
    s_lshr_b32 s39, s64, 1
    s_and_b32 s39, s39, 1
    s_mov_b32 s75, 20000
    s_mov_b64 s[58:59], -1
    s_mov_b64 s[62:63], -1
    v_mov_b32 v44, -1
    v_mov_b32 v45, -1
    v_mov_b32 v46, -1
    v_mov_b32 v47, -1
    ds_write_b128 v126, v[44:47]
    v_mov_b32 v32, 0
    v_mov_b32 v33, 0
    v_mov_b32 v34, 0
    v_mov_b32 v35, 0
    v_mov_b32 v36, 0
    v_mov_b32 v37, 0
    v_mov_b32 v38, 0
    v_mov_b32 v39, 0
    v_mov_b32 v40, 0
    v_mov_b32 v41, 0
    v_mov_b32 v42, 0
    v_mov_b32 v43, 0
    v_mov_b32 v44, 0
    v_mov_b32 v45, 0
    v_mov_b32 v46, 0
    v_mov_b32 v47, 0
    s_add_u32 s96, s64, 1
    s_min_u32 s96, s96, 63
    s_cmp_le_u32 s99, s96
    s_cbranch_scc1 Ls_wp
Ls_wpr:
    s_nop 15
    buffer_load_dwordx4 v[0:3], v121, s[4:7], s69 offen sc1
    buffer_load_dwordx4 v[4:7], v121, s[4:7], s69 offen offset:1024 sc1
    s_nop 15
    s_nop 15
    s_branch Ls_p2
Ls_redo:
    s_sub_u32 s94, s94, 1
    s_cbranch_scc1 Ls_cont
    s_nop 15
    v_mov_b32 v0, 0
    v_mov_b32 v1, 0
    v_mov_b32 v2, 0
    v_mov_b32 v3, 0
    v_mov_b32 v4, 0
    v_mov_b32 v5, 0
    v_mov_b32 v6, 0
    v_mov_b32 v7, 0
    v_mov_b32 v32, 0
    v_mov_b32 v33, 0
    v_mov_b32 v34, 0
    v_mov_b32 v35, 0
    v_mov_b32 v36, 0
    v_mov_b32 v37, 0
    v_mov_b32 v38, 0
    v_mov_b32 v39, 0
    s_nop 1
    s_branch Ls_wo
Ls_end:
    v_add_u32 v24, s79, v124
    ds_read_b128 v[112:115], v24 offset:256
    buffer_store_dwordx4 v[48:51], v121, s[4:7], s68 offen sc1
    s_waitcnt lgkmcnt(0)
    buffer_store_dwordx4 v[112:115], v121, s[4:7], s67 offen sc1
    s_waitcnt vmcnt(0)
    s_barrier
    s_cmp_lg_u32 s29, 0
    s_cbranch_scc1 Ls_fin
    s_mov_b64 exec, 1
    v_mov_b32 v8, 64
    buffer_store_byte v8, off, s[4:7], s98 sc1
    s_waitcnt vmcnt(0)
Ls_fin:
    s_endpgm
Ls_wp:
    s_mov_b32 s57, 400000
Ls_wp2:
    buffer_load_dword v127, off, s[4:7], s95 sc1
    s_waitcnt vmcnt(0)
    v_readfirstlane_b32 s56, v127
    s_and_b32 s99, s56, 0xff
    s_bfe_u32 s97, s56, 0x80010
    s_min_u32 s99, s99, s97
    s_bfe_u32 s97, s56, 0x80008
    s_lshr_b32 s56, s56, 24
    s_min_u32 s97, s97, s56
    s_lshl_b32 s99, s99, 1
    s_lshl1_add_u32 s97, s97, 1
    s_min_u32 s99, s99, s97
    s_cmp_gt_u32 s99, s96
    s_cbranch_scc1 Ls_wpr
    s_sub_u32 s57, s57, 1
    s_cbranch_scc0 Ls_wp2
    s_branch Ls_wpr
L_work:
    s_cmp_lt_u32 s30, 224
    s_cbranch_scc1 L_nodl
    s_sleep 127
    s_sleep 127
    s_sleep 127
    s_sleep 127
L_nodl:
    s_sub_u32 s40, s30, 32
    s_cmp_ge_u32 s40, 192
    s_cbranch_scc1 L_second
    v_and_b32 v1, 63, v0
    v_and_b32 v2, 15, v1
    v_lshrrev_b32 v3, 4, v1
    v_lshlrev_b32 v4, 4, v1
    s_and_b32 s41, s40, 1
    s_lshr_b32 s42, s40, 1
    s_and_b32 s42, s42, 31
    s_lshr_b32 s43, s40, 6
    s_add_u32 s44, s43, 1
    s_cmp_eq_u32 s44, 3
    s_cselect_b32 s44, 0, s44
    s_lshl_b32 s45, s44, 3
    s_add_u32 s45, s45, 16
    s_load_dwordx2 s[12:13], s[0:1], s45
    s_mov_b32 s14, 0x400000
    s_mov_b32 s15, 0x00020000
    s_load_dwordx2 s[16:17], s[0:1], 0
    s_mov_b32 s18, 0x200000
    s_mov_b32 s19, 0x00020000
    v_lshlrev_b32 v5, 10, v2
    v_lshl_add_u32 v5, v3, 4, v5
    v_lshlrev_b32 v6, 16, v3
    v_lshl_add_u32 v6, v2, 2, v6
    s_lshl_b32 s46, s42, 8
    s_lshl_b32 s47, s29, 6
    s_add_u32 s46, s46, s47
    s_lshr_b32 s47, s29, 1
    s_lshl_b32 s47, s47, 14
    s_and_b32 s48, s29, 1
    s_lshl_b32 s48, s48, 9
    s_add_u32 s47, s47, s48
    s_lshl_b32 s48, s41, 15
    s_add_u32 s47, s47, s48
    s_lshl_b32 s49, s29, 13
    s_waitcnt lgkmcnt(0)
    s_add_u32 m0, s49, 0
    s_nop 0
    buffer_load_dwordx4 v5, s[16:19], s47 offen offset:0 lds
    s_add_u32 m0, s49, 960
    s_nop 0
    buffer_load_dwordx4 v5, s[16:19], s47 offen offset:64 lds
    s_add_u32 m0, s49, 1920
    s_nop 0
    buffer_load_dwordx4 v5, s[16:19], s47 offen offset:128 lds
    s_add_u32 m0, s49, 2880
    s_nop 0
    buffer_load_dwordx4 v5, s[16:19], s47 offen offset:192 lds
    s_add_u32 m0, s49, 3840
    s_nop 0
    buffer_load_dwordx4 v5, s[16:19], s47 offen offset:256 lds
    s_add_u32 m0, s49, 4800
    s_nop 0
    buffer_load_dwordx4 v5, s[16:19], s47 offen offset:320 lds
    s_add_u32 m0, s49, 5760
    s_nop 0
    buffer_load_dwordx4 v5, s[16:19], s47 offen offset:384 lds
    s_add_u32 m0, s49, 6720
    s_nop 0
    buffer_load_dwordx4 v5, s[16:19], s47 offen offset:448 lds
    s_add_u32 s47, s47, 0x10000
    s_xor_b32 s49, s49, 0x8000
    s_mov_b32 s60, 0x05040100
    s_mov_b32 s61, 0x07060302
    s_add_u32 s63, s46, 0
    buffer_load_dword v16, v6, s[12:15], s63 offen
    s_add_u32 s63, s46, 8192
    buffer_load_dword v17, v6, s[12:15], s63 offen
    s_add_u32 s63, s46, 16384
    buffer_load_dword v18, v6, s[12:15], s63 offen
    s_add_u32 s63, s46, 24576
    buffer_load_dword v19, v6, s[12:15], s63 offen
    s_add_u32 s63, s46, 32768
    buffer_load_dword v20, v6, s[12:15], s63 offen
    s_add_u32 s63, s46, 40960
    buffer_load_dword v21, v6, s[12:15], s63 offen
    s_add_u32 s63, s46, 49152
    buffer_load_dword v22, v6, s[12:15], s63 offen
    s_add_u32 s63, s46, 57344
    buffer_load_dword v23, v6, s[12:15], s63 offen
    s_add_u32 s63, s46, 262144
    buffer_load_dword v24, v6, s[12:15], s63 offen
    s_add_u32 s63, s46, 270336
    buffer_load_dword v25, v6, s[12:15], s63 offen
    s_add_u32 s63, s46, 278528
    buffer_load_dword v26, v6, s[12:15], s63 offen
    s_add_u32 s63, s46, 286720
    buffer_load_dword v27, v6, s[12:15], s63 offen
    s_add_u32 s63, s46, 294912
    buffer_load_dword v28, v6, s[12:15], s63 offen
    s_add_u32 s63, s46, 303104
    buffer_load_dword v29, v6, s[12:15], s63 offen
    s_add_u32 s63, s46, 311296
    buffer_load_dword v30, v6, s[12:15], s63 offen
    s_add_u32 s63, s46, 319488
    buffer_load_dword v31, v6, s[12:15], s63 offen
    s_add_u32 s63, s46, 524288
    buffer_load_dword v32, v6, s[12:15], s63 offen
    s_add_u32 s63, s46, 532480
    buffer_load_dword v33, v6, s[12:15], s63 offen
    s_add_u32 s63, s46, 540672
    buffer_load_dword v34, v6, s[12:15], s63 offen
    s_add_u32 s63, s46, 548864
    buffer_load_dword v35, v6, s[12:15], s63 offen
    s_add_u32 s63, s46, 557056
    buffer_load_dword v36, v6, s[12:15], s63 offen
    s_add_u32 s63, s46, 565248
    buffer_load_dword v37, v6, s[12:15], s63 offen
    s_add_u32 s63, s46, 573440
    buffer_load_dword v38, v6, s[12:15], s63 offen
    s_add_u32 s63, s46, 581632
    buffer_load_dword v39, v6, s[12:15], s63 offen
    s_add_u32 s63, s46, 786432
    buffer_load_dword v40, v6, s[12:15], s63 offen
    s_add_u32 s63, s46, 794624
    buffer_load_dword v41, v6, s[12:15], s63 offen
    s_add_u32 s63, s46, 802816
    buffer_load_dword v42, v6, s[12:15], s63 offen
    s_add_u32 s63, s46, 811008
    buffer_load_dword v43, v6, s[12:15], s63 offen
    s_add_u32 s63, s46, 819200
    buffer_load_dword v44, v6, s[12:15], s63 offen
    s_add_u32 s63, s46, 827392
    buffer_load_dword v45, v6, s[12:15], s63 offen
    s_add_u32 s63, s46, 835584
    buffer_load_dword v46, v6, s[12:15], s63 offen
    s_add_u32 s63, s46, 843776
    buffer_load_dword v47, v6, s[12:15], s63 offen
    s_add_u32 s63, s46, 1048576
    buffer_load_dword v48, v6, s[12:15], s63 offen
    s_add_u32 s63, s46, 1056768
    buffer_load_dword v49, v6, s[12:15], s63 offen
    s_add_u32 s63, s46, 1064960
    buffer_load_dword v50, v6, s[12:15], s63 offen
    s_add_u32 s63, s46, 1073152
    buffer_load_dword v51, v6, s[12:15], s63 offen
    s_add_u32 s63, s46, 1081344
    buffer_load_dword v52, v6, s[12:15], s63 offen
    s_add_u32 s63, s46, 1089536
    buffer_load_dword v53, v6, s[12:15], s63 offen
    s_add_u32 s63, s46, 1097728
    buffer_load_dword v54, v6, s[12:15], s63 offen
    s_add_u32 s63, s46, 1105920
    buffer_load_dword v55, v6, s[12:15], s63 offen
    s_add_u32 s63, s46, 1310720
    buffer_load_dword v56, v6, s[12:15], s63 offen
    s_add_u32 s63, s46, 1318912
    buffer_load_dword v57, v6, s[12:15], s63 offen
    s_add_u32 s63, s46, 1327104
    buffer_load_dword v58, v6, s[12:15], s63 offen
    s_add_u32 s63, s46, 1335296
    buffer_load_dword v59, v6, s[12:15], s63 offen
    s_add_u32 s63, s46, 1343488
    buffer_load_dword v60, v6, s[12:15], s63 offen
    s_add_u32 s63, s46, 1351680
    buffer_load_dword v61, v6, s[12:15], s63 offen
    s_add_u32 s63, s46, 1359872
    buffer_load_dword v62, v6, s[12:15], s63 offen
    s_add_u32 s63, s46, 1368064
    buffer_load_dword v63, v6, s[12:15], s63 offen
    s_waitcnt vmcnt(32)
    v_perm_b32 v128, v17, v16, s60
    v_perm_b32 v129, v19, v18, s60
    v_perm_b32 v130, v21, v20, s60
    v_perm_b32 v131, v23, v22, s60
    v_perm_b32 v132, v17, v16, s61
    v_perm_b32 v133, v19, v18, s61
    v_perm_b32 v134, v21, v20, s61
    v_perm_b32 v135, v23, v22, s61
    v_perm_b32 v136, v25, v24, s60
    v_perm_b32 v137, v27, v26, s60
    v_perm_b32 v138, v29, v28, s60
    v_perm_b32 v139, v31, v30, s60
    v_perm_b32 v140, v25, v24, s61
    v_perm_b32 v141, v27, v26, s61
    v_perm_b32 v142, v29, v28, s61
    v_perm_b32 v143, v31, v30, s61
    s_add_u32 s63, s46, 1572864
    buffer_load_dword v16, v6, s[12:15], s63 offen
    s_add_u32 s63, s46, 1581056
    buffer_load_dword v17, v6, s[12:15], s63 offen
    s_add_u32 s63, s46, 1589248
    buffer_load_dword v18, v6, s[12:15], s63 offen
    s_add_u32 s63, s46, 1597440
    buffer_load_dword v19, v6, s[12:15], s63 offen
    s_add_u32 s63, s46, 1605632
    buffer_load_dword v20, v6, s[12:15], s63 offen
    s_add_u32 s63, s46, 1613824
    buffer_load_dword v21, v6, s[12:15], s63 offen
    s_add_u32 s63, s46, 1622016
    buffer_load_dword v22, v6, s[12:15], s63 offen
    s_add_u32 s63, s46, 1630208
    buffer_load_dword v23, v6, s[12:15], s63 offen
    s_add_u32 s63, s46, 1835008
    buffer_load_dword v24, v6, s[12:15], s63 offen
    s_add_u32 s63, s46, 1843200
    buffer_load_dword v25, v6, s[12:15], s63 offen
    s_add_u32 s63, s46, 1851392
    buffer_load_dword v26, v6, s[12:15], s63 offen
    s_add_u32 s63, s46, 1859584
    buffer_load_dword v27, v6, s[12:15], s63 offen
    s_add_u32 s63, s46, 1867776
    buffer_load_dword v28, v6, s[12:15], s63 offen
    s_add_u32 s63, s46, 1875968
    buffer_load_dword v29, v6, s[12:15], s63 offen
    s_add_u32 s63, s46, 1884160
    buffer_load_dword v30, v6, s[12:15], s63 offen
    s_add_u32 s63, s46, 1892352
    buffer_load_dword v31, v6, s[12:15], s63 offen
    s_waitcnt vmcnt(32)
    v_perm_b32 v144, v33, v32, s60
    v_perm_b32 v145, v35, v34, s60
    v_perm_b32 v146, v37, v36, s60
    v_perm_b32 v147, v39, v38, s60
    v_perm_b32 v148, v33, v32, s61
    v_perm_b32 v149, v35, v34, s61
    v_perm_b32 v150, v37, v36, s61
    v_perm_b32 v151, v39, v38, s61
    v_perm_b32 v152, v41, v40, s60
    v_perm_b32 v153, v43, v42, s60
    v_perm_b32 v154, v45, v44, s60
    v_perm_b32 v155, v47, v46, s60
    v_perm_b32 v156, v41, v40, s61
    v_perm_b32 v157, v43, v42, s61
    v_perm_b32 v158, v45, v44, s61
    v_perm_b32 v159, v47, v46, s61
    s_add_u32 s63, s46, 2097152
    buffer_load_dword v32, v6, s[12:15], s63 offen
    s_add_u32 s63, s46, 2105344
    buffer_load_dword v33, v6, s[12:15], s63 offen
    s_add_u32 s63, s46, 2113536
    buffer_load_dword v34, v6, s[12:15], s63 offen
    s_add_u32 s63, s46, 2121728
    buffer_load_dword v35, v6, s[12:15], s63 offen
    s_add_u32 s63, s46, 2129920
    buffer_load_dword v36, v6, s[12:15], s63 offen
    s_add_u32 s63, s46, 2138112
    buffer_load_dword v37, v6, s[12:15], s63 offen
    s_add_u32 s63, s46, 2146304
    buffer_load_dword v38, v6, s[12:15], s63 offen
    s_add_u32 s63, s46, 2154496
    buffer_load_dword v39, v6, s[12:15], s63 offen
    s_add_u32 s63, s46, 2359296
    buffer_load_dword v40, v6, s[12:15], s63 offen
    s_add_u32 s63, s46, 2367488
    buffer_load_dword v41, v6, s[12:15], s63 offen
    s_add_u32 s63, s46, 2375680
    buffer_load_dword v42, v6, s[12:15], s63 offen
    s_add_u32 s63, s46, 2383872
    buffer_load_dword v43, v6, s[12:15], s63 offen
    s_add_u32 s63, s46, 2392064
    buffer_load_dword v44, v6, s[12:15], s63 offen
    s_add_u32 s63, s46, 2400256
    buffer_load_dword v45, v6, s[12:15], s63 offen
    s_add_u32 s63, s46, 2408448
    buffer_load_dword v46, v6, s[12:15], s63 offen
    s_add_u32 s63, s46, 2416640
    buffer_load_dword v47, v6, s[12:15], s63 offen
    s_waitcnt vmcnt(32)
    v_perm_b32 v160, v49, v48, s60
    v_perm_b32 v161, v51, v50, s60
    v_perm_b32 v162, v53, v52, s60
    v_perm_b32 v163, v55, v54, s60
    v_perm_b32 v164, v49, v48, s61
    v_perm_b32 v165, v51, v50, s61
    v_perm_b32 v166, v53, v52, s61
    v_perm_b32 v167, v55, v54, s61
    v_perm_b32 v168, v57, v56, s60
    v_perm_b32 v169, v59, v58, s60
    v_perm_b32 v170, v61, v60, s60
    v_perm_b32 v171, v63, v62, s60
    v_perm_b32 v172, v57, v56, s61
    v_perm_b32 v173, v59, v58, s61
    v_perm_b32 v174, v61, v60, s61
    v_perm_b32 v175, v63, v62, s61
    s_add_u32 s63, s46, 2621440
    buffer_load_dword v48, v6, s[12:15], s63 offen
    s_add_u32 s63, s46, 2629632
    buffer_load_dword v49, v6, s[12:15], s63 offen
    s_add_u32 s63, s46, 2637824
    buffer_load_dword v50, v6, s[12:15], s63 offen
    s_add_u32 s63, s46, 2646016
    buffer_load_dword v51, v6, s[12:15], s63 offen
    s_add_u32 s63, s46, 2654208
    buffer_load_dword v52, v6, s[12:15], s63 offen
    s_add_u32 s63, s46, 2662400
    buffer_load_dword v53, v6, s[12:15], s63 offen
    s_add_u32 s63, s46, 2670592
    buffer_load_dword v54, v6, s[12:15], s63 offen
    s_add_u32 s63, s46, 2678784
    buffer_load_dword v55, v6, s[12:15], s63 offen
    s_add_u32 s63, s46, 2883584
    buffer_load_dword v56, v6, s[12:15], s63 offen
    s_add_u32 s63, s46, 2891776
    buffer_load_dword v57, v6, s[12:15], s63 offen
    s_add_u32 s63, s46, 2899968
    buffer_load_dword v58, v6, s[12:15], s63 offen
    s_add_u32 s63, s46, 2908160
    buffer_load_dword v59, v6, s[12:15], s63 offen
    s_add_u32 s63, s46, 2916352
    buffer_load_dword v60, v6, s[12:15], s63 offen
    s_add_u32 s63, s46, 2924544
    buffer_load_dword v61, v6, s[12:15], s63 offen
    s_add_u32 s63, s46, 2932736
    buffer_load_dword v62, v6, s[12:15], s63 offen
    s_add_u32 s63, s46, 2940928
    buffer_load_dword v63, v6, s[12:15], s63 offen
    s_waitcnt vmcnt(32)
    v_perm_b32 v176, v17, v16, s60
    v_perm_b32 v177, v19, v18, s60
    v_perm_b32 v178, v21, v20, s60
    v_perm_b32 v179, v23, v22, s60
    v_perm_b32 v180, v17, v16, s61
    v_perm_b32 v181, v19, v18, s61
    v_perm_b32 v182, v21, v20, s61
    v_perm_b32 v183, v23, v22, s61
    v_perm_b32 v184, v25, v24, s60
    v_perm_b32 v185, v27, v26, s60
    v_perm_b32 v186, v29, v28, s60
    v_perm_b32 v187, v31, v30, s60
    v_perm_b32 v188, v25, v24, s61
    v_perm_b32 v189, v27, v26, s61
    v_perm_b32 v190, v29, v28, s61
    v_perm_b32 v191, v31, v30, s61
    s_add_u32 s63, s46, 3145728
    buffer_load_dword v16, v6, s[12:15], s63 offen
    s_add_u32 s63, s46, 3153920
    buffer_load_dword v17, v6, s[12:15], s63 offen
    s_add_u32 s63, s46, 3162112
    buffer_load_dword v18, v6, s[12:15], s63 offen
    s_add_u32 s63, s46, 3170304
    buffer_load_dword v19, v6, s[12:15], s63 offen
    s_add_u32 s63, s46, 3178496
    buffer_load_dword v20, v6, s[12:15], s63 offen
    s_add_u32 s63, s46, 3186688
    buffer_load_dword v21, v6, s[12:15], s63 offen
    s_add_u32 s63, s46, 3194880
    buffer_load_dword v22, v6, s[12:15], s63 offen
    s_add_u32 s63, s46, 3203072
    buffer_load_dword v23, v6, s[12:15], s63 offen
    s_add_u32 s63, s46, 3407872
    buffer_load_dword v24, v6, s[12:15], s63 offen
    s_add_u32 s63, s46, 3416064
    buffer_load_dword v25, v6, s[12:15], s63 offen
    s_add_u32 s63, s46, 3424256
    buffer_load_dword v26, v6, s[12:15], s63 offen
    s_add_u32 s63, s46, 3432448
    buffer_load_dword v27, v6, s[12:15], s63 offen
    s_add_u32 s63, s46, 3440640
    buffer_load_dword v28, v6, s[12:15], s63 offen
    s_add_u32 s63, s46, 3448832
    buffer_load_dword v29, v6, s[12:15], s63 offen
    s_add_u32 s63, s46, 3457024
    buffer_load_dword v30, v6, s[12:15], s63 offen
    s_add_u32 s63, s46, 3465216
    buffer_load_dword v31, v6, s[12:15], s63 offen
    s_waitcnt vmcnt(32)
    v_perm_b32 v192, v33, v32, s60
    v_perm_b32 v193, v35, v34, s60
    v_perm_b32 v194, v37, v36, s60
    v_perm_b32 v195, v39, v38, s60
    v_perm_b32 v196, v33, v32, s61
    v_perm_b32 v197, v35, v34, s61
    v_perm_b32 v198, v37, v36, s61
    v_perm_b32 v199, v39, v38, s61
    v_perm_b32 v200, v41, v40, s60
    v_perm_b32 v201, v43, v42, s60
    v_perm_b32 v202, v45, v44, s60
    v_perm_b32 v203, v47, v46, s60
    v_perm_b32 v204, v41, v40, s61
    v_perm_b32 v205, v43, v42, s61
    v_perm_b32 v206, v45, v44, s61
    v_perm_b32 v207, v47, v46, s61
    s_add_u32 s63, s46, 3670016
    buffer_load_dword v32, v6, s[12:15], s63 offen
    s_add_u32 s63, s46, 3678208
    buffer_load_dword v33, v6, s[12:15], s63 offen
    s_add_u32 s63, s46, 3686400
    buffer_load_dword v34, v6, s[12:15], s63 offen
    s_add_u32 s63, s46, 3694592
    buffer_load_dword v35, v6, s[12:15], s63 offen
    s_add_u32 s63, s46, 3702784
    buffer_load_dword v36, v6, s[12:15], s63 offen
    s_add_u32 s63, s46, 3710976
    buffer_load_dword v37, v6, s[12:15], s63 offen
    s_add_u32 s63, s46, 3719168
    buffer_load_dword v38, v6, s[12:15], s63 offen
    s_add_u32 s63, s46, 3727360
    buffer_load_dword v39, v6, s[12:15], s63 offen
    s_add_u32 s63, s46, 3932160
    buffer_load_dword v40, v6, s[12:15], s63 offen
    s_add_u32 s63, s46, 3940352
    buffer_load_dword v41, v6, s[12:15], s63 offen
    s_add_u32 s63, s46, 3948544
    buffer_load_dword v42, v6, s[12:15], s63 offen
    s_add_u32 s63, s46, 3956736
    buffer_load_dword v43, v6, s[12:15], s63 offen
    s_add_u32 s63, s46, 3964928
    buffer_load_dword v44, v6, s[12:15], s63 offen
    s_add_u32 s63, s46, 3973120
    buffer_load_dword v45, v6, s[12:15], s63 offen
    s_add_u32 s63, s46, 3981312
    buffer_load_dword v46, v6, s[12:15], s63 offen
    s_add_u32 s63, s46, 3989504
    buffer_load_dword v47, v6, s[12:15], s63 offen
    s_waitcnt vmcnt(32)
    v_perm_b32 v208, v49, v48, s60
    v_perm_b32 v209, v51, v50, s60
    v_perm_b32 v210, v53, v52, s60
    v_perm_b32 v211, v55, v54, s60
    v_perm_b32 v212, v49, v48, s61
    v_perm_b32 v213, v51, v50, s61
    v_perm_b32 v214, v53, v52, s61
    v_perm_b32 v215, v55, v54, s61
    v_perm_b32 v216, v57, v56, s60
    v_perm_b32 v217, v59, v58, s60
    v_perm_b32 v218, v61, v60, s60
    v_perm_b32 v219, v63, v62, s60
    v_perm_b32 v220, v57, v56, s61
    v_perm_b32 v221, v59, v58, s61
    v_perm_b32 v222, v61, v60, s61
    v_perm_b32 v223, v63, v62, s61
    s_waitcnt vmcnt(16)
    v_perm_b32 v224, v17, v16, s60
    v_perm_b32 v225, v19, v18, s60
    v_perm_b32 v226, v21, v20, s60
    v_perm_b32 v227, v23, v22, s60
    v_perm_b32 v228, v17, v16, s61
    v_perm_b32 v229, v19, v18, s61
    v_perm_b32 v230, v21, v20, s61
    v_perm_b32 v231, v23, v22, s61
    v_perm_b32 v232, v25, v24, s60
    v_perm_b32 v233, v27, v26, s60
    v_perm_b32 v234, v29, v28, s60
    v_perm_b32 v235, v31, v30, s60
    v_perm_b32 v236, v25, v24, s61
    v_perm_b32 v237, v27, v26, s61
    v_perm_b32 v238, v29, v28, s61
    v_perm_b32 v239, v31, v30, s61
    s_waitcnt vmcnt(0)
    v_perm_b32 v240, v33, v32, s60
    v_perm_b32 v241, v35, v34, s60
    v_perm_b32 v242, v37, v36, s60
    v_perm_b32 v243, v39, v38, s60
    v_perm_b32 v244, v33, v32, s61
    v_perm_b32 v245, v35, v34, s61
    v_perm_b32 v246, v37, v36, s61
    v_perm_b32 v247, v39, v38, s61
    v_perm_b32 v248, v41, v40, s60
    v_perm_b32 v249, v43, v42, s60
    v_perm_b32 v250, v45, v44, s60
    v_perm_b32 v251, v47, v46, s60
    v_perm_b32 v252, v41, v40, s61
    v_perm_b32 v253, v43, v42, s61
    v_perm_b32 v254, v45, v44, s61
    v_perm_b32 v255, v47, v46, s61
    s_mov_b32 s57, 400000
L_pj_rdy:
    buffer_load_dword v8, off, s[8:11], 0 offset:32 sc1
    s_waitcnt vmcnt(0)
    v_readfirstlane_b32 s56, v8
    s_and_b32 s56, s56, 0xffff
    s_cmp_ge_u32 s56, 32
    s_cbranch_scc1 L_pj_rdy_ok
    s_sleep 8
    s_sub_u32 s57, s57, 1
    s_cbranch_scc0 L_pj_rdy
L_pj_rdy_ok:
    s_lshl_b32 s50, s44, 24
    s_lshl_b32 s48, s41, 18
    s_add_u32 s50, s50, s48
    s_lshl_b32 s48, s42, 13
    s_add_u32 s50, s50, s48
    s_mov_b32 s51, 0
    s_mov_b32 s52, 0
    s_lshl_b32 s53, s42, 7
    s_add_u32 s53, s53, 0x4701000
    s_lshl_b32 s48, s43, 1
    s_add_u32 s53, s53, s48
    s_add_u32 s53, s53, s41
    s_cmp_eq_u32 s44, 2
    s_cbranch_scc1 L_pjV
    s_lshl_b32 s48, s29, 10
    s_add_u32 s50, s50, s48
L_pjK_loop:
    s_waitcnt vmcnt(0)
    s_barrier
    s_cmp_lg_u32 s29, 0
    s_cbranch_scc1 L_pjK_nf
    s_cmp_eq_u32 s43, 2
    s_cbranch_scc1 L_pjK_nf
    s_mov_b64 exec, 1
    v_mov_b32 v8, s51
    buffer_store_byte v8, off, s[4:7], s53 sc1
    s_mov_b64 exec, -1
L_pjK_nf:
    s_cmp_eq_u32 s51, 32
    s_cbranch_scc1 L_pj_done
    s_cmp_eq_u32 s51, 31
    s_cbranch_scc1 L_pjK_nd
    s_add_u32 m0, s49, 0
    s_nop 0
    buffer_load_dwordx4 v5, s[16:19], s47 offen offset:0 lds
    s_add_u32 m0, s49, 960
    s_nop 0
    buffer_load_dwordx4 v5, s[16:19], s47 offen offset:64 lds
    s_add_u32 m0, s49, 1920
    s_nop 0
    buffer_load_dwordx4 v5, s[16:19], s47 offen offset:128 lds
    s_add_u32 m0, s49, 2880
    s_nop 0
    buffer_load_dwordx4 v5, s[16:19], s47 offen offset:192 lds
    s_add_u32 m0, s49, 3840
    s_nop 0
    buffer_load_dwordx4 v5, s[16:19], s47 offen offset:256 lds
    s_add_u32 m0, s49, 4800
    s_nop 0
    buffer_load_dwordx4 v5, s[16:19], s47 offen offset:320 lds
    s_add_u32 m0, s49, 5760
    s_nop 0
    buffer_load_dwordx4 v5, s[16:19], s47 offen offset:384 lds
    s_add_u32 m0, s49, 6720
    s_nop 0
    buffer_load_dwordx4 v5, s[16:19], s47 offen offset:448 lds
    s_add_u32 s47, s47, 0x10000
    s_xor_b32 s49, s49, 0x8000
L_pjK_nd:
    v_add_u32 v7, s52, v4
    s_xor_b32 s52, s52, 0x8000
    ds_read_b128 v[16:19], v7 offset:0
    ds_read_b128 v[20:23], v7 offset:16384
    ds_read_b128 v[24:27], v7 offset:1024
    ds_read_b128 v[28:31], v7 offset:17408
    ds_read_b128 v[32:35], v7 offset:2048
    ds_read_b128 v[36:39], v7 offset:18432
    ds_read_b128 v[40:43], v7 offset:3072
    ds_read_b128 v[44:47], v7 offset:19456
    ds_read_b128 v[48:51], v7 offset:4096
    ds_read_b128 v[52:55], v7 offset:20480
    ds_read_b128 v[56:59], v7 offset:5120
    ds_read_b128 v[60:63], v7 offset:21504
    ds_read_b128 v[64:67], v7 offset:6144
    ds_read_b128 v[68:71], v7 offset:22528
    ds_read_b128 v[72:75], v7 offset:7168
    ds_read_b128 v[76:79], v7 offset:23552
    s_waitcnt lgkmcnt(8)
    v_mfma_f32_16x16x32_bf16 v[80:83], v[128:131], v[16:19], 0
    v_mfma_f32_16x16x32_bf16 v[84:87], v[132:135], v[16:19], 0
    v_mfma_f32_16x16x32_bf16 v[88:91], v[128:131], v[20:23], 0
    v_mfma_f32_16x16x32_bf16 v[92:95], v[132:135], v[20:23], 0
    v_mfma_f32_16x16x32_bf16 v[80:83], v[136:139], v[24:27], v[80:83]
    v_mfma_f32_16x16x32_bf16 v[84:87], v[140:143], v[24:27], v[84:87]
    v_mfma_f32_16x16x32_bf16 v[88:91], v[136:139], v[28:31], v[88:91]
    v_mfma_f32_16x16x32_bf16 v[92:95], v[140:143], v[28:31], v[92:95]
    v_mfma_f32_16x16x32_bf16 v[80:83], v[144:147], v[32:35], v[80:83]
    v_mfma_f32_16x16x32_bf16 v[84:87], v[148:151], v[32:35], v[84:87]
    v_mfma_f32_16x16x32_bf16 v[88:91], v[144:147], v[36:39], v[88:91]
    v_mfma_f32_16x16x32_bf16 v[92:95], v[148:151], v[36:39], v[92:95]
    v_mfma_f32_16x16x32_bf16 v[80:83], v[152:155], v[40:43], v[80:83]
    v_mfma_f32_16x16x32_bf16 v[84:87], v[156:159], v[40:43], v[84:87]
    v_mfma_f32_16x16x32_bf16 v[88:91], v[152:155], v[44:47], v[88:91]
    v_mfma_f32_16x16x32_bf16 v[92:95], v[156:159], v[44:47], v[92:95]
    ds_read_b128 v[16:19], v7 offset:8192
    ds_read_b128 v[20:23], v7 offset:24576
    ds_read_b128 v[24:27], v7 offset:9216
    ds_read_b128 v[28:31], v7 offset:25600
    ds_read_b128 v[32:35], v7 offset:10240
    ds_read_b128 v[36:39], v7 offset:26624
    ds_read_b128 v[40:43], v7 offset:11264
    ds_read_b128 v[44:47], v7 offset:27648
    s_waitcnt lgkmcnt(8)
    v_mfma_f32_16x16x32_bf16 v[80:83], v[160:163], v[48:51], v[80:83]
    v_mfma_f32_16x16x32_bf16 v[84:87], v[164:167], v[48:51], v[84:87]
    v_mfma_f32_16x16x32_bf16 v[88:91], v[160:163], v[52:55], v[88:91]
    v_mfma_f32_16x16x32_bf16 v[92:95], v[164:167], v[52:55], v[92:95]
    v_mfma_f32_16x16x32_bf16 v[80:83], v[168:171], v[56:59], v[80:83]
    v_mfma_f32_16x16x32_bf16 v[84:87], v[172:175], v[56:59], v[84:87]
    v_mfma_f32_16x16x32_bf16 v[88:91], v[168:171], v[60:63], v[88:91]
    v_mfma_f32_16x16x32_bf16 v[92:95], v[172:175], v[60:63], v[92:95]
    v_mfma_f32_16x16x32_bf16 v[80:83], v[176:179], v[64:67], v[80:83]
    v_mfma_f32_16x16x32_bf16 v[84:87], v[180:183], v[64:67], v[84:87]
    v_mfma_f32_16x16x32_bf16 v[88:91], v[176:179], v[68:71], v[88:91]
    v_mfma_f32_16x16x32_bf16 v[92:95], v[180:183], v[68:71], v[92:95]
    v_mfma_f32_16x16x32_bf16 v[80:83], v[184:187], v[72:75], v[80:83]
    v_mfma_f32_16x16x32_bf16 v[84:87], v[188:191], v[72:75], v[84:87]
    v_mfma_f32_16x16x32_bf16 v[88:91], v[184:187], v[76:79], v[88:91]
    v_mfma_f32_16x16x32_bf16 v[92:95], v[188:191], v[76:79], v[92:95]
    ds_read_b128 v[48:51], v7 offset:12288
    ds_read_b128 v[52:55], v7 offset:28672
    ds_read_b128 v[56:59], v7 offset:13312
    ds_read_b128 v[60:63], v7 offset:29696
    ds_read_b128 v[64:67], v7 offset:14336
    ds_read_b128 v[68:71], v7 offset:30720
    ds_read_b128 v[72:75], v7 offset:15360
    ds_read_b128 v[76:79], v7 offset:31744
    s_waitcnt lgkmcnt(8)
    v_mfma_f32_16x16x32_bf16 v[80:83], v[192:195], v[16:19], v[80:83]
    v_mfma_f32_16x16x32_bf16 v[84:87], v[196:199], v[16:19], v[84:87]
    v_mfma_f32_16x16x32_bf16 v[88:91], v[192:195], v[20:23], v[88:91]
    v_mfma_f32_16x16x32_bf16 v[92:95], v[196:199], v[20:23], v[92:95]
    v_mfma_f32_16x16x32_bf16 v[80:83], v[200:203], v[24:27], v[80:83]
    v_mfma_f32_16x16x32_bf16 v[84:87], v[204:207], v[24:27], v[84:87]
    v_mfma_f32_16x16x32_bf16 v[88:91], v[200:203], v[28:31], v[88:91]
    v_mfma_f32_16x16x32_bf16 v[92:95], v[204:207], v[28:31], v[92:95]
    v_mfma_f32_16x16x32_bf16 v[80:83], v[208:211], v[32:35], v[80:83]
    v_mfma_f32_16x16x32_bf16 v[84:87], v[212:215], v[32:35], v[84:87]
    v_mfma_f32_16x16x32_bf16 v[88:91], v[208:211], v[36:39], v[88:91]
    v_mfma_f32_16x16x32_bf16 v[92:95], v[212:215], v[36:39], v[92:95]
    v_mfma_f32_16x16x32_bf16 v[80:83], v[216:219], v[40:43], v[80:83]
    v_mfma_f32_16x16x32_bf16 v[84:87], v[220:223], v[40:43], v[84:87]
    v_mfma_f32_16x16x32_bf16 v[88:91], v[216:219], v[44:47], v[88:91]
    v_mfma_f32_16x16x32_bf16 v[92:95], v[220:223], v[44:47], v[92:95]
    s_waitcnt lgkmcnt(0)
    v_mfma_f32_16x16x32_bf16 v[80:83], v[224:227], v[48:51], v[80:83]
    v_mfma_f32_16x16x32_bf16 v[84:87], v[228:231], v[48:51], v[84:87]
    v_mfma_f32_16x16x32_bf16 v[88:91], v[224:227], v[52:55], v[88:91]
    v_mfma_f32_16x16x32_bf16 v[92:95], v[228:231], v[52:55], v[92:95]
    v_mfma_f32_16x16x32_bf16 v[80:83], v[232:235], v[56:59], v[80:83]
    v_mfma_f32_16x16x32_bf16 v[84:87], v[236:239], v[56:59], v[84:87]
    v_mfma_f32_16x16x32_bf16 v[88:91], v[232:235], v[60:63], v[88:91]
    v_mfma_f32_16x16x32_bf16 v[92:95], v[236:239], v[60:63], v[92:95]
    v_mfma_f32_16x16x32_bf16 v[80:83], v[240:243], v[64:67], v[80:83]
    v_mfma_f32_16x16x32_bf16 v[84:87], v[244:247], v[64:67], v[84:87]
    v_mfma_f32_16x16x32_bf16 v[88:91], v[240:243], v[68:71], v[88:91]
    v_mfma_f32_16x16x32_bf16 v[92:95], v[244:247], v[68:71], v[92:95]
    v_mfma_f32_16x16x32_bf16 v[80:83], v[248:251], v[72:75], v[80:83]
    v_mfma_f32_16x16x32_bf16 v[84:87], v[252:255], v[72:75], v[84:87]
    v_mfma_f32_16x16x32_bf16 v[88:91], v[248:251], v[76:79], v[88:91]
    v_mfma_f32_16x16x32_bf16 v[92:95], v[252:255], v[76:79], v[92:95]
    s_nop 7
    v_cvt_pk_bf16_f32 v96, v80, v84
    v_cvt_pk_bf16_f32 v97, v81, v85
    v_cvt_pk_bf16_f32 v98, v82, v86
    v_cvt_pk_bf16_f32 v99, v83, v87
    v_cvt_pk_bf16_f32 v100, v88, v92
    v_cvt_pk_bf16_f32 v101, v89, v93
    v_cvt_pk_bf16_f32 v102, v90, v94
    v_cvt_pk_bf16_f32 v103, v91, v95
    s_add_u32 s48, s50, 4096
    buffer_store_dwordx4 v[96:99], v4, s[4:7], s50 offen sc1
    buffer_store_dwordx4 v[100:103], v4, s[4:7], s48 offen sc1
    s_add_u32 s50, s50, 0x80000
    s_add_u32 s51, s51, 1
    s_branch L_pjK_loop
L_pjV:
    s_lshl_b32 s48, s29, 11
    s_add_u32 s50, s50, s48
L_pjV_loop:
    s_waitcnt vmcnt(0)
    s_barrier
    s_cmp_lg_u32 s29, 0
    s_cbranch_scc1 L_pjV_nf
    s_cmp_eq_u32 s43, 2
    s_cbranch_scc1 L_pjV_nf
    s_mov_b64 exec, 1
    v_mov_b32 v8, s51
    buffer_store_byte v8, off, s[4:7], s53 sc1
    s_mov_b64 exec, -1
L_pjV_nf:
    s_cmp_eq_u32 s51, 32
    s_cbranch_scc1 L_pj_done
    s_cmp_eq_u32 s51, 31
    s_cbranch_scc1 L_pjV_nd
    s_add_u32 m0, s49, 0
    s_nop 0
    buffer_load_dwordx4 v5, s[16:19], s47 offen offset:0 lds
    s_add_u32 m0, s49, 960
    s_nop 0
    buffer_load_dwordx4 v5, s[16:19], s47 offen offset:64 lds
    s_add_u32 m0, s49, 1920
    s_nop 0
    buffer_load_dwordx4 v5, s[16:19], s47 offen offset:128 lds
    s_add_u32 m0, s49, 2880
    s_nop 0
    buffer_load_dwordx4 v5, s[16:19], s47 offen offset:192 lds
    s_add_u32 m0, s49, 3840
    s_nop 0
    buffer_load_dwordx4 v5, s[16:19], s47 offen offset:256 lds
    s_add_u32 m0, s49, 4800
    s_nop 0
    buffer_load_dwordx4 v5, s[16:19], s47 offen offset:320 lds
    s_add_u32 m0, s49, 5760
    s_nop 0
    buffer_load_dwordx4 v5, s[16:19], s47 offen offset:384 lds
    s_add_u32 m0, s49, 6720
    s_nop 0
    buffer_load_dwordx4 v5, s[16:19], s47 offen offset:448 lds
    s_add_u32 s47, s47, 0x10000
    s_xor_b32 s49, s49, 0x8000
L_pjV_nd:
    v_add_u32 v7, s52, v4
    s_xor_b32 s52, s52, 0x8000
    ds_read_b128 v[16:19], v7 offset:0
    ds_read_b128 v[20:23], v7 offset:16384
    ds_read_b128 v[24:27], v7 offset:1024
    ds_read_b128 v[28:31], v7 offset:17408
    ds_read_b128 v[32:35], v7 offset:2048
    ds_read_b128 v[36:39], v7 offset:18432
    ds_read_b128 v[40:43], v7 offset:3072
    ds_read_b128 v[44:47], v7 offset:19456
    ds_read_b128 v[48:51], v7 offset:4096
    ds_read_b128 v[52:55], v7 offset:20480
    ds_read_b128 v[56:59], v7 offset:5120
    ds_read_b128 v[60:63], v7 offset:21504
    ds_read_b128 v[64:67], v7 offset:6144
    ds_read_b128 v[68:71], v7 offset:22528
    ds_read_b128 v[72:75], v7 offset:7168
    ds_read_b128 v[76:79], v7 offset:23552
    s_waitcnt lgkmcnt(8)
    v_mfma_f32_16x16x32_bf16 v[80:83], v[16:19], v[128:131], 0
    v_mfma_f32_16x16x32_bf16 v[84:87], v[16:19], v[132:135], 0
    v_mfma_f32_16x16x32_bf16 v[88:91], v[20:23], v[128:131], 0
    v_mfma_f32_16x16x32_bf16 v[92:95], v[20:23], v[132:135], 0
    v_mfma_f32_16x16x32_bf16 v[80:83], v[24:27], v[136:139], v[80:83]
    v_mfma_f32_16x16x32_bf16 v[84:87], v[24:27], v[140:143], v[84:87]
    v_mfma_f32_16x16x32_bf16 v[88:91], v[28:31], v[136:139], v[88:91]
    v_mfma_f32_16x16x32_bf16 v[92:95], v[28:31], v[140:143], v[92:95]
    v_mfma_f32_16x16x32_bf16 v[80:83], v[32:35], v[144:147], v[80:83]
    v_mfma_f32_16x16x32_bf16 v[84:87], v[32:35], v[148:151], v[84:87]
    v_mfma_f32_16x16x32_bf16 v[88:91], v[36:39], v[144:147], v[88:91]
    v_mfma_f32_16x16x32_bf16 v[92:95], v[36:39], v[148:151], v[92:95]
    v_mfma_f32_16x16x32_bf16 v[80:83], v[40:43], v[152:155], v[80:83]
    v_mfma_f32_16x16x32_bf16 v[84:87], v[40:43], v[156:159], v[84:87]
    v_mfma_f32_16x16x32_bf16 v[88:91], v[44:47], v[152:155], v[88:91]
    v_mfma_f32_16x16x32_bf16 v[92:95], v[44:47], v[156:159], v[92:95]
    ds_read_b128 v[16:19], v7 offset:8192
    ds_read_b128 v[20:23], v7 offset:24576
    ds_read_b128 v[24:27], v7 offset:9216
    ds_read_b128 v[28:31], v7 offset:25600
    ds_read_b128 v[32:35], v7 offset:10240
    ds_read_b128 v[36:39], v7 offset:26624
    ds_read_b128 v[40:43], v7 offset:11264
    ds_read_b128 v[44:47], v7 offset:27648
    s_waitcnt lgkmcnt(8)
    v_mfma_f32_16x16x32_bf16 v[80:83], v[48:51], v[160:163], v[80:83]
    v_mfma_f32_16x16x32_bf16 v[84:87], v[48:51], v[164:167], v[84:87]
    v_mfma_f32_16x16x32_bf16 v[88:91], v[52:55], v[160:163], v[88:91]
    v_mfma_f32_16x16x32_bf16 v[92:95], v[52:55], v[164:167], v[92:95]
    v_mfma_f32_16x16x32_bf16 v[80:83], v[56:59], v[168:171], v[80:83]
    v_mfma_f32_16x16x32_bf16 v[84:87], v[56:59], v[172:175], v[84:87]
    v_mfma_f32_16x16x32_bf16 v[88:91], v[60:63], v[168:171], v[88:91]
    v_mfma_f32_16x16x32_bf16 v[92:95], v[60:63], v[172:175], v[92:95]
    v_mfma_f32_16x16x32_bf16 v[80:83], v[64:67], v[176:179], v[80:83]
    v_mfma_f32_16x16x32_bf16 v[84:87], v[64:67], v[180:183], v[84:87]
    v_mfma_f32_16x16x32_bf16 v[88:91], v[68:71], v[176:179], v[88:91]
    v_mfma_f32_16x16x32_bf16 v[92:95], v[68:71], v[180:183], v[92:95]
    v_mfma_f32_16x16x32_bf16 v[80:83], v[72:75], v[184:187], v[80:83]
    v_mfma_f32_16x16x32_bf16 v[84:87], v[72:75], v[188:191], v[84:87]
    v_mfma_f32_16x16x32_bf16 v[88:91], v[76:79], v[184:187], v[88:91]
    v_mfma_f32_16x16x32_bf16 v[92:95], v[76:79], v[188:191], v[92:95]
    ds_read_b128 v[48:51], v7 offset:12288
    ds_read_b128 v[52:55], v7 offset:28672
    ds_read_b128 v[56:59], v7 offset:13312
    ds_read_b128 v[60:63], v7 offset:29696
    ds_read_b128 v[64:67], v7 offset:14336
    ds_read_b128 v[68:71], v7 offset:30720
    ds_read_b128 v[72:75], v7 offset:15360
    ds_read_b128 v[76:79], v7 offset:31744
    s_waitcnt lgkmcnt(8)
    v_mfma_f32_16x16x32_bf16 v[80:83], v[16:19], v[192:195], v[80:83]
    v_mfma_f32_16x16x32_bf16 v[84:87], v[16:19], v[196:199], v[84:87]
    v_mfma_f32_16x16x32_bf16 v[88:91], v[20:23], v[192:195], v[88:91]
    v_mfma_f32_16x16x32_bf16 v[92:95], v[20:23], v[196:199], v[92:95]
    v_mfma_f32_16x16x32_bf16 v[80:83], v[24:27], v[200:203], v[80:83]
    v_mfma_f32_16x16x32_bf16 v[84:87], v[24:27], v[204:207], v[84:87]
    v_mfma_f32_16x16x32_bf16 v[88:91], v[28:31], v[200:203], v[88:91]
    v_mfma_f32_16x16x32_bf16 v[92:95], v[28:31], v[204:207], v[92:95]
    v_mfma_f32_16x16x32_bf16 v[80:83], v[32:35], v[208:211], v[80:83]
    v_mfma_f32_16x16x32_bf16 v[84:87], v[32:35], v[212:215], v[84:87]
    v_mfma_f32_16x16x32_bf16 v[88:91], v[36:39], v[208:211], v[88:91]
    v_mfma_f32_16x16x32_bf16 v[92:95], v[36:39], v[212:215], v[92:95]
    v_mfma_f32_16x16x32_bf16 v[80:83], v[40:43], v[216:219], v[80:83]
    v_mfma_f32_16x16x32_bf16 v[84:87], v[40:43], v[220:223], v[84:87]
    v_mfma_f32_16x16x32_bf16 v[88:91], v[44:47], v[216:219], v[88:91]
    v_mfma_f32_16x16x32_bf16 v[92:95], v[44:47], v[220:223], v[92:95]
    s_waitcnt lgkmcnt(0)
    v_mfma_f32_16x16x32_bf16 v[80:83], v[48:51], v[224:227], v[80:83]
    v_mfma_f32_16x16x32_bf16 v[84:87], v[48:51], v[228:231], v[84:87]
    v_mfma_f32_16x16x32_bf16 v[88:91], v[52:55], v[224:227], v[88:91]
    v_mfma_f32_16x16x32_bf16 v[92:95], v[52:55], v[228:231], v[92:95]
    v_mfma_f32_16x16x32_bf16 v[80:83], v[56:59], v[232:235], v[80:83]
    v_mfma_f32_16x16x32_bf16 v[84:87], v[56:59], v[236:239], v[84:87]
    v_mfma_f32_16x16x32_bf16 v[88:91], v[60:63], v[232:235], v[88:91]
    v_mfma_f32_16x16x32_bf16 v[92:95], v[60:63], v[236:239], v[92:95]
    v_mfma_f32_16x16x32_bf16 v[80:83], v[64:67], v[240:243], v[80:83]
    v_mfma_f32_16x16x32_bf16 v[84:87], v[64:67], v[244:247], v[84:87]
    v_mfma_f32_16x16x32_bf16 v[88:91], v[68:71], v[240:243], v[88:91]
    v_mfma_f32_16x16x32_bf16 v[92:95], v[68:71], v[244:247], v[92:95]
    v_mfma_f32_16x16x32_bf16 v[80:83], v[72:75], v[248:251], v[80:83]
    v_mfma_f32_16x16x32_bf16 v[84:87], v[72:75], v[252:255], v[84:87]
    v_mfma_f32_16x16x32_bf16 v[88:91], v[76:79], v[248:251], v[88:91]
    v_mfma_f32_16x16x32_bf16 v[92:95], v[76:79], v[252:255], v[92:95]
    s_nop 7
    v_cvt_pk_bf16_f32 v96, v80, v81
    v_cvt_pk_bf16_f32 v97, v82, v83
    v_cvt_pk_bf16_f32 v98, v88, v89
    v_cvt_pk_bf16_f32 v99, v90, v91
    v_cvt_pk_bf16_f32 v100, v84, v85
    v_cvt_pk_bf16_f32 v101, v86, v87
    v_cvt_pk_bf16_f32 v102, v92, v93
    v_cvt_pk_bf16_f32 v103, v94, v95
    buffer_store_dwordx4 v[96:99], v4, s[4:7], s50 offen sc1
    buffer_store_dwordx4 v[100:103], v4, s[4:7], s50 offen offset:1024 sc1
    s_add_u32 s50, s50, 0x80000
    s_add_u32 s51, s51, 1
    s_branch L_pjV_loop
L_pj_done:
    s_cmp_lg_u32 s29, 0
    s_cbranch_scc1 L_second
    s_mov_b64 exec, 1
    v_mov_b32 v8, 1
    buffer_atomic_add v8, off, s[8:11], 0 offset:36
    s_mov_b64 exec, -1
    s_branch L_second
L_second:
    s_sub_u32 s40, s30, 32
    s_cmp_lt_u32 s40, 64
    s_cbranch_scc1 L_oproj
    s_sub_u32 s40, s40, 64
    s_cmp_lt_u32 s40, 32
    s_cbranch_scc1 L_attn
    s_add_u32 s40, s40, 32
    s_cmp_lt_u32 s40, 128
    s_cbranch_scc1 L_oproj
    s_sub_u32 s40, s40, 128
    s_load_dwordx2 s[12:13], s[0:1], 64
    s_mov_b32 s14, 0x200000
    s_mov_b32 s15, 0x00020000
    s_load_dwordx2 s[16:17], s[0:1], 72
    s_mov_b32 s18, 0x200000
    s_mov_b32 s19, 0x00020000
    s_load_dwordx2 s[20:21], s[0:1], 56
    s_mov_b32 s22, 0x200000
    s_mov_b32 s23, 0x00020000
    s_load_dwordx2 s[24:25], s[0:1], 104
    s_mov_b32 s26, 0x400000
    s_mov_b32 s27, 0x00020000
    s_load_dwordx2 s[32:33], s[0:1], 88
    s_mov_b32 s34, 0x200000
    s_mov_b32 s35, 0x00020000
    s_load_dwordx2 s[36:37], s[0:1], 80
    s_load_dwordx2 s[38:39], s[0:1], 96
    s_lshl_b32 s41, s40, 6
    s_lshl_b32 s42, s40, 4
    s_mov_b32 s43, 0xffff0000
    v_lshlrev_b32 v2, 13, v0
    v_add_u32 v2, s42, v2
    v_subrev_u32 v1, 3072, v2
    v_add_u32 v3, 4096, v2
    s_waitcnt lgkmcnt(0)
    s_load_dwordx16 s[44:59], s[36:37], s41
    s_load_dwordx4 s[60:63], s[38:39], s42
    buffer_load_dwordx4 v[16:19], v1, s[12:15], 0 offen offset:0
    buffer_load_dwordx4 v[20:23], v1, s[12:15], 0 offen offset:1024
    buffer_load_dwordx4 v[24:27], v1, s[12:15], 0 offen offset:2048
    buffer_load_dwordx4 v[28:31], v2, s[12:15], 0 offen offset:0
    buffer_load_dwordx4 v[32:35], v2, s[12:15], 0 offen offset:1024
    buffer_load_dwordx4 v[36:39], v2, s[12:15], 0 offen offset:2048
    buffer_load_dwordx4 v[40:43], v2, s[12:15], 0 offen offset:3072
    buffer_load_dwordx4 v[44:47], v3, s[12:15], 0 offen offset:0
    buffer_load_dwordx4 v[48:51], v3, s[12:15], 0 offen offset:1024
    buffer_load_dwordx4 v[52:55], v3, s[12:15], 0 offen offset:2048
    buffer_load_dwordx4 v[56:59], v3, s[12:15], 0 offen offset:3072
    buffer_load_dwordx4 v[64:67], v2, s[16:19], 0 offen offset:0
    buffer_load_dwordx4 v[68:71], v2, s[16:19], 0 offen offset:1024
    buffer_load_dwordx4 v[72:75], v2, s[16:19], 0 offen offset:2048
    buffer_load_dwordx4 v[76:79], v2, s[16:19], 0 offen offset:3072
    buffer_load_dwordx4 v[80:83], v3, s[16:19], 0 offen offset:0
    buffer_load_dwordx4 v[84:87], v3, s[16:19], 0 offen offset:1024
    buffer_load_dwordx4 v[88:91], v3, s[16:19], 0 offen offset:2048
    buffer_load_dwordx4 v[92:95], v3, s[16:19], 0 offen offset:3072
    buffer_load_dwordx4 v[128:131], v2, s[20:23], 0 offen offset:0
    buffer_load_dwordx4 v[132:135], v2, s[20:23], 0 offen offset:1024
    buffer_load_dwordx4 v[136:139], v2, s[20:23], 0 offen offset:2048
    buffer_load_dwordx4 v[140:143], v2, s[20:23], 0 offen offset:3072
    buffer_load_dwordx4 v[144:147], v3, s[20:23], 0 offen offset:0
    buffer_load_dwordx4 v[148:151], v3, s[20:23], 0 offen offset:1024
    buffer_load_dwordx4 v[152:155], v3, s[20:23], 0 offen offset:2048
    buffer_load_dwordx4 v[156:159], v3, s[20:23], 0 offen offset:3072
    s_barrier
    v_mov_b32 v8, 0
    v_mov_b32 v9, 0
    v_mov_b32 v10, 0
    v_mov_b32 v11, 0
    v_lshlrev_b32 v4, 4, v0
    v_cmp_gt_u32 vcc, 160, v0
    s_and_saveexec_b64 s[64:65], vcc
    s_cbranch_execz L_cv_nz
    ds_write_b128 v4, v[8:11] offset:2560
    ds_write_b128 v4, v[8:11] offset:10240
    ds_write_b128 v4, v[8:11] offset:17920
    ds_write_b128 v4, v[8:11] offset:25600
    ds_write_b128 v4, v[8:11] offset:33280
    ds_write_b128 v4, v[8:11] offset:40960
    ds_write_b128 v4, v[8:11] offset:48640
    ds_write_b128 v4, v[8:11] offset:56320
L_cv_nz:
    s_mov_b64 exec, s[64:65]
    v_lshrrev_b32 v4, 2, v0
    v_mul_u32_u24 v4, 80, v4
    v_and_b32 v5, 3, v0
    v_lshl_add_u32 v6, v5, 4, v4
    v_xor_b32 v5, 3, v5
    v_lshl_add_u32 v5, v5, 4, v4
    s_waitcnt lgkmcnt(0)
    s_lshl_b32 s64, s44, 16
    s_and_b32 s65, s44, s43
    s_lshl_b32 s66, s45, 16
    s_and_b32 s67, s45, s43
    s_lshl_b32 s68, s46, 16
    s_and_b32 s69, s46, s43
    s_lshl_b32 s70, s47, 16
    s_and_b32 s71, s47, s43
    s_lshl_b32 s72, s48, 16
    s_and_b32 s73, s48, s43
    s_lshl_b32 s74, s49, 16
    s_and_b32 s75, s49, s43
    s_lshl_b32 s76, s50, 16
    s_and_b32 s77, s50, s43
    s_lshl_b32 s78, s51, 16
    s_and_b32 s79, s51, s43
    s_lshl_b32 s80, s52, 16
    s_and_b32 s81, s52, s43
    s_lshl_b32 s82, s53, 16
    s_and_b32 s83, s53, s43
    s_lshl_b32 s84, s54, 16
    s_and_b32 s85, s54, s43
    s_lshl_b32 s86, s55, 16
    s_and_b32 s87, s55, s43
    s_lshl_b32 s88, s56, 16
    s_and_b32 s89, s56, s43
    s_lshl_b32 s90, s57, 16
    s_and_b32 s91, s57, s43
    s_lshl_b32 s92, s58, 16
    s_and_b32 s93, s58, s43
    s_lshl_b32 s94, s59, 16
    s_and_b32 s95, s59, s43
    s_lshl_b32 s44, s60, 16
    s_and_b32 s45, s60, s43
    s_lshl_b32 s46, s61, 16
    s_and_b32 s47, s61, s43
    s_lshl_b32 s48, s62, 16
    s_and_b32 s49, s62, s43
    s_lshl_b32 s50, s63, 16
    s_and_b32 s51, s63, s43
    s_waitcnt vmcnt(8)
    v_lshlrev_b32 v176, 16, v16
    v_and_b32 v177, s43, v16
    v_lshlrev_b32 v178, 16, v20
    v_and_b32 v179, s43, v20
    v_lshlrev_b32 v180, 16, v24
    v_and_b32 v181, s43, v24
    v_lshlrev_b32 v182, 16, v28
    v_and_b32 v183, s43, v28
    v_lshlrev_b32 v184, 16, v32
    v_and_b32 v185, s43, v32
    v_lshlrev_b32 v186, 16, v36
    v_and_b32 v187, s43, v36
    v_lshlrev_b32 v188, 16, v40
    v_and_b32 v189, s43, v40
    v_lshlrev_b32 v190, 16, v44
    v_and_b32 v191, s43, v44
    v_lshlrev_b32 v192, 16, v48
    v_and_b32 v193, s43, v48
    v_lshlrev_b32 v194, 16, v52
    v_and_b32 v195, s43, v52
    v_lshlrev_b32 v196, 16, v56
    v_and_b32 v197, s43, v56
    v_mul_f32 v200, s67, v176
    v_mul_f32 v201, s71, v177
    v_mul_f32 v202, s67, v178
    v_mul_f32 v203, s71, v179
    v_mul_f32 v204, s67, v180
    v_mul_f32 v205, s71, v181
    v_mul_f32 v206, s67, v182
    v_mul_f32 v207, s71, v183
    v_mul_f32 v208, s67, v184
    v_mul_f32 v209, s71, v185
    v_mul_f32 v210, s67, v186
    v_mul_f32 v211, s71, v187
    v_mul_f32 v212, s67, v188
    v_mul_f32 v213, s71, v189
    v_mul_f32 v214, s67, v190
    v_mul_f32 v215, s71, v191
    v_cvt_pk_bf16_f32 v201, v200, v201
    v_lshlrev_b32 v200, 16, v201
    v_and_b32 v201, s43, v201
    v_cvt_pk_bf16_f32 v203, v202, v203
    v_lshlrev_b32 v202, 16, v203
    v_and_b32 v203, s43, v203
    v_cvt_pk_bf16_f32 v205, v204, v205
    v_lshlrev_b32 v204, 16, v205
    v_and_b32 v205, s43, v205
    v_cvt_pk_bf16_f32 v207, v206, v207
    v_lshlrev_b32 v206, 16, v207
    v_and_b32 v207, s43, v207
    v_cvt_pk_bf16_f32 v209, v208, v209
    v_lshlrev_b32 v208, 16, v209
    v_and_b32 v209, s43, v209
    v_cvt_pk_bf16_f32 v211, v210, v211
    v_lshlrev_b32 v210, 16, v211
    v_and_b32 v211, s43, v211
    v_cvt_pk_bf16_f32 v213, v212, v213
    v_lshlrev_b32 v212, 16, v213
    v_and_b32 v213, s43, v213
    v_cvt_pk_bf16_f32 v215, v214, v215
    v_lshlrev_b32 v214, 16, v215
    v_and_b32 v215, s43, v215
    v_mul_f32 v216, s66, v178
    v_mul_f32 v217, s70, v179
    v_mul_f32 v218, s66, v180
    v_mul_f32 v219, s70, v181
    v_mul_f32 v220, s66, v182
    v_mul_f32 v221, s70, v183
    v_mul_f32 v222, s66, v184
    v_mul_f32 v223, s70, v185
    v_mul_f32 v224, s66, v186
    v_mul_f32 v225, s70, v187
    v_mul_f32 v226, s66, v188
    v_mul_f32 v227, s70, v189
    v_mul_f32 v228, s66, v190
    v_mul_f32 v229, s70, v191
    v_mul_f32 v230, s66, v192
    v_mul_f32 v231, s70, v193
    v_cvt_pk_bf16_f32 v217, v216, v217
    v_lshlrev_b32 v216, 16, v217
    v_and_b32 v217, s43, v217
    v_cvt_pk_bf16_f32 v219, v218, v219
    v_lshlrev_b32 v218, 16, v219
    v_and_b32 v219, s43, v219
    v_cvt_pk_bf16_f32 v221, v220, v221
    v_lshlrev_b32 v220, 16, v221
    v_and_b32 v221, s43, v221
    v_cvt_pk_bf16_f32 v223, v222, v223
    v_lshlrev_b32 v222, 16, v223
    v_and_b32 v223, s43, v223
    v_cvt_pk_bf16_f32 v225, v224, v225
    v_lshlrev_b32 v224, 16, v225
    v_and_b32 v225, s43, v225
    v_cvt_pk_bf16_f32 v227, v226, v227
    v_lshlrev_b32 v226, 16, v227
    v_and_b32 v227, s43, v227
    v_cvt_pk_bf16_f32 v229, v228, v229
    v_lshlrev_b32 v228, 16, v229
    v_and_b32 v229, s43, v229
    v_cvt_pk_bf16_f32 v231, v230, v231
    v_lshlrev_b32 v230, 16, v231
    v_and_b32 v231, s43, v231
    v_add_f32 v200, v200, v216
    v_add_f32 v201, v201, v217
    v_add_f32 v202, v202, v218
    v_add_f32 v203, v203, v219
    v_add_f32 v204, v204, v220
    v_add_f32 v205, v205, v221
    v_add_f32 v206, v206, v222
    v_add_f32 v207, v207, v223
    v_add_f32 v208, v208, v224
    v_add_f32 v209, v209, v225
    v_add_f32 v210, v210, v226
    v_add_f32 v211, v211, v227
    v_add_f32 v212, v212, v228
    v_add_f32 v213, v213, v229
    v_add_f32 v214, v214, v230
    v_add_f32 v215, v215, v231
    v_cvt_pk_bf16_f32 v201, v200, v201
    v_lshlrev_b32 v200, 16, v201
    v_and_b32 v201, s43, v201
    v_cvt_pk_bf16_f32 v203, v202, v203
    v_lshlrev_b32 v202, 16, v203
    v_and_b32 v203, s43, v203
    v_cvt_pk_bf16_f32 v205, v204, v205
    v_lshlrev_b32 v204, 16, v205
    v_and_b32 v205, s43, v205
    v_cvt_pk_bf16_f32 v207, v206, v207
    v_lshlrev_b32 v206, 16, v207
    v_and_b32 v207, s43, v207
    v_cvt_pk_bf16_f32 v209, v208, v209
    v_lshlrev_b32 v208, 16, v209
    v_and_b32 v209, s43, v209
    v_cvt_pk_bf16_f32 v211, v210, v211
    v_lshlrev_b32 v210, 16, v211
    v_and_b32 v211, s43, v211
    v_cvt_pk_bf16_f32 v213, v212, v213
    v_lshlrev_b32 v212, 16, v213
    v_and_b32 v213, s43, v213
    v_cvt_pk_bf16_f32 v215, v214, v215
    v_lshlrev_b32 v214, 16, v215
    v_and_b32 v215, s43, v215
    v_mul_f32 v216, s65, v180
    v_mul_f32 v217, s69, v181
    v_mul_f32 v218, s65, v182
    v_mul_f32 v219, s69, v183
    v_mul_f32 v220, s65, v184
    v_mul_f32 v221, s69, v185
    v_mul_f32 v222, s65, v186
    v_mul_f32 v223, s69, v187
    v_mul_f32 v224, s65, v188
    v_mul_f32 v225, s69, v189
    v_mul_f32 v226, s65, v190
    v_mul_f32 v227, s69, v191
    v_mul_f32 v228, s65, v192
    v_mul_f32 v229, s69, v193
    v_mul_f32 v230, s65, v194
    v_mul_f32 v231, s69, v195
    v_cvt_pk_bf16_f32 v217, v216, v217
    v_lshlrev_b32 v216, 16, v217
    v_and_b32 v217, s43, v217
    v_cvt_pk_bf16_f32 v219, v218, v219
    v_lshlrev_b32 v218, 16, v219
    v_and_b32 v219, s43, v219
    v_cvt_pk_bf16_f32 v221, v220, v221
    v_lshlrev_b32 v220, 16, v221
    v_and_b32 v221, s43, v221
    v_cvt_pk_bf16_f32 v223, v222, v223
    v_lshlrev_b32 v222, 16, v223
    v_and_b32 v223, s43, v223
    v_cvt_pk_bf16_f32 v225, v224, v225
    v_lshlrev_b32 v224, 16, v225
    v_and_b32 v225, s43, v225
    v_cvt_pk_bf16_f32 v227, v226, v227
    v_lshlrev_b32 v226, 16, v227
    v_and_b32 v227, s43, v227
    v_cvt_pk_bf16_f32 v229, v228, v229
    v_lshlrev_b32 v228, 16, v229
    v_and_b32 v229, s43, v229
    v_cvt_pk_bf16_f32 v231, v230, v231
    v_lshlrev_b32 v230, 16, v231
    v_and_b32 v231, s43, v231
    v_add_f32 v200, v200, v216
    v_add_f32 v201, v201, v217
    v_add_f32 v202, v202, v218
    v_add_f32 v203, v203, v219
    v_add_f32 v204, v204, v220
    v_add_f32 v205, v205, v221
    v_add_f32 v206, v206, v222
    v_add_f32 v207, v207, v223
    v_add_f32 v208, v208, v224
    v_add_f32 v209, v209, v225
    v_add_f32 v210, v210, v226
    v_add_f32 v211, v211, v227
    v_add_f32 v212, v212, v228
    v_add_f32 v213, v213, v229
    v_add_f32 v214, v214, v230
    v_add_f32 v215, v215, v231
    v_cvt_pk_bf16_f32 v201, v200, v201
    v_lshlrev_b32 v200, 16, v201
    v_and_b32 v201, s43, v201
    v_cvt_pk_bf16_f32 v203, v202, v203
    v_lshlrev_b32 v202, 16, v203
    v_and_b32 v203, s43, v203
    v_cvt_pk_bf16_f32 v205, v204, v205
    v_lshlrev_b32 v204, 16, v205
    v_and_b32 v205, s43, v205
    v_cvt_pk_bf16_f32 v207, v206, v207
    v_lshlrev_b32 v206, 16, v207
    v_and_b32 v207, s43, v207
    v_cvt_pk_bf16_f32 v209, v208, v209
    v_lshlrev_b32 v208, 16, v209
    v_and_b32 v209, s43, v209
    v_cvt_pk_bf16_f32 v211, v210, v211
    v_lshlrev_b32 v210, 16, v211
    v_and_b32 v211, s43, v211
    v_cvt_pk_bf16_f32 v213, v212, v213
    v_lshlrev_b32 v212, 16, v213
    v_and_b32 v213, s43, v213
    v_cvt_pk_bf16_f32 v215, v214, v215
    v_lshlrev_b32 v214, 16, v215
    v_and_b32 v215, s43, v215
    v_mul_f32 v216, s64, v182
    v_mul_f32 v217, s68, v183
    v_mul_f32 v218, s64, v184
    v_mul_f32 v219, s68, v185
    v_mul_f32 v220, s64, v186
    v_mul_f32 v221, s68, v187
    v_mul_f32 v222, s64, v188
    v_mul_f32 v223, s68, v189
    v_mul_f32 v224, s64, v190
    v_mul_f32 v225, s68, v191
    v_mul_f32 v226, s64, v192
    v_mul_f32 v227, s68, v193
    v_mul_f32 v228, s64, v194
    v_mul_f32 v229, s68, v195
    v_mul_f32 v230, s64, v196
    v_mul_f32 v231, s68, v197
    v_cvt_pk_bf16_f32 v217, v216, v217
    v_lshlrev_b32 v216, 16, v217
    v_and_b32 v217, s43, v217
    v_cvt_pk_bf16_f32 v219, v218, v219
    v_lshlrev_b32 v218, 16, v219
    v_and_b32 v219, s43, v219
    v_cvt_pk_bf16_f32 v221, v220, v221
    v_lshlrev_b32 v220, 16, v221
    v_and_b32 v221, s43, v221
    v_cvt_pk_bf16_f32 v223, v222, v223
    v_lshlrev_b32 v222, 16, v223
    v_and_b32 v223, s43, v223
    v_cvt_pk_bf16_f32 v225, v224, v225
    v_lshlrev_b32 v224, 16, v225
    v_and_b32 v225, s43, v225
    v_cvt_pk_bf16_f32 v227, v226, v227
    v_lshlrev_b32 v226, 16, v227
    v_and_b32 v227, s43, v227
    v_cvt_pk_bf16_f32 v229, v228, v229
    v_lshlrev_b32 v228, 16, v229
    v_and_b32 v229, s43, v229
    v_cvt_pk_bf16_f32 v231, v230, v231
    v_lshlrev_b32 v230, 16, v231
    v_and_b32 v231, s43, v231
    v_add_f32 v200, v200, v216
    v_add_f32 v201, v201, v217
    v_add_f32 v202, v202, v218
    v_add_f32 v203, v203, v219
    v_add_f32 v204, v204, v220
    v_add_f32 v205, v205, v221
    v_add_f32 v206, v206, v222
    v_add_f32 v207, v207, v223
    v_add_f32 v208, v208, v224
    v_add_f32 v209, v209, v225
    v_add_f32 v210, v210, v226
    v_add_f32 v211, v211, v227
    v_add_f32 v212, v212, v228
    v_add_f32 v213, v213, v229
    v_add_f32 v214, v214, v230
    v_add_f32 v215, v215, v231
    v_cvt_pk_bf16_f32 v201, v200, v201
    v_lshlrev_b32 v200, 16, v201
    v_and_b32 v201, s43, v201
    v_cvt_pk_bf16_f32 v203, v202, v203
    v_lshlrev_b32 v202, 16, v203
    v_and_b32 v203, s43, v203
    v_cvt_pk_bf16_f32 v205, v204, v205
    v_lshlrev_b32 v204, 16, v205
    v_and_b32 v205, s43, v205
    v_cvt_pk_bf16_f32 v207, v206, v207
    v_lshlrev_b32 v206, 16, v207
    v_and_b32 v207, s43, v207
    v_cvt_pk_bf16_f32 v209, v208, v209
    v_lshlrev_b32 v208, 16, v209
    v_and_b32 v209, s43, v209
    v_cvt_pk_bf16_f32 v211, v210, v211
    v_lshlrev_b32 v210, 16, v211
    v_and_b32 v211, s43, v211
    v_cvt_pk_bf16_f32 v213, v212, v213
    v_lshlrev_b32 v212, 16, v213
    v_and_b32 v213, s43, v213
    v_cvt_pk_bf16_f32 v215, v214, v215
    v_lshlrev_b32 v214, 16, v215
    v_and_b32 v215, s43, v215
    v_lshlrev_b32 v216, 16, v64
    v_and_b32 v217, s43, v64
    v_lshlrev_b32 v218, 16, v68
    v_and_b32 v219, s43, v68
    v_lshlrev_b32 v220, 16, v72
    v_and_b32 v221, s43, v72
    v_lshlrev_b32 v222, 16, v76
    v_and_b32 v223, s43, v76
    v_lshlrev_b32 v224, 16, v80
    v_and_b32 v225, s43, v80
    v_lshlrev_b32 v226, 16, v84
    v_and_b32 v227, s43, v84
    v_lshlrev_b32 v228, 16, v88
    v_and_b32 v229, s43, v88
    v_lshlrev_b32 v230, 16, v92
    v_and_b32 v231, s43, v92
    v_mul_f32 v200, v200, v216
    v_mul_f32 v201, v201, v217
    v_mul_f32 v202, v202, v218
    v_mul_f32 v203, v203, v219
    v_mul_f32 v204, v204, v220
    v_mul_f32 v205, v205, v221
    v_mul_f32 v206, v206, v222
    v_mul_f32 v207, v207, v223
    v_mul_f32 v208, v208, v224
    v_mul_f32 v209, v209, v225
    v_mul_f32 v210, v210, v226
    v_mul_f32 v211, v211, v227
    v_mul_f32 v212, v212, v228
    v_mul_f32 v213, v213, v229
    v_mul_f32 v214, v214, v230
    v_mul_f32 v215, v215, v231
    v_cvt_pk_bf16_f32 v96, v214, v212
    v_cvt_pk_bf16_f32 v97, v210, v208
    v_cvt_pk_bf16_f32 v98, v206, v204
    v_cvt_pk_bf16_f32 v99, v202, v200
    ds_write_b128 v5, v[96:99] offset:5120
    v_cvt_pk_bf16_f32 v100, v215, v213
    v_cvt_pk_bf16_f32 v101, v211, v209
    v_cvt_pk_bf16_f32 v102, v207, v205
    v_cvt_pk_bf16_f32 v103, v203, v201
    ds_write_b128 v5, v[100:103] offset:12800
    v_lshlrev_b32 v176, 16, v17
    v_and_b32 v177, s43, v17
    v_lshlrev_b32 v178, 16, v21
    v_and_b32 v179, s43, v21
    v_lshlrev_b32 v180, 16, v25
    v_and_b32 v181, s43, v25
    v_lshlrev_b32 v182, 16, v29
    v_and_b32 v183, s43, v29
    v_lshlrev_b32 v184, 16, v33
    v_and_b32 v185, s43, v33
    v_lshlrev_b32 v186, 16, v37
    v_and_b32 v187, s43, v37
    v_lshlrev_b32 v188, 16, v41
    v_and_b32 v189, s43, v41
    v_lshlrev_b32 v190, 16, v45
    v_and_b32 v191, s43, v45
    v_lshlrev_b32 v192, 16, v49
    v_and_b32 v193, s43, v49
    v_lshlrev_b32 v194, 16, v53
    v_and_b32 v195, s43, v53
    v_lshlrev_b32 v196, 16, v57
    v_and_b32 v197, s43, v57
    v_mul_f32 v200, s75, v176
    v_mul_f32 v201, s79, v177
    v_mul_f32 v202, s75, v178
    v_mul_f32 v203, s79, v179
    v_mul_f32 v204, s75, v180
    v_mul_f32 v205, s79, v181
    v_mul_f32 v206, s75, v182
    v_mul_f32 v207, s79, v183
    v_mul_f32 v208, s75, v184
    v_mul_f32 v209, s79, v185
    v_mul_f32 v210, s75, v186
    v_mul_f32 v211, s79, v187
    v_mul_f32 v212, s75, v188
    v_mul_f32 v213, s79, v189
    v_mul_f32 v214, s75, v190
    v_mul_f32 v215, s79, v191
    v_cvt_pk_bf16_f32 v201, v200, v201
    v_lshlrev_b32 v200, 16, v201
    v_and_b32 v201, s43, v201
    v_cvt_pk_bf16_f32 v203, v202, v203
    v_lshlrev_b32 v202, 16, v203
    v_and_b32 v203, s43, v203
    v_cvt_pk_bf16_f32 v205, v204, v205
    v_lshlrev_b32 v204, 16, v205
    v_and_b32 v205, s43, v205
    v_cvt_pk_bf16_f32 v207, v206, v207
    v_lshlrev_b32 v206, 16, v207
    v_and_b32 v207, s43, v207
    v_cvt_pk_bf16_f32 v209, v208, v209
    v_lshlrev_b32 v208, 16, v209
    v_and_b32 v209, s43, v209
    v_cvt_pk_bf16_f32 v211, v210, v211
    v_lshlrev_b32 v210, 16, v211
    v_and_b32 v211, s43, v211
    v_cvt_pk_bf16_f32 v213, v212, v213
    v_lshlrev_b32 v212, 16, v213
    v_and_b32 v213, s43, v213
    v_cvt_pk_bf16_f32 v215, v214, v215
    v_lshlrev_b32 v214, 16, v215
    v_and_b32 v215, s43, v215
    v_mul_f32 v216, s74, v178
    v_mul_f32 v217, s78, v179
    v_mul_f32 v218, s74, v180
    v_mul_f32 v219, s78, v181
    v_mul_f32 v220, s74, v182
    v_mul_f32 v221, s78, v183
    v_mul_f32 v222, s74, v184
    v_mul_f32 v223, s78, v185
    v_mul_f32 v224, s74, v186
    v_mul_f32 v225, s78, v187
    v_mul_f32 v226, s74, v188
    v_mul_f32 v227, s78, v189
    v_mul_f32 v228, s74, v190
    v_mul_f32 v229, s78, v191
    v_mul_f32 v230, s74, v192
    v_mul_f32 v231, s78, v193
    v_cvt_pk_bf16_f32 v217, v216, v217
    v_lshlrev_b32 v216, 16, v217
    v_and_b32 v217, s43, v217
    v_cvt_pk_bf16_f32 v219, v218, v219
    v_lshlrev_b32 v218, 16, v219
    v_and_b32 v219, s43, v219
    v_cvt_pk_bf16_f32 v221, v220, v221
    v_lshlrev_b32 v220, 16, v221
    v_and_b32 v221, s43, v221
    v_cvt_pk_bf16_f32 v223, v222, v223
    v_lshlrev_b32 v222, 16, v223
    v_and_b32 v223, s43, v223
    v_cvt_pk_bf16_f32 v225, v224, v225
    v_lshlrev_b32 v224, 16, v225
    v_and_b32 v225, s43, v225
    v_cvt_pk_bf16_f32 v227, v226, v227
    v_lshlrev_b32 v226, 16, v227
    v_and_b32 v227, s43, v227
    v_cvt_pk_bf16_f32 v229, v228, v229
    v_lshlrev_b32 v228, 16, v229
    v_and_b32 v229, s43, v229
    v_cvt_pk_bf16_f32 v231, v230, v231
    v_lshlrev_b32 v230, 16, v231
    v_and_b32 v231, s43, v231
    v_add_f32 v200, v200, v216
    v_add_f32 v201, v201, v217
    v_add_f32 v202, v202, v218
    v_add_f32 v203, v203, v219
    v_add_f32 v204, v204, v220
    v_add_f32 v205, v205, v221
    v_add_f32 v206, v206, v222
    v_add_f32 v207, v207, v223
    v_add_f32 v208, v208, v224
    v_add_f32 v209, v209, v225
    v_add_f32 v210, v210, v226
    v_add_f32 v211, v211, v227
    v_add_f32 v212, v212, v228
    v_add_f32 v213, v213, v229
    v_add_f32 v214, v214, v230
    v_add_f32 v215, v215, v231
    v_cvt_pk_bf16_f32 v201, v200, v201
    v_lshlrev_b32 v200, 16, v201
    v_and_b32 v201, s43, v201
    v_cvt_pk_bf16_f32 v203, v202, v203
    v_lshlrev_b32 v202, 16, v203
    v_and_b32 v203, s43, v203
    v_cvt_pk_bf16_f32 v205, v204, v205
    v_lshlrev_b32 v204, 16, v205
    v_and_b32 v205, s43, v205
    v_cvt_pk_bf16_f32 v207, v206, v207
    v_lshlrev_b32 v206, 16, v207
    v_and_b32 v207, s43, v207
    v_cvt_pk_bf16_f32 v209, v208, v209
    v_lshlrev_b32 v208, 16, v209
    v_and_b32 v209, s43, v209
    v_cvt_pk_bf16_f32 v211, v210, v211
    v_lshlrev_b32 v210, 16, v211
    v_and_b32 v211, s43, v211
    v_cvt_pk_bf16_f32 v213, v212, v213
    v_lshlrev_b32 v212, 16, v213
    v_and_b32 v213, s43, v213
    v_cvt_pk_bf16_f32 v215, v214, v215
    v_lshlrev_b32 v214, 16, v215
    v_and_b32 v215, s43, v215
    v_mul_f32 v216, s73, v180
    v_mul_f32 v217, s77, v181
    v_mul_f32 v218, s73, v182
    v_mul_f32 v219, s77, v183
    v_mul_f32 v220, s73, v184
    v_mul_f32 v221, s77, v185
    v_mul_f32 v222, s73, v186
    v_mul_f32 v223, s77, v187
    v_mul_f32 v224, s73, v188
    v_mul_f32 v225, s77, v189
    v_mul_f32 v226, s73, v190
    v_mul_f32 v227, s77, v191
    v_mul_f32 v228, s73, v192
    v_mul_f32 v229, s77, v193
    v_mul_f32 v230, s73, v194
    v_mul_f32 v231, s77, v195
    v_cvt_pk_bf16_f32 v217, v216, v217
    v_lshlrev_b32 v216, 16, v217
    v_and_b32 v217, s43, v217
    v_cvt_pk_bf16_f32 v219, v218, v219
    v_lshlrev_b32 v218, 16, v219
    v_and_b32 v219, s43, v219
    v_cvt_pk_bf16_f32 v221, v220, v221
    v_lshlrev_b32 v220, 16, v221
    v_and_b32 v221, s43, v221
    v_cvt_pk_bf16_f32 v223, v222, v223
    v_lshlrev_b32 v222, 16, v223
    v_and_b32 v223, s43, v223
    v_cvt_pk_bf16_f32 v225, v224, v225
    v_lshlrev_b32 v224, 16, v225
    v_and_b32 v225, s43, v225
    v_cvt_pk_bf16_f32 v227, v226, v227
    v_lshlrev_b32 v226, 16, v227
    v_and_b32 v227, s43, v227
    v_cvt_pk_bf16_f32 v229, v228, v229
    v_lshlrev_b32 v228, 16, v229
    v_and_b32 v229, s43, v229
    v_cvt_pk_bf16_f32 v231, v230, v231
    v_lshlrev_b32 v230, 16, v231
    v_and_b32 v231, s43, v231
    v_add_f32 v200, v200, v216
    v_add_f32 v201, v201, v217
    v_add_f32 v202, v202, v218
    v_add_f32 v203, v203, v219
    v_add_f32 v204, v204, v220
    v_add_f32 v205, v205, v221
    v_add_f32 v206, v206, v222
    v_add_f32 v207, v207, v223
    v_add_f32 v208, v208, v224
    v_add_f32 v209, v209, v225
    v_add_f32 v210, v210, v226
    v_add_f32 v211, v211, v227
    v_add_f32 v212, v212, v228
    v_add_f32 v213, v213, v229
    v_add_f32 v214, v214, v230
    v_add_f32 v215, v215, v231
    v_cvt_pk_bf16_f32 v201, v200, v201
    v_lshlrev_b32 v200, 16, v201
    v_and_b32 v201, s43, v201
    v_cvt_pk_bf16_f32 v203, v202, v203
    v_lshlrev_b32 v202, 16, v203
    v_and_b32 v203, s43, v203
    v_cvt_pk_bf16_f32 v205, v204, v205
    v_lshlrev_b32 v204, 16, v205
    v_and_b32 v205, s43, v205
    v_cvt_pk_bf16_f32 v207, v206, v207
    v_lshlrev_b32 v206, 16, v207
    v_and_b32 v207, s43, v207
    v_cvt_pk_bf16_f32 v209, v208, v209
    v_lshlrev_b32 v208, 16, v209
    v_and_b32 v209, s43, v209
    v_cvt_pk_bf16_f32 v211, v210, v211
    v_lshlrev_b32 v210, 16, v211
    v_and_b32 v211, s43, v211
    v_cvt_pk_bf16_f32 v213, v212, v213
    v_lshlrev_b32 v212, 16, v213
    v_and_b32 v213, s43, v213
    v_cvt_pk_bf16_f32 v215, v214, v215
    v_lshlrev_b32 v214, 16, v215
    v_and_b32 v215, s43, v215
    v_mul_f32 v216, s72, v182
    v_mul_f32 v217, s76, v183
    v_mul_f32 v218, s72, v184
    v_mul_f32 v219, s76, v185
    v_mul_f32 v220, s72, v186
    v_mul_f32 v221, s76, v187
    v_mul_f32 v222, s72, v188
    v_mul_f32 v223, s76, v189
    v_mul_f32 v224, s72, v190
    v_mul_f32 v225, s76, v191
    v_mul_f32 v226, s72, v192
    v_mul_f32 v227, s76, v193
    v_mul_f32 v228, s72, v194
    v_mul_f32 v229, s76, v195
    v_mul_f32 v230, s72, v196
    v_mul_f32 v231, s76, v197
    v_cvt_pk_bf16_f32 v217, v216, v217
    v_lshlrev_b32 v216, 16, v217
    v_and_b32 v217, s43, v217
    v_cvt_pk_bf16_f32 v219, v218, v219
    v_lshlrev_b32 v218, 16, v219
    v_and_b32 v219, s43, v219
    v_cvt_pk_bf16_f32 v221, v220, v221
    v_lshlrev_b32 v220, 16, v221
    v_and_b32 v221, s43, v221
    v_cvt_pk_bf16_f32 v223, v222, v223
    v_lshlrev_b32 v222, 16, v223
    v_and_b32 v223, s43, v223
    v_cvt_pk_bf16_f32 v225, v224, v225
    v_lshlrev_b32 v224, 16, v225
    v_and_b32 v225, s43, v225
    v_cvt_pk_bf16_f32 v227, v226, v227
    v_lshlrev_b32 v226, 16, v227
    v_and_b32 v227, s43, v227
    v_cvt_pk_bf16_f32 v229, v228, v229
    v_lshlrev_b32 v228, 16, v229
    v_and_b32 v229, s43, v229
    v_cvt_pk_bf16_f32 v231, v230, v231
    v_lshlrev_b32 v230, 16, v231
    v_and_b32 v231, s43, v231
    v_add_f32 v200, v200, v216
    v_add_f32 v201, v201, v217
    v_add_f32 v202, v202, v218
    v_add_f32 v203, v203, v219
    v_add_f32 v204, v204, v220
    v_add_f32 v205, v205, v221
    v_add_f32 v206, v206, v222
    v_add_f32 v207, v207, v223
    v_add_f32 v208, v208, v224
    v_add_f32 v209, v209, v225
    v_add_f32 v210, v210, v226
    v_add_f32 v211, v211, v227
    v_add_f32 v212, v212, v228
    v_add_f32 v213, v213, v229
    v_add_f32 v214, v214, v230
    v_add_f32 v215, v215, v231
    v_cvt_pk_bf16_f32 v201, v200, v201
    v_lshlrev_b32 v200, 16, v201
    v_and_b32 v201, s43, v201
    v_cvt_pk_bf16_f32 v203, v202, v203
    v_lshlrev_b32 v202, 16, v203
    v_and_b32 v203, s43, v203
    v_cvt_pk_bf16_f32 v205, v204, v205
    v_lshlrev_b32 v204, 16, v205
    v_and_b32 v205, s43, v205
    v_cvt_pk_bf16_f32 v207, v206, v207
    v_lshlrev_b32 v206, 16, v207
    v_and_b32 v207, s43, v207
    v_cvt_pk_bf16_f32 v209, v208, v209
    v_lshlrev_b32 v208, 16, v209
    v_and_b32 v209, s43, v209
    v_cvt_pk_bf16_f32 v211, v210, v211
    v_lshlrev_b32 v210, 16, v211
    v_and_b32 v211, s43, v211
    v_cvt_pk_bf16_f32 v213, v212, v213
    v_lshlrev_b32 v212, 16, v213
    v_and_b32 v213, s43, v213
    v_cvt_pk_bf16_f32 v215, v214, v215
    v_lshlrev_b32 v214, 16, v215
    v_and_b32 v215, s43, v215
    v_lshlrev_b32 v216, 16, v65
    v_and_b32 v217, s43, v65
    v_lshlrev_b32 v218, 16, v69
    v_and_b32 v219, s43, v69
    v_lshlrev_b32 v220, 16, v73
    v_and_b32 v221, s43, v73
    v_lshlrev_b32 v222, 16, v77
    v_and_b32 v223, s43, v77
    v_lshlrev_b32 v224, 16, v81
    v_and_b32 v225, s43, v81
    v_lshlrev_b32 v226, 16, v85
    v_and_b32 v227, s43, v85
    v_lshlrev_b32 v228, 16, v89
    v_and_b32 v229, s43, v89
    v_lshlrev_b32 v230, 16, v93
    v_and_b32 v231, s43, v93
    v_mul_f32 v200, v200, v216
    v_mul_f32 v201, v201, v217
    v_mul_f32 v202, v202, v218
    v_mul_f32 v203, v203, v219
    v_mul_f32 v204, v204, v220
    v_mul_f32 v205, v205, v221
    v_mul_f32 v206, v206, v222
    v_mul_f32 v207, v207, v223
    v_mul_f32 v208, v208, v224
    v_mul_f32 v209, v209, v225
    v_mul_f32 v210, v210, v226
    v_mul_f32 v211, v211, v227
    v_mul_f32 v212, v212, v228
    v_mul_f32 v213, v213, v229
    v_mul_f32 v214, v214, v230
    v_mul_f32 v215, v215, v231
    v_cvt_pk_bf16_f32 v104, v214, v212
    v_cvt_pk_bf16_f32 v105, v210, v208
    v_cvt_pk_bf16_f32 v106, v206, v204
    v_cvt_pk_bf16_f32 v107, v202, v200
    ds_write_b128 v5, v[104:107] offset:20480
    v_cvt_pk_bf16_f32 v108, v215, v213
    v_cvt_pk_bf16_f32 v109, v211, v209
    v_cvt_pk_bf16_f32 v110, v207, v205
    v_cvt_pk_bf16_f32 v111, v203, v201
    ds_write_b128 v5, v[108:111] offset:28160
    v_lshlrev_b32 v176, 16, v18
    v_and_b32 v177, s43, v18
    v_lshlrev_b32 v178, 16, v22
    v_and_b32 v179, s43, v22
    v_lshlrev_b32 v180, 16, v26
    v_and_b32 v181, s43, v26
    v_lshlrev_b32 v182, 16, v30
    v_and_b32 v183, s43, v30
    v_lshlrev_b32 v184, 16, v34
    v_and_b32 v185, s43, v34
    v_lshlrev_b32 v186, 16, v38
    v_and_b32 v187, s43, v38
    v_lshlrev_b32 v188, 16, v42
    v_and_b32 v189, s43, v42
    v_lshlrev_b32 v190, 16, v46
    v_and_b32 v191, s43, v46
    v_lshlrev_b32 v192, 16, v50
    v_and_b32 v193, s43, v50
    v_lshlrev_b32 v194, 16, v54
    v_and_b32 v195, s43, v54
    v_lshlrev_b32 v196, 16, v58
    v_and_b32 v197, s43, v58
    v_mul_f32 v200, s83, v176
    v_mul_f32 v201, s87, v177
    v_mul_f32 v202, s83, v178
    v_mul_f32 v203, s87, v179
    v_mul_f32 v204, s83, v180
    v_mul_f32 v205, s87, v181
    v_mul_f32 v206, s83, v182
    v_mul_f32 v207, s87, v183
    v_mul_f32 v208, s83, v184
    v_mul_f32 v209, s87, v185
    v_mul_f32 v210, s83, v186
    v_mul_f32 v211, s87, v187
    v_mul_f32 v212, s83, v188
    v_mul_f32 v213, s87, v189
    v_mul_f32 v214, s83, v190
    v_mul_f32 v215, s87, v191
    v_cvt_pk_bf16_f32 v201, v200, v201
    v_lshlrev_b32 v200, 16, v201
    v_and_b32 v201, s43, v201
    v_cvt_pk_bf16_f32 v203, v202, v203
    v_lshlrev_b32 v202, 16, v203
    v_and_b32 v203, s43, v203
    v_cvt_pk_bf16_f32 v205, v204, v205
    v_lshlrev_b32 v204, 16, v205
    v_and_b32 v205, s43, v205
    v_cvt_pk_bf16_f32 v207, v206, v207
    v_lshlrev_b32 v206, 16, v207
    v_and_b32 v207, s43, v207
    v_cvt_pk_bf16_f32 v209, v208, v209
    v_lshlrev_b32 v208, 16, v209
    v_and_b32 v209, s43, v209
    v_cvt_pk_bf16_f32 v211, v210, v211
    v_lshlrev_b32 v210, 16, v211
    v_and_b32 v211, s43, v211
    v_cvt_pk_bf16_f32 v213, v212, v213
    v_lshlrev_b32 v212, 16, v213
    v_and_b32 v213, s43, v213
    v_cvt_pk_bf16_f32 v215, v214, v215
    v_lshlrev_b32 v214, 16, v215
    v_and_b32 v215, s43, v215
    v_mul_f32 v216, s82, v178
    v_mul_f32 v217, s86, v179
    v_mul_f32 v218, s82, v180
    v_mul_f32 v219, s86, v181
    v_mul_f32 v220, s82, v182
    v_mul_f32 v221, s86, v183
    v_mul_f32 v222, s82, v184
    v_mul_f32 v223, s86, v185
    v_mul_f32 v224, s82, v186
    v_mul_f32 v225, s86, v187
    v_mul_f32 v226, s82, v188
    v_mul_f32 v227, s86, v189
    v_mul_f32 v228, s82, v190
    v_mul_f32 v229, s86, v191
    v_mul_f32 v230, s82, v192
    v_mul_f32 v231, s86, v193
    v_cvt_pk_bf16_f32 v217, v216, v217
    v_lshlrev_b32 v216, 16, v217
    v_and_b32 v217, s43, v217
    v_cvt_pk_bf16_f32 v219, v218, v219
    v_lshlrev_b32 v218, 16, v219
    v_and_b32 v219, s43, v219
    v_cvt_pk_bf16_f32 v221, v220, v221
    v_lshlrev_b32 v220, 16, v221
    v_and_b32 v221, s43, v221
    v_cvt_pk_bf16_f32 v223, v222, v223
    v_lshlrev_b32 v222, 16, v223
    v_and_b32 v223, s43, v223
    v_cvt_pk_bf16_f32 v225, v224, v225
    v_lshlrev_b32 v224, 16, v225
    v_and_b32 v225, s43, v225
    v_cvt_pk_bf16_f32 v227, v226, v227
    v_lshlrev_b32 v226, 16, v227
    v_and_b32 v227, s43, v227
    v_cvt_pk_bf16_f32 v229, v228, v229
    v_lshlrev_b32 v228, 16, v229
    v_and_b32 v229, s43, v229
    v_cvt_pk_bf16_f32 v231, v230, v231
    v_lshlrev_b32 v230, 16, v231
    v_and_b32 v231, s43, v231
    v_add_f32 v200, v200, v216
    v_add_f32 v201, v201, v217
    v_add_f32 v202, v202, v218
    v_add_f32 v203, v203, v219
    v_add_f32 v204, v204, v220
    v_add_f32 v205, v205, v221
    v_add_f32 v206, v206, v222
    v_add_f32 v207, v207, v223
    v_add_f32 v208, v208, v224
    v_add_f32 v209, v209, v225
    v_add_f32 v210, v210, v226
    v_add_f32 v211, v211, v227
    v_add_f32 v212, v212, v228
    v_add_f32 v213, v213, v229
    v_add_f32 v214, v214, v230
    v_add_f32 v215, v215, v231
    v_cvt_pk_bf16_f32 v201, v200, v201
    v_lshlrev_b32 v200, 16, v201
    v_and_b32 v201, s43, v201
    v_cvt_pk_bf16_f32 v203, v202, v203
    v_lshlrev_b32 v202, 16, v203
    v_and_b32 v203, s43, v203
    v_cvt_pk_bf16_f32 v205, v204, v205
    v_lshlrev_b32 v204, 16, v205
    v_and_b32 v205, s43, v205
    v_cvt_pk_bf16_f32 v207, v206, v207
    v_lshlrev_b32 v206, 16, v207
    v_and_b32 v207, s43, v207
    v_cvt_pk_bf16_f32 v209, v208, v209
    v_lshlrev_b32 v208, 16, v209
    v_and_b32 v209, s43, v209
    v_cvt_pk_bf16_f32 v211, v210, v211
    v_lshlrev_b32 v210, 16, v211
    v_and_b32 v211, s43, v211
    v_cvt_pk_bf16_f32 v213, v212, v213
    v_lshlrev_b32 v212, 16, v213
    v_and_b32 v213, s43, v213
    v_cvt_pk_bf16_f32 v215, v214, v215
    v_lshlrev_b32 v214, 16, v215
    v_and_b32 v215, s43, v215
    v_mul_f32 v216, s81, v180
    v_mul_f32 v217, s85, v181
    v_mul_f32 v218, s81, v182
    v_mul_f32 v219, s85, v183
    v_mul_f32 v220, s81, v184
    v_mul_f32 v221, s85, v185
    v_mul_f32 v222, s81, v186
    v_mul_f32 v223, s85, v187
    v_mul_f32 v224, s81, v188
    v_mul_f32 v225, s85, v189
    v_mul_f32 v226, s81, v190
    v_mul_f32 v227, s85, v191
    v_mul_f32 v228, s81, v192
    v_mul_f32 v229, s85, v193
    v_mul_f32 v230, s81, v194
    v_mul_f32 v231, s85, v195
    v_cvt_pk_bf16_f32 v217, v216, v217
    v_lshlrev_b32 v216, 16, v217
    v_and_b32 v217, s43, v217
    v_cvt_pk_bf16_f32 v219, v218, v219
    v_lshlrev_b32 v218, 16, v219
    v_and_b32 v219, s43, v219
    v_cvt_pk_bf16_f32 v221, v220, v221
    v_lshlrev_b32 v220, 16, v221
    v_and_b32 v221, s43, v221
    v_cvt_pk_bf16_f32 v223, v222, v223
    v_lshlrev_b32 v222, 16, v223
    v_and_b32 v223, s43, v223
    v_cvt_pk_bf16_f32 v225, v224, v225
    v_lshlrev_b32 v224, 16, v225
    v_and_b32 v225, s43, v225
    v_cvt_pk_bf16_f32 v227, v226, v227
    v_lshlrev_b32 v226, 16, v227
    v_and_b32 v227, s43, v227
    v_cvt_pk_bf16_f32 v229, v228, v229
    v_lshlrev_b32 v228, 16, v229
    v_and_b32 v229, s43, v229
    v_cvt_pk_bf16_f32 v231, v230, v231
    v_lshlrev_b32 v230, 16, v231
    v_and_b32 v231, s43, v231
    v_add_f32 v200, v200, v216
    v_add_f32 v201, v201, v217
    v_add_f32 v202, v202, v218
    v_add_f32 v203, v203, v219
    v_add_f32 v204, v204, v220
    v_add_f32 v205, v205, v221
    v_add_f32 v206, v206, v222
    v_add_f32 v207, v207, v223
    v_add_f32 v208, v208, v224
    v_add_f32 v209, v209, v225
    v_add_f32 v210, v210, v226
    v_add_f32 v211, v211, v227
    v_add_f32 v212, v212, v228
    v_add_f32 v213, v213, v229
    v_add_f32 v214, v214, v230
    v_add_f32 v215, v215, v231
    v_cvt_pk_bf16_f32 v201, v200, v201
    v_lshlrev_b32 v200, 16, v201
    v_and_b32 v201, s43, v201
    v_cvt_pk_bf16_f32 v203, v202, v203
    v_lshlrev_b32 v202, 16, v203
    v_and_b32 v203, s43, v203
    v_cvt_pk_bf16_f32 v205, v204, v205
    v_lshlrev_b32 v204, 16, v205
    v_and_b32 v205, s43, v205
    v_cvt_pk_bf16_f32 v207, v206, v207
    v_lshlrev_b32 v206, 16, v207
    v_and_b32 v207, s43, v207
    v_cvt_pk_bf16_f32 v209, v208, v209
    v_lshlrev_b32 v208, 16, v209
    v_and_b32 v209, s43, v209
    v_cvt_pk_bf16_f32 v211, v210, v211
    v_lshlrev_b32 v210, 16, v211
    v_and_b32 v211, s43, v211
    v_cvt_pk_bf16_f32 v213, v212, v213
    v_lshlrev_b32 v212, 16, v213
    v_and_b32 v213, s43, v213
    v_cvt_pk_bf16_f32 v215, v214, v215
    v_lshlrev_b32 v214, 16, v215
    v_and_b32 v215, s43, v215
    v_mul_f32 v216, s80, v182
    v_mul_f32 v217, s84, v183
    v_mul_f32 v218, s80, v184
    v_mul_f32 v219, s84, v185
    v_mul_f32 v220, s80, v186
    v_mul_f32 v221, s84, v187
    v_mul_f32 v222, s80, v188
    v_mul_f32 v223, s84, v189
    v_mul_f32 v224, s80, v190
    v_mul_f32 v225, s84, v191
    v_mul_f32 v226, s80, v192
    v_mul_f32 v227, s84, v193
    v_mul_f32 v228, s80, v194
    v_mul_f32 v229, s84, v195
    v_mul_f32 v230, s80, v196
    v_mul_f32 v231, s84, v197
    v_cvt_pk_bf16_f32 v217, v216, v217
    v_lshlrev_b32 v216, 16, v217
    v_and_b32 v217, s43, v217
    v_cvt_pk_bf16_f32 v219, v218, v219
    v_lshlrev_b32 v218, 16, v219
    v_and_b32 v219, s43, v219
    v_cvt_pk_bf16_f32 v221, v220, v221
    v_lshlrev_b32 v220, 16, v221
    v_and_b32 v221, s43, v221
    v_cvt_pk_bf16_f32 v223, v222, v223
    v_lshlrev_b32 v222, 16, v223
    v_and_b32 v223, s43, v223
    v_cvt_pk_bf16_f32 v225, v224, v225
    v_lshlrev_b32 v224, 16, v225
    v_and_b32 v225, s43, v225
    v_cvt_pk_bf16_f32 v227, v226, v227
    v_lshlrev_b32 v226, 16, v227
    v_and_b32 v227, s43, v227
    v_cvt_pk_bf16_f32 v229, v228, v229
    v_lshlrev_b32 v228, 16, v229
    v_and_b32 v229, s43, v229
    v_cvt_pk_bf16_f32 v231, v230, v231
    v_lshlrev_b32 v230, 16, v231
    v_and_b32 v231, s43, v231
    v_add_f32 v200, v200, v216
    v_add_f32 v201, v201, v217
    v_add_f32 v202, v202, v218
    v_add_f32 v203, v203, v219
    v_add_f32 v204, v204, v220
    v_add_f32 v205, v205, v221
    v_add_f32 v206, v206, v222
    v_add_f32 v207, v207, v223
    v_add_f32 v208, v208, v224
    v_add_f32 v209, v209, v225
    v_add_f32 v210, v210, v226
    v_add_f32 v211, v211, v227
    v_add_f32 v212, v212, v228
    v_add_f32 v213, v213, v229
    v_add_f32 v214, v214, v230
    v_add_f32 v215, v215, v231
    v_cvt_pk_bf16_f32 v201, v200, v201
    v_lshlrev_b32 v200, 16, v201
    v_and_b32 v201, s43, v201
    v_cvt_pk_bf16_f32 v203, v202, v203
    v_lshlrev_b32 v202, 16, v203
    v_and_b32 v203, s43, v203
    v_cvt_pk_bf16_f32 v205, v204, v205
    v_lshlrev_b32 v204, 16, v205
    v_and_b32 v205, s43, v205
    v_cvt_pk_bf16_f32 v207, v206, v207
    v_lshlrev_b32 v206, 16, v207
    v_and_b32 v207, s43, v207
    v_cvt_pk_bf16_f32 v209, v208, v209
    v_lshlrev_b32 v208, 16, v209
    v_and_b32 v209, s43, v209
    v_cvt_pk_bf16_f32 v211, v210, v211
    v_lshlrev_b32 v210, 16, v211
    v_and_b32 v211, s43, v211
    v_cvt_pk_bf16_f32 v213, v212, v213
    v_lshlrev_b32 v212, 16, v213
    v_and_b32 v213, s43, v213
    v_cvt_pk_bf16_f32 v215, v214, v215
    v_lshlrev_b32 v214, 16, v215
    v_and_b32 v215, s43, v215
    v_lshlrev_b32 v216, 16, v66
    v_and_b32 v217, s43, v66
    v_lshlrev_b32 v218, 16, v70
    v_and_b32 v219, s43, v70
    v_lshlrev_b32 v220, 16, v74
    v_and_b32 v221, s43, v74
    v_lshlrev_b32 v222, 16, v78
    v_and_b32 v223, s43, v78
    v_lshlrev_b32 v224, 16, v82
    v_and_b32 v225, s43, v82
    v_lshlrev_b32 v226, 16, v86
    v_and_b32 v227, s43, v86
    v_lshlrev_b32 v228, 16, v90
    v_and_b32 v229, s43, v90
    v_lshlrev_b32 v230, 16, v94
    v_and_b32 v231, s43, v94
    v_mul_f32 v200, v200, v216
    v_mul_f32 v201, v201, v217
    v_mul_f32 v202, v202, v218
    v_mul_f32 v203, v203, v219
    v_mul_f32 v204, v204, v220
    v_mul_f32 v205, v205, v221
    v_mul_f32 v206, v206, v222
    v_mul_f32 v207, v207, v223
    v_mul_f32 v208, v208, v224
    v_mul_f32 v209, v209, v225
    v_mul_f32 v210, v210, v226
    v_mul_f32 v211, v211, v227
    v_mul_f32 v212, v212, v228
    v_mul_f32 v213, v213, v229
    v_mul_f32 v214, v214, v230
    v_mul_f32 v215, v215, v231
    v_cvt_pk_bf16_f32 v112, v214, v212
    v_cvt_pk_bf16_f32 v113, v210, v208
    v_cvt_pk_bf16_f32 v114, v206, v204
    v_cvt_pk_bf16_f32 v115, v202, v200
    ds_write_b128 v5, v[112:115] offset:35840
    v_cvt_pk_bf16_f32 v116, v215, v213
    v_cvt_pk_bf16_f32 v117, v211, v209
    v_cvt_pk_bf16_f32 v118, v207, v205
    v_cvt_pk_bf16_f32 v119, v203, v201
    ds_write_b128 v5, v[116:119] offset:43520
    v_lshlrev_b32 v176, 16, v19
    v_and_b32 v177, s43, v19
    v_lshlrev_b32 v178, 16, v23
    v_and_b32 v179, s43, v23
    v_lshlrev_b32 v180, 16, v27
    v_and_b32 v181, s43, v27
    v_lshlrev_b32 v182, 16, v31
    v_and_b32 v183, s43, v31
    v_lshlrev_b32 v184, 16, v35
    v_and_b32 v185, s43, v35
    v_lshlrev_b32 v186, 16, v39
    v_and_b32 v187, s43, v39
    v_lshlrev_b32 v188, 16, v43
    v_and_b32 v189, s43, v43
    v_lshlrev_b32 v190, 16, v47
    v_and_b32 v191, s43, v47
    v_lshlrev_b32 v192, 16, v51
    v_and_b32 v193, s43, v51
    v_lshlrev_b32 v194, 16, v55
    v_and_b32 v195, s43, v55
    v_lshlrev_b32 v196, 16, v59
    v_and_b32 v197, s43, v59
    v_mul_f32 v200, s91, v176
    v_mul_f32 v201, s95, v177
    v_mul_f32 v202, s91, v178
    v_mul_f32 v203, s95, v179
    v_mul_f32 v204, s91, v180
    v_mul_f32 v205, s95, v181
    v_mul_f32 v206, s91, v182
    v_mul_f32 v207, s95, v183
    v_mul_f32 v208, s91, v184
    v_mul_f32 v209, s95, v185
    v_mul_f32 v210, s91, v186
    v_mul_f32 v211, s95, v187
    v_mul_f32 v212, s91, v188
    v_mul_f32 v213, s95, v189
    v_mul_f32 v214, s91, v190
    v_mul_f32 v215, s95, v191
    v_cvt_pk_bf16_f32 v201, v200, v201
    v_lshlrev_b32 v200, 16, v201
    v_and_b32 v201, s43, v201
    v_cvt_pk_bf16_f32 v203, v202, v203
    v_lshlrev_b32 v202, 16, v203
    v_and_b32 v203, s43, v203
    v_cvt_pk_bf16_f32 v205, v204, v205
    v_lshlrev_b32 v204, 16, v205
    v_and_b32 v205, s43, v205
    v_cvt_pk_bf16_f32 v207, v206, v207
    v_lshlrev_b32 v206, 16, v207
    v_and_b32 v207, s43, v207
    v_cvt_pk_bf16_f32 v209, v208, v209
    v_lshlrev_b32 v208, 16, v209
    v_and_b32 v209, s43, v209
    v_cvt_pk_bf16_f32 v211, v210, v211
    v_lshlrev_b32 v210, 16, v211
    v_and_b32 v211, s43, v211
    v_cvt_pk_bf16_f32 v213, v212, v213
    v_lshlrev_b32 v212, 16, v213
    v_and_b32 v213, s43, v213
    v_cvt_pk_bf16_f32 v215, v214, v215
    v_lshlrev_b32 v214, 16, v215
    v_and_b32 v215, s43, v215
    v_mul_f32 v216, s90, v178
    v_mul_f32 v217, s94, v179
    v_mul_f32 v218, s90, v180
    v_mul_f32 v219, s94, v181
    v_mul_f32 v220, s90, v182
    v_mul_f32 v221, s94, v183
    v_mul_f32 v222, s90, v184
    v_mul_f32 v223, s94, v185
    v_mul_f32 v224, s90, v186
    v_mul_f32 v225, s94, v187
    v_mul_f32 v226, s90, v188
    v_mul_f32 v227, s94, v189
    v_mul_f32 v228, s90, v190
    v_mul_f32 v229, s94, v191
    v_mul_f32 v230, s90, v192
    v_mul_f32 v231, s94, v193
    v_cvt_pk_bf16_f32 v217, v216, v217
    v_lshlrev_b32 v216, 16, v217
    v_and_b32 v217, s43, v217
    v_cvt_pk_bf16_f32 v219, v218, v219
    v_lshlrev_b32 v218, 16, v219
    v_and_b32 v219, s43, v219
    v_cvt_pk_bf16_f32 v221, v220, v221
    v_lshlrev_b32 v220, 16, v221
    v_and_b32 v221, s43, v221
    v_cvt_pk_bf16_f32 v223, v222, v223
    v_lshlrev_b32 v222, 16, v223
    v_and_b32 v223, s43, v223
    v_cvt_pk_bf16_f32 v225, v224, v225
    v_lshlrev_b32 v224, 16, v225
    v_and_b32 v225, s43, v225
    v_cvt_pk_bf16_f32 v227, v226, v227
    v_lshlrev_b32 v226, 16, v227
    v_and_b32 v227, s43, v227
    v_cvt_pk_bf16_f32 v229, v228, v229
    v_lshlrev_b32 v228, 16, v229
    v_and_b32 v229, s43, v229
    v_cvt_pk_bf16_f32 v231, v230, v231
    v_lshlrev_b32 v230, 16, v231
    v_and_b32 v231, s43, v231
    v_add_f32 v200, v200, v216
    v_add_f32 v201, v201, v217
    v_add_f32 v202, v202, v218
    v_add_f32 v203, v203, v219
    v_add_f32 v204, v204, v220
    v_add_f32 v205, v205, v221
    v_add_f32 v206, v206, v222
    v_add_f32 v207, v207, v223
    v_add_f32 v208, v208, v224
    v_add_f32 v209, v209, v225
    v_add_f32 v210, v210, v226
    v_add_f32 v211, v211, v227
    v_add_f32 v212, v212, v228
    v_add_f32 v213, v213, v229
    v_add_f32 v214, v214, v230
    v_add_f32 v215, v215, v231
    v_cvt_pk_bf16_f32 v201, v200, v201
    v_lshlrev_b32 v200, 16, v201
    v_and_b32 v201, s43, v201
    v_cvt_pk_bf16_f32 v203, v202, v203
    v_lshlrev_b32 v202, 16, v203
    v_and_b32 v203, s43, v203
    v_cvt_pk_bf16_f32 v205, v204, v205
    v_lshlrev_b32 v204, 16, v205
    v_and_b32 v205, s43, v205
    v_cvt_pk_bf16_f32 v207, v206, v207
    v_lshlrev_b32 v206, 16, v207
    v_and_b32 v207, s43, v207
    v_cvt_pk_bf16_f32 v209, v208, v209
    v_lshlrev_b32 v208, 16, v209
    v_and_b32 v209, s43, v209
    v_cvt_pk_bf16_f32 v211, v210, v211
    v_lshlrev_b32 v210, 16, v211
    v_and_b32 v211, s43, v211
    v_cvt_pk_bf16_f32 v213, v212, v213
    v_lshlrev_b32 v212, 16, v213
    v_and_b32 v213, s43, v213
    v_cvt_pk_bf16_f32 v215, v214, v215
    v_lshlrev_b32 v214, 16, v215
    v_and_b32 v215, s43, v215
    v_mul_f32 v216, s89, v180
    v_mul_f32 v217, s93, v181
    v_mul_f32 v218, s89, v182
    v_mul_f32 v219, s93, v183
    v_mul_f32 v220, s89, v184
    v_mul_f32 v221, s93, v185
    v_mul_f32 v222, s89, v186
    v_mul_f32 v223, s93, v187
    v_mul_f32 v224, s89, v188
    v_mul_f32 v225, s93, v189
    v_mul_f32 v226, s89, v190
    v_mul_f32 v227, s93, v191
    v_mul_f32 v228, s89, v192
    v_mul_f32 v229, s93, v193
    v_mul_f32 v230, s89, v194
    v_mul_f32 v231, s93, v195
    v_cvt_pk_bf16_f32 v217, v216, v217
    v_lshlrev_b32 v216, 16, v217
    v_and_b32 v217, s43, v217
    v_cvt_pk_bf16_f32 v219, v218, v219
    v_lshlrev_b32 v218, 16, v219
    v_and_b32 v219, s43, v219
    v_cvt_pk_bf16_f32 v221, v220, v221
    v_lshlrev_b32 v220, 16, v221
    v_and_b32 v221, s43, v221
    v_cvt_pk_bf16_f32 v223, v222, v223
    v_lshlrev_b32 v222, 16, v223
    v_and_b32 v223, s43, v223
    v_cvt_pk_bf16_f32 v225, v224, v225
    v_lshlrev_b32 v224, 16, v225
    v_and_b32 v225, s43, v225
    v_cvt_pk_bf16_f32 v227, v226, v227
    v_lshlrev_b32 v226, 16, v227
    v_and_b32 v227, s43, v227
    v_cvt_pk_bf16_f32 v229, v228, v229
    v_lshlrev_b32 v228, 16, v229
    v_and_b32 v229, s43, v229
    v_cvt_pk_bf16_f32 v231, v230, v231
    v_lshlrev_b32 v230, 16, v231
    v_and_b32 v231, s43, v231
    v_add_f32 v200, v200, v216
    v_add_f32 v201, v201, v217
    v_add_f32 v202, v202, v218
    v_add_f32 v203, v203, v219
    v_add_f32 v204, v204, v220
    v_add_f32 v205, v205, v221
    v_add_f32 v206, v206, v222
    v_add_f32 v207, v207, v223
    v_add_f32 v208, v208, v224
    v_add_f32 v209, v209, v225
    v_add_f32 v210, v210, v226
    v_add_f32 v211, v211, v227
    v_add_f32 v212, v212, v228
    v_add_f32 v213, v213, v229
    v_add_f32 v214, v214, v230
    v_add_f32 v215, v215, v231
    v_cvt_pk_bf16_f32 v201, v200, v201
    v_lshlrev_b32 v200, 16, v201
    v_and_b32 v201, s43, v201
    v_cvt_pk_bf16_f32 v203, v202, v203
    v_lshlrev_b32 v202, 16, v203
    v_and_b32 v203, s43, v203
    v_cvt_pk_bf16_f32 v205, v204, v205
    v_lshlrev_b32 v204, 16, v205
    v_and_b32 v205, s43, v205
    v_cvt_pk_bf16_f32 v207, v206, v207
    v_lshlrev_b32 v206, 16, v207
    v_and_b32 v207, s43, v207
    v_cvt_pk_bf16_f32 v209, v208, v209
    v_lshlrev_b32 v208, 16, v209
    v_and_b32 v209, s43, v209
    v_cvt_pk_bf16_f32 v211, v210, v211
    v_lshlrev_b32 v210, 16, v211
    v_and_b32 v211, s43, v211
    v_cvt_pk_bf16_f32 v213, v212, v213
    v_lshlrev_b32 v212, 16, v213
    v_and_b32 v213, s43, v213
    v_cvt_pk_bf16_f32 v215, v214, v215
    v_lshlrev_b32 v214, 16, v215
    v_and_b32 v215, s43, v215
    v_mul_f32 v216, s88, v182
    v_mul_f32 v217, s92, v183
    v_mul_f32 v218, s88, v184
    v_mul_f32 v219, s92, v185
    v_mul_f32 v220, s88, v186
    v_mul_f32 v221, s92, v187
    v_mul_f32 v222, s88, v188
    v_mul_f32 v223, s92, v189
    v_mul_f32 v224, s88, v190
    v_mul_f32 v225, s92, v191
    v_mul_f32 v226, s88, v192
    v_mul_f32 v227, s92, v193
    v_mul_f32 v228, s88, v194
    v_mul_f32 v229, s92, v195
    v_mul_f32 v230, s88, v196
    v_mul_f32 v231, s92, v197
    v_cvt_pk_bf16_f32 v217, v216, v217
    v_lshlrev_b32 v216, 16, v217
    v_and_b32 v217, s43, v217
    v_cvt_pk_bf16_f32 v219, v218, v219
    v_lshlrev_b32 v218, 16, v219
    v_and_b32 v219, s43, v219
    v_cvt_pk_bf16_f32 v221, v220, v221
    v_lshlrev_b32 v220, 16, v221
    v_and_b32 v221, s43, v221
    v_cvt_pk_bf16_f32 v223, v222, v223
    v_lshlrev_b32 v222, 16, v223
    v_and_b32 v223, s43, v223
    v_cvt_pk_bf16_f32 v225, v224, v225
    v_lshlrev_b32 v224, 16, v225
    v_and_b32 v225, s43, v225
    v_cvt_pk_bf16_f32 v227, v226, v227
    v_lshlrev_b32 v226, 16, v227
    v_and_b32 v227, s43, v227
    v_cvt_pk_bf16_f32 v229, v228, v229
    v_lshlrev_b32 v228, 16, v229
    v_and_b32 v229, s43, v229
    v_cvt_pk_bf16_f32 v231, v230, v231
    v_lshlrev_b32 v230, 16, v231
    v_and_b32 v231, s43, v231
    v_add_f32 v200, v200, v216
    v_add_f32 v201, v201, v217
    v_add_f32 v202, v202, v218
    v_add_f32 v203, v203, v219
    v_add_f32 v204, v204, v220
    v_add_f32 v205, v205, v221
    v_add_f32 v206, v206, v222
    v_add_f32 v207, v207, v223
    v_add_f32 v208, v208, v224
    v_add_f32 v209, v209, v225
    v_add_f32 v210, v210, v226
    v_add_f32 v211, v211, v227
    v_add_f32 v212, v212, v228
    v_add_f32 v213, v213, v229
    v_add_f32 v214, v214, v230
    v_add_f32 v215, v215, v231
    v_cvt_pk_bf16_f32 v201, v200, v201
    v_lshlrev_b32 v200, 16, v201
    v_and_b32 v201, s43, v201
    v_cvt_pk_bf16_f32 v203, v202, v203
    v_lshlrev_b32 v202, 16, v203
    v_and_b32 v203, s43, v203
    v_cvt_pk_bf16_f32 v205, v204, v205
    v_lshlrev_b32 v204, 16, v205
    v_and_b32 v205, s43, v205
    v_cvt_pk_bf16_f32 v207, v206, v207
    v_lshlrev_b32 v206, 16, v207
    v_and_b32 v207, s43, v207
    v_cvt_pk_bf16_f32 v209, v208, v209
    v_lshlrev_b32 v208, 16, v209
    v_and_b32 v209, s43, v209
    v_cvt_pk_bf16_f32 v211, v210, v211
    v_lshlrev_b32 v210, 16, v211
    v_and_b32 v211, s43, v211
    v_cvt_pk_bf16_f32 v213, v212, v213
    v_lshlrev_b32 v212, 16, v213
    v_and_b32 v213, s43, v213
    v_cvt_pk_bf16_f32 v215, v214, v215
    v_lshlrev_b32 v214, 16, v215
    v_and_b32 v215, s43, v215
    v_lshlrev_b32 v216, 16, v67
    v_and_b32 v217, s43, v67
    v_lshlrev_b32 v218, 16, v71
    v_and_b32 v219, s43, v71
    v_lshlrev_b32 v220, 16, v75
    v_and_b32 v221, s43, v75
    v_lshlrev_b32 v222, 16, v79
    v_and_b32 v223, s43, v79
    v_lshlrev_b32 v224, 16, v83
    v_and_b32 v225, s43, v83
    v_lshlrev_b32 v226, 16, v87
    v_and_b32 v227, s43, v87
    v_lshlrev_b32 v228, 16, v91
    v_and_b32 v229, s43, v91
    v_lshlrev_b32 v230, 16, v95
    v_and_b32 v231, s43, v95
    v_mul_f32 v200, v200, v216
    v_mul_f32 v201, v201, v217
    v_mul_f32 v202, v202, v218
    v_mul_f32 v203, v203, v219
    v_mul_f32 v204, v204, v220
    v_mul_f32 v205, v205, v221
    v_mul_f32 v206, v206, v222
    v_mul_f32 v207, v207, v223
    v_mul_f32 v208, v208, v224
    v_mul_f32 v209, v209, v225
    v_mul_f32 v210, v210, v226
    v_mul_f32 v211, v211, v227
    v_mul_f32 v212, v212, v228
    v_mul_f32 v213, v213, v229
    v_mul_f32 v214, v214, v230
    v_mul_f32 v215, v215, v231
    v_cvt_pk_bf16_f32 v120, v214, v212
    v_cvt_pk_bf16_f32 v121, v210, v208
    v_cvt_pk_bf16_f32 v122, v206, v204
    v_cvt_pk_bf16_f32 v123, v202, v200
    ds_write_b128 v5, v[120:123] offset:51200
    v_cvt_pk_bf16_f32 v124, v215, v213
    v_cvt_pk_bf16_f32 v125, v211, v209
    v_cvt_pk_bf16_f32 v126, v207, v205
    v_cvt_pk_bf16_f32 v127, v203, v201
    ds_write_b128 v5, v[124:127] offset:58880
    v_and_b32 v1, 63, v0
    v_and_b32 v2, 31, v1
    v_lshrrev_b32 v3, 5, v1
    s_mul_i32 s52, s29, 17152
    s_add_u32 s52, s52, 64000
    v_lshlrev_b32 v7, 4, v1
    v_add_u32 v12, s52, v7
    v_add_u32 v8, 1, v2
    v_and_b32 v9, 3, v8
    v_mul_u32_u24 v9, 4288, v9
    v_and_b32 v8, 60, v8
    v_lshl_add_u32 v9, v8, 1, v9
    v_lshl_add_u32 v9, v3, 4, v9
    v_add_u32 v13, s52, v9
    v_add_u32 v14, 2048, v13
    v_mul_u32_u24 v15, 80, v2
    s_mov_b32 s53, 0
    v_cmp_eq_u32 s[54:55], 3, v1
    s_waitcnt lgkmcnt(0)
    s_barrier
L_cv_round:
    s_add_u32 s56, s53, s29
    s_mul_i32 s57, s56, 7680
    s_add_u32 s57, s57, 2560
    s_lshl_b32 s58, s40, 3
    s_add_u32 s56, s56, s58
    s_lshl_b32 s56, s56, 12
    v_add_u32 v8, s56, v7
    buffer_load_dwordx4 v[16:19], v8, s[32:35], 0 offen offset:0
    buffer_load_dwordx2 v[20:21], v8, s[32:35], 0 offen offset:16
    buffer_load_dwordx4 v[24:27], v8, s[32:35], 0 offen offset:1024
    buffer_load_dwordx2 v[28:29], v8, s[32:35], 0 offen offset:1040
    buffer_load_dwordx4 v[32:35], v8, s[32:35], 0 offen offset:2048
    buffer_load_dwordx2 v[36:37], v8, s[32:35], 0 offen offset:2064
    buffer_load_dwordx4 v[40:43], v8, s[32:35], 0 offen offset:3072
    buffer_load_dwordx2 v[44:45], v8, s[32:35], 0 offen offset:3088
    s_waitcnt vmcnt(0)
    v_readfirstlane_b32 s58, v16
    v_readfirstlane_b32 s59, v17
    v_alignbit_b32 v56, v17, v16, 16
    v_alignbit_b32 v57, v18, v17, 16
    v_alignbit_b32 v58, v19, v18, 16
    v_alignbit_b32 v59, v20, v19, 16
    v_alignbit_b32 v60, v21, v20, 16
    v_mov_b32 v64, v17
    v_mov_b32 v68, v57
    v_mov_b32 v65, v18
    v_mov_b32 v69, v58
    v_mov_b32 v66, v19
    v_mov_b32 v70, v59
    v_mov_b32 v67, v20
    v_mov_b32 v71, v60
    ds_write_b128 v12, v[16:19] offset:64
    ds_write_b128 v12, v[56:59] offset:4352
    ds_write_b128 v12, v[64:67] offset:8640
    ds_write_b128 v12, v[68:71] offset:12928
    s_waitcnt lgkmcnt(0)
    v_alignbit_b32 v56, v25, v24, 16
    v_alignbit_b32 v57, v26, v25, 16
    v_alignbit_b32 v58, v27, v26, 16
    v_alignbit_b32 v59, v28, v27, 16
    v_alignbit_b32 v60, v29, v28, 16
    v_mov_b32 v64, v25
    v_mov_b32 v68, v57
    v_mov_b32 v65, v26
    v_mov_b32 v69, v58
    v_mov_b32 v66, v27
    v_mov_b32 v70, v59
    v_mov_b32 v67, v28
    v_mov_b32 v71, v60
    ds_write_b128 v12, v[24:27] offset:1088
    ds_write_b128 v12, v[56:59] offset:5376
    ds_write_b128 v12, v[64:67] offset:9664
    ds_write_b128 v12, v[68:71] offset:13952
    s_waitcnt lgkmcnt(0)
    v_alignbit_b32 v56, v33, v32, 16
    v_alignbit_b32 v57, v34, v33, 16
    v_alignbit_b32 v58, v35, v34, 16
    v_alignbit_b32 v59, v36, v35, 16
    v_alignbit_b32 v60, v37, v36, 16
    v_mov_b32 v64, v33
    v_mov_b32 v68, v57
    v_mov_b32 v65, v34
    v_mov_b32 v69, v58
    v_mov_b32 v66, v35
    v_mov_b32 v70, v59
    v_mov_b32 v67, v36
    v_mov_b32 v71, v60
    ds_write_b128 v12, v[32:35] offset:2112
    ds_write_b128 v12, v[56:59] offset:6400
    ds_write_b128 v12, v[64:67] offset:10688
    ds_write_b128 v12, v[68:71] offset:14976
    s_waitcnt lgkmcnt(0)
    v_alignbit_b32 v56, v41, v40, 16
    v_alignbit_b32 v57, v42, v41, 16
    v_alignbit_b32 v58, v43, v42, 16
    v_alignbit_b32 v59, v44, v43, 16
    v_alignbit_b32 v60, v45, v44, 16
    v_mov_b32 v64, v41
    v_mov_b32 v68, v57
    v_mov_b32 v65, v42
    v_mov_b32 v69, v58
    v_mov_b32 v66, v43
    v_mov_b32 v70, v59
    v_mov_b32 v67, v44
    v_mov_b32 v71, v60
    ds_write_b128 v12, v[40:43] offset:3136
    ds_write_b128 v12, v[56:59] offset:7424
    ds_write_b128 v12, v[64:67] offset:11712
    ds_write_b128 v12, v[68:71] offset:16000
    s_waitcnt lgkmcnt(0)
    v_mov_b32 v48, 0
    v_mov_b32 v49, 0
    v_mov_b32 v50, 0
    v_mov_b32 v51, 0
    v_mov_b32 v52, s58
    v_mov_b32 v53, s59
    v_cndmask_b32 v52, 0, v52, s[54:55]
    v_cndmask_b32 v53, 0, v53, s[54:55]
    s_mov_b64 exec, 15
    v_alignbit_b32 v56, v49, v48, 16
    v_alignbit_b32 v57, v50, v49, 16
    v_alignbit_b32 v58, v51, v50, 16
    v_alignbit_b32 v59, v52, v51, 16
    v_alignbit_b32 v60, v53, v52, 16
    v_mov_b32 v64, v49
    v_mov_b32 v68, v57
    v_mov_b32 v65, v50
    v_mov_b32 v69, v58
    v_mov_b32 v66, v51
    v_mov_b32 v70, v59
    v_mov_b32 v67, v52
    v_mov_b32 v71, v60
    ds_write_b128 v12, v[48:51] offset:0
    ds_write_b128 v12, v[56:59] offset:4288
    ds_write_b128 v12, v[64:67] offset:8576
    ds_write_b128 v12, v[68:71] offset:12864
    s_waitcnt lgkmcnt(0)
    s_mov_b64 exec, -1
    v_add_u32 v10, s57, v15
    v_lshl_add_u32 v11, v3, 4, v10
    v_subrev_u32 v11, 2480, v11
    v_lshl_add_u32 v10, v3, 3, v10
    ds_read2_b64 v[16:19], v13 offset0:0 offset1:1
    ds_read_b128 v[20:23], v11 offset:5040
    ds_read_b128 v[24:27], v11 offset:7600
    ds_read2_b64 v[28:31], v13 offset0:4 offset1:5
    ds_read_b128 v[32:35], v11 offset:5072
    ds_read_b128 v[36:39], v11 offset:7632
    ds_read2_b64 v[40:43], v13 offset0:8 offset1:9
    ds_read_b128 v[44:47], v11 offset:4960
    ds_read_b128 v[48:51], v11 offset:7520
    ds_read2_b64 v[52:55], v13 offset0:12 offset1:13
    ds_read_b128 v[56:59], v11 offset:4992
    ds_read_b128 v[60:63], v11 offset:7552
    s_waitcnt lgkmcnt(9)
    v_mfma_f32_32x32x16_bf16 v[176:191], v[16:19], v[20:23], 0
    v_mfma_f32_32x32x16_bf16 v[192:207], v[16:19], v[24:27], 0
    ds_read2_b64 v[16:19], v13 offset0:16 offset1:17
    ds_read_b128 v[20:23], v11 offset:4880
    ds_read_b128 v[24:27], v11 offset:7440
    s_waitcnt lgkmcnt(9)
    v_mfma_f32_32x32x16_bf16 v[176:191], v[28:31], v[32:35], v[176:191]
    v_mfma_f32_32x32x16_bf16 v[192:207], v[28:31], v[36:39], v[192:207]
    ds_read2_b64 v[28:31], v13 offset0:20 offset1:21
    ds_read_b128 v[32:35], v11 offset:4912
    ds_read_b128 v[36:39], v11 offset:7472
    s_waitcnt lgkmcnt(9)
    v_mfma_f32_32x32x16_bf16 v[176:191], v[40:43], v[44:47], v[176:191]
    v_mfma_f32_32x32x16_bf16 v[192:207], v[40:43], v[48:51], v[192:207]
    ds_read2_b64 v[40:43], v13 offset0:24 offset1:25
    ds_read_b128 v[44:47], v11 offset:4800
    ds_read_b128 v[48:51], v11 offset:7360
    s_waitcnt lgkmcnt(9)
    v_mfma_f32_32x32x16_bf16 v[176:191], v[52:55], v[56:59], v[176:191]
    v_mfma_f32_32x32x16_bf16 v[192:207], v[52:55], v[60:63], v[192:207]
    ds_read2_b64 v[52:55], v13 offset0:28 offset1:29
    ds_read_b128 v[56:59], v11 offset:4832
    ds_read_b128 v[60:63], v11 offset:7392
    s_waitcnt lgkmcnt(9)
    v_mfma_f32_32x32x16_bf16 v[176:191], v[16:19], v[20:23], v[176:191]
    v_mfma_f32_32x32x16_bf16 v[192:207], v[16:19], v[24:27], v[192:207]
    ds_read2_b64 v[16:19], v13 offset0:32 offset1:33
    ds_read_b128 v[20:23], v11 offset:4720
    ds_read_b128 v[24:27], v11 offset:7280
    s_waitcnt lgkmcnt(9)
    v_mfma_f32_32x32x16_bf16 v[176:191], v[28:31], v[32:35], v[176:191]
    v_mfma_f32_32x32x16_bf16 v[192:207], v[28:31], v[36:39], v[192:207]
    ds_read2_b64 v[28:31], v13 offset0:36 offset1:37
    ds_read_b128 v[32:35], v11 offset:4752
    ds_read_b128 v[36:39], v11 offset:7312
    s_waitcnt lgkmcnt(9)
    v_mfma_f32_32x32x16_bf16 v[176:191], v[40:43], v[44:47], v[176:191]
    v_mfma_f32_32x32x16_bf16 v[192:207], v[40:43], v[48:51], v[192:207]
    ds_read2_b64 v[40:43], v13 offset0:40 offset1:41
    ds_read_b128 v[44:47], v11 offset:4640
    ds_read_b128 v[48:51], v11 offset:7200
    s_waitcnt lgkmcnt(9)
    v_mfma_f32_32x32x16_bf16 v[176:191], v[52:55], v[56:59], v[176:191]
    v_mfma_f32_32x32x16_bf16 v[192:207], v[52:55], v[60:63], v[192:207]
    ds_read2_b64 v[52:55], v13 offset0:44 offset1:45
    ds_read_b128 v[56:59], v11 offset:4672
    ds_read_b128 v[60:63], v11 offset:7232
    s_waitcnt lgkmcnt(9)
    v_mfma_f32_32x32x16_bf16 v[176:191], v[16:19], v[20:23], v[176:191]
    v_mfma_f32_32x32x16_bf16 v[192:207], v[16:19], v[24:27], v[192:207]
    ds_read2_b64 v[16:19], v13 offset0:48 offset1:49
    ds_read_b128 v[20:23], v11 offset:4560
    ds_read_b128 v[24:27], v11 offset:7120
    s_waitcnt lgkmcnt(9)
    v_mfma_f32_32x32x16_bf16 v[176:191], v[28:31], v[32:35], v[176:191]
    v_mfma_f32_32x32x16_bf16 v[192:207], v[28:31], v[36:39], v[192:207]
    ds_read2_b64 v[28:31], v13 offset0:52 offset1:53
    ds_read_b128 v[32:35], v11 offset:4592
    ds_read_b128 v[36:39], v11 offset:7152
    s_waitcnt lgkmcnt(9)
    v_mfma_f32_32x32x16_bf16 v[176:191], v[40:43], v[44:47], v[176:191]
    v_mfma_f32_32x32x16_bf16 v[192:207], v[40:43], v[48:51], v[192:207]
    ds_read2_b64 v[40:43], v13 offset0:56 offset1:57
    ds_read_b128 v[44:47], v11 offset:4480
    ds_read_b128 v[48:51], v11 offset:7040
    s_waitcnt lgkmcnt(9)
    v_mfma_f32_32x32x16_bf16 v[176:191], v[52:55], v[56:59], v[176:191]
    v_mfma_f32_32x32x16_bf16 v[192:207], v[52:55], v[60:63], v[192:207]
    ds_read2_b64 v[52:55], v13 offset0:60 offset1:61
    ds_read_b128 v[56:59], v11 offset:4512
    ds_read_b128 v[60:63], v11 offset:7072
    s_waitcnt lgkmcnt(9)
    v_mfma_f32_32x32x16_bf16 v[176:191], v[16:19], v[20:23], v[176:191]
    v_mfma_f32_32x32x16_bf16 v[192:207], v[16:19], v[24:27], v[192:207]
    ds_read2_b64 v[16:19], v13 offset0:64 offset1:65
    ds_read_b128 v[20:23], v11 offset:4400
    ds_read_b128 v[24:27], v11 offset:6960
    s_waitcnt lgkmcnt(9)
    v_mfma_f32_32x32x16_bf16 v[176:191], v[28:31], v[32:35], v[176:191]
    v_mfma_f32_32x32x16_bf16 v[192:207], v[28:31], v[36:39], v[192:207]
    ds_read2_b64 v[28:31], v13 offset0:68 offset1:69
    ds_read_b128 v[32:35], v11 offset:4432
    ds_read_b128 v[36:39], v11 offset:6992
    s_waitcnt lgkmcnt(9)
    v_mfma_f32_32x32x16_bf16 v[176:191], v[40:43], v[44:47], v[176:191]
    v_mfma_f32_32x32x16_bf16 v[192:207], v[40:43], v[48:51], v[192:207]
    ds_read2_b64 v[40:43], v13 offset0:72 offset1:73
    ds_read_b128 v[44:47], v11 offset:4320
    ds_read_b128 v[48:51], v11 offset:6880
    s_waitcnt lgkmcnt(9)
    v_mfma_f32_32x32x16_bf16 v[176:191], v[52:55], v[56:59], v[176:191]
    v_mfma_f32_32x32x16_bf16 v[192:207], v[52:55], v[60:63], v[192:207]
    ds_read2_b64 v[52:55], v13 offset0:76 offset1:77
    ds_read_b128 v[56:59], v11 offset:4352
    ds_read_b128 v[60:63], v11 offset:6912
    s_waitcnt lgkmcnt(9)
    v_mfma_f32_32x32x16_bf16 v[176:191], v[16:19], v[20:23], v[176:191]
    v_mfma_f32_32x32x16_bf16 v[192:207], v[16:19], v[24:27], v[192:207]
    ds_read2_b64 v[16:19], v13 offset0:80 offset1:81
    ds_read_b128 v[20:23], v11 offset:4240
    ds_read_b128 v[24:27], v11 offset:6800
    s_waitcnt lgkmcnt(9)
    v_mfma_f32_32x32x16_bf16 v[176:191], v[28:31], v[32:35], v[176:191]
    v_mfma_f32_32x32x16_bf16 v[192:207], v[28:31], v[36:39], v[192:207]
    ds_read2_b64 v[28:31], v13 offset0:84 offset1:85
    ds_read_b128 v[32:35], v11 offset:4272
    ds_read_b128 v[36:39], v11 offset:6832
    s_waitcnt lgkmcnt(9)
    v_mfma_f32_32x32x16_bf16 v[176:191], v[40:43], v[44:47], v[176:191]
    v_mfma_f32_32x32x16_bf16 v[192:207], v[40:43], v[48:51], v[192:207]
    ds_read2_b64 v[40:43], v13 offset0:88 offset1:89
    ds_read_b128 v[44:47], v11 offset:4160
    ds_read_b128 v[48:51], v11 offset:6720
    s_waitcnt lgkmcnt(9)
    v_mfma_f32_32x32x16_bf16 v[176:191], v[52:55], v[56:59], v[176:191]
    v_mfma_f32_32x32x16_bf16 v[192:207], v[52:55], v[60:63], v[192:207]
    ds_read2_b64 v[52:55], v13 offset0:92 offset1:93
    ds_read_b128 v[56:59], v11 offset:4192
    ds_read_b128 v[60:63], v11 offset:6752
    s_waitcnt lgkmcnt(9)
    v_mfma_f32_32x32x16_bf16 v[176:191], v[16:19], v[20:23], v[176:191]
    v_mfma_f32_32x32x16_bf16 v[192:207], v[16:19], v[24:27], v[192:207]
    ds_read2_b64 v[16:19], v13 offset0:96 offset1:97
    ds_read_b128 v[20:23], v11 offset:4080
    ds_read_b128 v[24:27], v11 offset:6640
    s_waitcnt lgkmcnt(9)
    v_mfma_f32_32x32x16_bf16 v[176:191], v[28:31], v[32:35], v[176:191]
    v_mfma_f32_32x32x16_bf16 v[192:207], v[28:31], v[36:39], v[192:207]
    ds_read2_b64 v[28:31], v13 offset0:100 offset1:101
    ds_read_b128 v[32:35], v11 offset:4112
    ds_read_b128 v[36:39], v11 offset:6672
    s_waitcnt lgkmcnt(9)
    v_mfma_f32_32x32x16_bf16 v[176:191], v[40:43], v[44:47], v[176:191]
    v_mfma_f32_32x32x16_bf16 v[192:207], v[40:43], v[48:51], v[192:207]
    ds_read2_b64 v[40:43], v13 offset0:104 offset1:105
    ds_read_b128 v[44:47], v11 offset:4000
    ds_read_b128 v[48:51], v11 offset:6560
    s_waitcnt lgkmcnt(9)
    v_mfma_f32_32x32x16_bf16 v[176:191], v[52:55], v[56:59], v[176:191]
    v_mfma_f32_32x32x16_bf16 v[192:207], v[52:55], v[60:63], v[192:207]
    ds_read2_b64 v[52:55], v13 offset0:108 offset1:109
    ds_read_b128 v[56:59], v11 offset:4032
    ds_read_b128 v[60:63], v11 offset:6592
    s_waitcnt lgkmcnt(9)
    v_mfma_f32_32x32x16_bf16 v[176:191], v[16:19], v[20:23], v[176:191]
    v_mfma_f32_32x32x16_bf16 v[192:207], v[16:19], v[24:27], v[192:207]
    ds_read2_b64 v[16:19], v13 offset0:112 offset1:113
    ds_read_b128 v[20:23], v11 offset:3920
    ds_read_b128 v[24:27], v11 offset:6480
    s_waitcnt lgkmcnt(9)
    v_mfma_f32_32x32x16_bf16 v[176:191], v[28:31], v[32:35], v[176:191]
    v_mfma_f32_32x32x16_bf16 v[192:207], v[28:31], v[36:39], v[192:207]
    ds_read2_b64 v[28:31], v13 offset0:116 offset1:117
    ds_read_b128 v[32:35], v11 offset:3952
    ds_read_b128 v[36:39], v11 offset:6512
    s_waitcnt lgkmcnt(9)
    v_mfma_f32_32x32x16_bf16 v[176:191], v[40:43], v[44:47], v[176:191]
    v_mfma_f32_32x32x16_bf16 v[192:207], v[40:43], v[48:51], v[192:207]
    ds_read2_b64 v[40:43], v13 offset0:120 offset1:121
    ds_read_b128 v[44:47], v11 offset:3840
    ds_read_b128 v[48:51], v11 offset:6400
    s_waitcnt lgkmcnt(9)
    v_mfma_f32_32x32x16_bf16 v[176:191], v[52:55], v[56:59], v[176:191]
    v_mfma_f32_32x32x16_bf16 v[192:207], v[52:55], v[60:63], v[192:207]
    ds_read2_b64 v[52:55], v13 offset0:124 offset1:125
    ds_read_b128 v[56:59], v11 offset:3872
    ds_read_b128 v[60:63], v11 offset:6432
    s_waitcnt lgkmcnt(9)
    v_mfma_f32_32x32x16_bf16 v[176:191], v[16:19], v[20:23], v[176:191]
    v_mfma_f32_32x32x16_bf16 v[192:207], v[16:19], v[24:27], v[192:207]
    ds_read2_b64 v[16:19], v13 offset0:128 offset1:129
    ds_read_b128 v[20:23], v11 offset:3760
    ds_read_b128 v[24:27], v11 offset:6320
    s_waitcnt lgkmcnt(9)
    v_mfma_f32_32x32x16_bf16 v[176:191], v[28:31], v[32:35], v[176:191]
    v_mfma_f32_32x32x16_bf16 v[192:207], v[28:31], v[36:39], v[192:207]
    ds_read2_b64 v[28:31], v13 offset0:132 offset1:133
    ds_read_b128 v[32:35], v11 offset:3792
    ds_read_b128 v[36:39], v11 offset:6352
    s_waitcnt lgkmcnt(9)
    v_mfma_f32_32x32x16_bf16 v[176:191], v[40:43], v[44:47], v[176:191]
    v_mfma_f32_32x32x16_bf16 v[192:207], v[40:43], v[48:51], v[192:207]
    ds_read2_b64 v[40:43], v13 offset0:136 offset1:137
    ds_read_b128 v[44:47], v11 offset:3680
    ds_read_b128 v[48:51], v11 offset:6240
    s_waitcnt lgkmcnt(9)
    v_mfma_f32_32x32x16_bf16 v[176:191], v[52:55], v[56:59], v[176:191]
    v_mfma_f32_32x32x16_bf16 v[192:207], v[52:55], v[60:63], v[192:207]
    ds_read2_b64 v[52:55], v13 offset0:140 offset1:141
    ds_read_b128 v[56:59], v11 offset:3712
    ds_read_b128 v[60:63], v11 offset:6272
    s_waitcnt lgkmcnt(9)
    v_mfma_f32_32x32x16_bf16 v[176:191], v[16:19], v[20:23], v[176:191]
    v_mfma_f32_32x32x16_bf16 v[192:207], v[16:19], v[24:27], v[192:207]
    ds_read2_b64 v[16:19], v13 offset0:144 offset1:145
    ds_read_b128 v[20:23], v11 offset:3600
    ds_read_b128 v[24:27], v11 offset:6160
    s_waitcnt lgkmcnt(9)
    v_mfma_f32_32x32x16_bf16 v[176:191], v[28:31], v[32:35], v[176:191]
    v_mfma_f32_32x32x16_bf16 v[192:207], v[28:31], v[36:39], v[192:207]
    ds_read2_b64 v[28:31], v13 offset0:148 offset1:149
    ds_read_b128 v[32:35], v11 offset:3632
    ds_read_b128 v[36:39], v11 offset:6192
    s_waitcnt lgkmcnt(9)
    v_mfma_f32_32x32x16_bf16 v[176:191], v[40:43], v[44:47], v[176:191]
    v_mfma_f32_32x32x16_bf16 v[192:207], v[40:43], v[48:51], v[192:207]
    ds_read2_b64 v[40:43], v13 offset0:152 offset1:153
    ds_read_b128 v[44:47], v11 offset:3520
    ds_read_b128 v[48:51], v11 offset:6080
    s_waitcnt lgkmcnt(9)
    v_mfma_f32_32x32x16_bf16 v[176:191], v[52:55], v[56:59], v[176:191]
    v_mfma_f32_32x32x16_bf16 v[192:207], v[52:55], v[60:63], v[192:207]
    ds_read2_b64 v[52:55], v13 offset0:156 offset1:157
    ds_read_b128 v[56:59], v11 offset:3552
    ds_read_b128 v[60:63], v11 offset:6112
    s_waitcnt lgkmcnt(9)
    v_mfma_f32_32x32x16_bf16 v[176:191], v[16:19], v[20:23], v[176:191]
    v_mfma_f32_32x32x16_bf16 v[192:207], v[16:19], v[24:27], v[192:207]
    ds_read2_b64 v[16:19], v13 offset0:160 offset1:161
    ds_read_b128 v[20:23], v11 offset:3440
    ds_read_b128 v[24:27], v11 offset:6000
    s_waitcnt lgkmcnt(9)
    v_mfma_f32_32x32x16_bf16 v[176:191], v[28:31], v[32:35], v[176:191]
    v_mfma_f32_32x32x16_bf16 v[192:207], v[28:31], v[36:39], v[192:207]
    ds_read2_b64 v[28:31], v13 offset0:164 offset1:165
    ds_read_b128 v[32:35], v11 offset:3472
    ds_read_b128 v[36:39], v11 offset:6032
    s_waitcnt lgkmcnt(9)
    v_mfma_f32_32x32x16_bf16 v[176:191], v[40:43], v[44:47], v[176:191]
    v_mfma_f32_32x32x16_bf16 v[192:207], v[40:43], v[48:51], v[192:207]
    ds_read2_b64 v[40:43], v13 offset0:168 offset1:169
    ds_read_b128 v[44:47], v11 offset:3360
    ds_read_b128 v[48:51], v11 offset:5920
    s_waitcnt lgkmcnt(9)
    v_mfma_f32_32x32x16_bf16 v[176:191], v[52:55], v[56:59], v[176:191]
    v_mfma_f32_32x32x16_bf16 v[192:207], v[52:55], v[60:63], v[192:207]
    ds_read2_b64 v[52:55], v13 offset0:172 offset1:173
    ds_read_b128 v[56:59], v11 offset:3392
    ds_read_b128 v[60:63], v11 offset:5952
    s_waitcnt lgkmcnt(9)
    v_mfma_f32_32x32x16_bf16 v[176:191], v[16:19], v[20:23], v[176:191]
    v_mfma_f32_32x32x16_bf16 v[192:207], v[16:19], v[24:27], v[192:207]
    ds_read2_b64 v[16:19], v13 offset0:176 offset1:177
    ds_read_b128 v[20:23], v11 offset:3280
    ds_read_b128 v[24:27], v11 offset:5840
    s_waitcnt lgkmcnt(9)
    v_mfma_f32_32x32x16_bf16 v[176:191], v[28:31], v[32:35], v[176:191]
    v_mfma_f32_32x32x16_bf16 v[192:207], v[28:31], v[36:39], v[192:207]
    ds_read2_b64 v[28:31], v13 offset0:180 offset1:181
    ds_read_b128 v[32:35], v11 offset:3312
    ds_read_b128 v[36:39], v11 offset:5872
    s_waitcnt lgkmcnt(9)
    v_mfma_f32_32x32x16_bf16 v[176:191], v[40:43], v[44:47], v[176:191]
    v_mfma_f32_32x32x16_bf16 v[192:207], v[40:43], v[48:51], v[192:207]
    ds_read2_b64 v[40:43], v13 offset0:184 offset1:185
    ds_read_b128 v[44:47], v11 offset:3200
    ds_read_b128 v[48:51], v11 offset:5760
    s_waitcnt lgkmcnt(9)
    v_mfma_f32_32x32x16_bf16 v[176:191], v[52:55], v[56:59], v[176:191]
    v_mfma_f32_32x32x16_bf16 v[192:207], v[52:55], v[60:63], v[192:207]
    ds_read2_b64 v[52:55], v13 offset0:188 offset1:189
    ds_read_b128 v[56:59], v11 offset:3232
    ds_read_b128 v[60:63], v11 offset:5792
    s_waitcnt lgkmcnt(9)
    v_mfma_f32_32x32x16_bf16 v[176:191], v[16:19], v[20:23], v[176:191]
    v_mfma_f32_32x32x16_bf16 v[192:207], v[16:19], v[24:27], v[192:207]
    ds_read2_b64 v[16:19], v13 offset0:192 offset1:193
    ds_read_b128 v[20:23], v11 offset:3120
    ds_read_b128 v[24:27], v11 offset:5680
    s_waitcnt lgkmcnt(9)
    v_mfma_f32_32x32x16_bf16 v[176:191], v[28:31], v[32:35], v[176:191]
    v_mfma_f32_32x32x16_bf16 v[192:207], v[28:31], v[36:39], v[192:207]
    ds_read2_b64 v[28:31], v13 offset0:196 offset1:197
    ds_read_b128 v[32:35], v11 offset:3152
    ds_read_b128 v[36:39], v11 offset:5712
    s_waitcnt lgkmcnt(9)
    v_mfma_f32_32x32x16_bf16 v[176:191], v[40:43], v[44:47], v[176:191]
    v_mfma_f32_32x32x16_bf16 v[192:207], v[40:43], v[48:51], v[192:207]
    ds_read2_b64 v[40:43], v13 offset0:200 offset1:201
    ds_read_b128 v[44:47], v11 offset:3040
    ds_read_b128 v[48:51], v11 offset:5600
    s_waitcnt lgkmcnt(9)
    v_mfma_f32_32x32x16_bf16 v[176:191], v[52:55], v[56:59], v[176:191]
    v_mfma_f32_32x32x16_bf16 v[192:207], v[52:55], v[60:63], v[192:207]
    ds_read2_b64 v[52:55], v13 offset0:204 offset1:205
    ds_read_b128 v[56:59], v11 offset:3072
    ds_read_b128 v[60:63], v11 offset:5632
    s_waitcnt lgkmcnt(9)
    v_mfma_f32_32x32x16_bf16 v[176:191], v[16:19], v[20:23], v[176:191]
    v_mfma_f32_32x32x16_bf16 v[192:207], v[16:19], v[24:27], v[192:207]
    ds_read2_b64 v[16:19], v13 offset0:208 offset1:209
    ds_read_b128 v[20:23], v11 offset:2960
    ds_read_b128 v[24:27], v11 offset:5520
    s_waitcnt lgkmcnt(9)
    v_mfma_f32_32x32x16_bf16 v[176:191], v[28:31], v[32:35], v[176:191]
    v_mfma_f32_32x32x16_bf16 v[192:207], v[28:31], v[36:39], v[192:207]
    ds_read2_b64 v[28:31], v13 offset0:212 offset1:213
    ds_read_b128 v[32:35], v11 offset:2992
    ds_read_b128 v[36:39], v11 offset:5552
    s_waitcnt lgkmcnt(9)
    v_mfma_f32_32x32x16_bf16 v[176:191], v[40:43], v[44:47], v[176:191]
    v_mfma_f32_32x32x16_bf16 v[192:207], v[40:43], v[48:51], v[192:207]
    ds_read2_b64 v[40:43], v13 offset0:216 offset1:217
    ds_read_b128 v[44:47], v11 offset:2880
    ds_read_b128 v[48:51], v11 offset:5440
    s_waitcnt lgkmcnt(9)
    v_mfma_f32_32x32x16_bf16 v[176:191], v[52:55], v[56:59], v[176:191]
    v_mfma_f32_32x32x16_bf16 v[192:207], v[52:55], v[60:63], v[192:207]
    ds_read2_b64 v[52:55], v13 offset0:220 offset1:221
    ds_read_b128 v[56:59], v11 offset:2912
    ds_read_b128 v[60:63], v11 offset:5472
    s_waitcnt lgkmcnt(9)
    v_mfma_f32_32x32x16_bf16 v[176:191], v[16:19], v[20:23], v[176:191]
    v_mfma_f32_32x32x16_bf16 v[192:207], v[16:19], v[24:27], v[192:207]
    ds_read2_b64 v[16:19], v13 offset0:224 offset1:225
    ds_read_b128 v[20:23], v11 offset:2800
    ds_read_b128 v[24:27], v11 offset:5360
    s_waitcnt lgkmcnt(9)
    v_mfma_f32_32x32x16_bf16 v[176:191], v[28:31], v[32:35], v[176:191]
    v_mfma_f32_32x32x16_bf16 v[192:207], v[28:31], v[36:39], v[192:207]
    ds_read2_b64 v[28:31], v13 offset0:228 offset1:229
    ds_read_b128 v[32:35], v11 offset:2832
    ds_read_b128 v[36:39], v11 offset:5392
    s_waitcnt lgkmcnt(9)
    v_mfma_f32_32x32x16_bf16 v[176:191], v[40:43], v[44:47], v[176:191]
    v_mfma_f32_32x32x16_bf16 v[192:207], v[40:43], v[48:51], v[192:207]
    ds_read2_b64 v[40:43], v13 offset0:232 offset1:233
    ds_read_b128 v[44:47], v11 offset:2720
    ds_read_b128 v[48:51], v11 offset:5280
    s_waitcnt lgkmcnt(9)
    v_mfma_f32_32x32x16_bf16 v[176:191], v[52:55], v[56:59], v[176:191]
    v_mfma_f32_32x32x16_bf16 v[192:207], v[52:55], v[60:63], v[192:207]
    ds_read2_b64 v[52:55], v13 offset0:236 offset1:237
    ds_read_b128 v[56:59], v11 offset:2752
    ds_read_b128 v[60:63], v11 offset:5312
    s_waitcnt lgkmcnt(9)
    v_mfma_f32_32x32x16_bf16 v[176:191], v[16:19], v[20:23], v[176:191]
    v_mfma_f32_32x32x16_bf16 v[192:207], v[16:19], v[24:27], v[192:207]
    ds_read2_b64 v[16:19], v13 offset0:240 offset1:241
    ds_read_b128 v[20:23], v11 offset:2640
    ds_read_b128 v[24:27], v11 offset:5200
    s_waitcnt lgkmcnt(9)
    v_mfma_f32_32x32x16_bf16 v[176:191], v[28:31], v[32:35], v[176:191]
    v_mfma_f32_32x32x16_bf16 v[192:207], v[28:31], v[36:39], v[192:207]
    ds_read2_b64 v[28:31], v13 offset0:244 offset1:245
    ds_read_b128 v[32:35], v11 offset:2672
    ds_read_b128 v[36:39], v11 offset:5232
    s_waitcnt lgkmcnt(9)
    v_mfma_f32_32x32x16_bf16 v[176:191], v[40:43], v[44:47], v[176:191]
    v_mfma_f32_32x32x16_bf16 v[192:207], v[40:43], v[48:51], v[192:207]
    ds_read2_b64 v[40:43], v13 offset0:248 offset1:249
    ds_read_b128 v[44:47], v11 offset:2560
    ds_read_b128 v[48:51], v11 offset:5120
    s_waitcnt lgkmcnt(9)
    v_mfma_f32_32x32x16_bf16 v[176:191], v[52:55], v[56:59], v[176:191]
    v_mfma_f32_32x32x16_bf16 v[192:207], v[52:55], v[60:63], v[192:207]
    ds_read2_b64 v[52:55], v13 offset0:252 offset1:253
    ds_read_b128 v[56:59], v11 offset:2592
    ds_read_b128 v[60:63], v11 offset:5152
    s_waitcnt lgkmcnt(9)
    v_mfma_f32_32x32x16_bf16 v[176:191], v[16:19], v[20:23], v[176:191]
    v_mfma_f32_32x32x16_bf16 v[192:207], v[16:19], v[24:27], v[192:207]
    ds_read2_b64 v[16:19], v14 offset0:0 offset1:1
    ds_read_b128 v[24:27], v11 offset:5040
    s_waitcnt lgkmcnt(8)
    v_mfma_f32_32x32x16_bf16 v[176:191], v[28:31], v[32:35], v[176:191]
    v_mfma_f32_32x32x16_bf16 v[192:207], v[28:31], v[36:39], v[192:207]
    ds_read2_b64 v[28:31], v14 offset0:4 offset1:5
    ds_read_b128 v[36:39], v11 offset:5072
    s_waitcnt lgkmcnt(7)
    v_mfma_f32_32x32x16_bf16 v[176:191], v[40:43], v[44:47], v[176:191]
    v_mfma_f32_32x32x16_bf16 v[192:207], v[40:43], v[48:51], v[192:207]
    ds_read2_b64 v[40:43], v14 offset0:8 offset1:9
    ds_read_b128 v[48:51], v11 offset:4960
    s_waitcnt lgkmcnt(6)
    v_mfma_f32_32x32x16_bf16 v[176:191], v[52:55], v[56:59], v[176:191]
    v_mfma_f32_32x32x16_bf16 v[192:207], v[52:55], v[60:63], v[192:207]
    ds_read2_b64 v[52:55], v14 offset0:12 offset1:13
    ds_read_b128 v[60:63], v11 offset:4992
    s_waitcnt lgkmcnt(6)
    v_mfma_f32_32x32x16_bf16 v[192:207], v[16:19], v[24:27], v[192:207]
    ds_read2_b64 v[16:19], v14 offset0:16 offset1:17
    ds_read_b128 v[24:27], v11 offset:4880
    s_waitcnt lgkmcnt(6)
    v_mfma_f32_32x32x16_bf16 v[192:207], v[28:31], v[36:39], v[192:207]
    ds_read2_b64 v[28:31], v14 offset0:20 offset1:21
    ds_read_b128 v[36:39], v11 offset:4912
    s_waitcnt lgkmcnt(6)
    v_mfma_f32_32x32x16_bf16 v[192:207], v[40:43], v[48:51], v[192:207]
    ds_read2_b64 v[40:43], v14 offset0:24 offset1:25
    ds_read_b128 v[48:51], v11 offset:4800
    s_waitcnt lgkmcnt(6)
    v_mfma_f32_32x32x16_bf16 v[192:207], v[52:55], v[60:63], v[192:207]
    ds_read2_b64 v[52:55], v14 offset0:28 offset1:29
    ds_read_b128 v[60:63], v11 offset:4832
    s_waitcnt lgkmcnt(6)
    v_mfma_f32_32x32x16_bf16 v[192:207], v[16:19], v[24:27], v[192:207]
    ds_read2_b64 v[16:19], v14 offset0:32 offset1:33
    ds_read_b128 v[24:27], v11 offset:4720
    s_waitcnt lgkmcnt(6)
    v_mfma_f32_32x32x16_bf16 v[192:207], v[28:31], v[36:39], v[192:207]
    ds_read2_b64 v[28:31], v14 offset0:36 offset1:37
    ds_read_b128 v[36:39], v11 offset:4752
    s_waitcnt lgkmcnt(6)
    v_mfma_f32_32x32x16_bf16 v[192:207], v[40:43], v[48:51], v[192:207]
    ds_read2_b64 v[40:43], v14 offset0:40 offset1:41
    ds_read_b128 v[48:51], v11 offset:4640
    s_waitcnt lgkmcnt(6)
    v_mfma_f32_32x32x16_bf16 v[192:207], v[52:55], v[60:63], v[192:207]
    ds_read2_b64 v[52:55], v14 offset0:44 offset1:45
    ds_read_b128 v[60:63], v11 offset:4672
    s_waitcnt lgkmcnt(6)
    v_mfma_f32_32x32x16_bf16 v[192:207], v[16:19], v[24:27], v[192:207]
    ds_read2_b64 v[16:19], v14 offset0:48 offset1:49
    ds_read_b128 v[24:27], v11 offset:4560
    s_waitcnt lgkmcnt(6)
    v_mfma_f32_32x32x16_bf16 v[192:207], v[28:31], v[36:39], v[192:207]
    ds_read2_b64 v[28:31], v14 offset0:52 offset1:53
    ds_read_b128 v[36:39], v11 offset:4592
    s_waitcnt lgkmcnt(6)
    v_mfma_f32_32x32x16_bf16 v[192:207], v[40:43], v[48:51], v[192:207]
    ds_read2_b64 v[40:43], v14 offset0:56 offset1:57
    ds_read_b128 v[48:51], v11 offset:4480
    s_waitcnt lgkmcnt(6)
    v_mfma_f32_32x32x16_bf16 v[192:207], v[52:55], v[60:63], v[192:207]
    ds_read2_b64 v[52:55], v14 offset0:60 offset1:61
    ds_read_b128 v[60:63], v11 offset:4512
    s_waitcnt lgkmcnt(6)
    v_mfma_f32_32x32x16_bf16 v[192:207], v[16:19], v[24:27], v[192:207]
    ds_read2_b64 v[16:19], v14 offset0:64 offset1:65
    ds_read_b128 v[24:27], v11 offset:4400
    s_waitcnt lgkmcnt(6)
    v_mfma_f32_32x32x16_bf16 v[192:207], v[28:31], v[36:39], v[192:207]
    ds_read2_b64 v[28:31], v14 offset0:68 offset1:69
    ds_read_b128 v[36:39], v11 offset:4432
    s_waitcnt lgkmcnt(6)
    v_mfma_f32_32x32x16_bf16 v[192:207], v[40:43], v[48:51], v[192:207]
    ds_read2_b64 v[40:43], v14 offset0:72 offset1:73
    ds_read_b128 v[48:51], v11 offset:4320
    s_waitcnt lgkmcnt(6)
    v_mfma_f32_32x32x16_bf16 v[192:207], v[52:55], v[60:63], v[192:207]
    ds_read2_b64 v[52:55], v14 offset0:76 offset1:77
    ds_read_b128 v[60:63], v11 offset:4352
    s_waitcnt lgkmcnt(6)
    v_mfma_f32_32x32x16_bf16 v[192:207], v[16:19], v[24:27], v[192:207]
    ds_read2_b64 v[16:19], v14 offset0:80 offset1:81
    ds_read_b128 v[24:27], v11 offset:4240
    s_waitcnt lgkmcnt(6)
    v_mfma_f32_32x32x16_bf16 v[192:207], v[28:31], v[36:39], v[192:207]
    ds_read2_b64 v[28:31], v14 offset0:84 offset1:85
    ds_read_b128 v[36:39], v11 offset:4272
    s_waitcnt lgkmcnt(6)
    v_mfma_f32_32x32x16_bf16 v[192:207], v[40:43], v[48:51], v[192:207]
    ds_read2_b64 v[40:43], v14 offset0:88 offset1:89
    ds_read_b128 v[48:51], v11 offset:4160
    s_waitcnt lgkmcnt(6)
    v_mfma_f32_32x32x16_bf16 v[192:207], v[52:55], v[60:63], v[192:207]
    ds_read2_b64 v[52:55], v14 offset0:92 offset1:93
    ds_read_b128 v[60:63], v11 offset:4192
    s_waitcnt lgkmcnt(6)
    v_mfma_f32_32x32x16_bf16 v[192:207], v[16:19], v[24:27], v[192:207]
    ds_read2_b64 v[16:19], v14 offset0:96 offset1:97
    ds_read_b128 v[24:27], v11 offset:4080
    s_waitcnt lgkmcnt(6)
    v_mfma_f32_32x32x16_bf16 v[192:207], v[28:31], v[36:39], v[192:207]
    ds_read2_b64 v[28:31], v14 offset0:100 offset1:101
    ds_read_b128 v[36:39], v11 offset:4112
    s_waitcnt lgkmcnt(6)
    v_mfma_f32_32x32x16_bf16 v[192:207], v[40:43], v[48:51], v[192:207]
    ds_read2_b64 v[40:43], v14 offset0:104 offset1:105
    ds_read_b128 v[48:51], v11 offset:4000
    s_waitcnt lgkmcnt(6)
    v_mfma_f32_32x32x16_bf16 v[192:207], v[52:55], v[60:63], v[192:207]
    ds_read2_b64 v[52:55], v14 offset0:108 offset1:109
    ds_read_b128 v[60:63], v11 offset:4032
    s_waitcnt lgkmcnt(6)
    v_mfma_f32_32x32x16_bf16 v[192:207], v[16:19], v[24:27], v[192:207]
    ds_read2_b64 v[16:19], v14 offset0:112 offset1:113
    ds_read_b128 v[24:27], v11 offset:3920
    s_waitcnt lgkmcnt(6)
    v_mfma_f32_32x32x16_bf16 v[192:207], v[28:31], v[36:39], v[192:207]
    ds_read2_b64 v[28:31], v14 offset0:116 offset1:117
    ds_read_b128 v[36:39], v11 offset:3952
    s_waitcnt lgkmcnt(6)
    v_mfma_f32_32x32x16_bf16 v[192:207], v[40:43], v[48:51], v[192:207]
    ds_read2_b64 v[40:43], v14 offset0:120 offset1:121
    ds_read_b128 v[48:51], v11 offset:3840
    s_waitcnt lgkmcnt(6)
    v_mfma_f32_32x32x16_bf16 v[192:207], v[52:55], v[60:63], v[192:207]
    ds_read2_b64 v[52:55], v14 offset0:124 offset1:125
    ds_read_b128 v[60:63], v11 offset:3872
    s_waitcnt lgkmcnt(6)
    v_mfma_f32_32x32x16_bf16 v[192:207], v[16:19], v[24:27], v[192:207]
    ds_read2_b64 v[16:19], v14 offset0:128 offset1:129
    ds_read_b128 v[24:27], v11 offset:3760
    s_waitcnt lgkmcnt(6)
    v_mfma_f32_32x32x16_bf16 v[192:207], v[28:31], v[36:39], v[192:207]
    ds_read2_b64 v[28:31], v14 offset0:132 offset1:133
    ds_read_b128 v[36:39], v11 offset:3792
    s_waitcnt lgkmcnt(6)
    v_mfma_f32_32x32x16_bf16 v[192:207], v[40:43], v[48:51], v[192:207]
    ds_read2_b64 v[40:43], v14 offset0:136 offset1:137
    ds_read_b128 v[48:51], v11 offset:3680
    s_waitcnt lgkmcnt(6)
    v_mfma_f32_32x32x16_bf16 v[192:207], v[52:55], v[60:63], v[192:207]
    ds_read2_b64 v[52:55], v14 offset0:140 offset1:141
    ds_read_b128 v[60:63], v11 offset:3712
    s_waitcnt lgkmcnt(6)
    v_mfma_f32_32x32x16_bf16 v[192:207], v[16:19], v[24:27], v[192:207]
    ds_read2_b64 v[16:19], v14 offset0:144 offset1:145
    ds_read_b128 v[24:27], v11 offset:3600
    s_waitcnt lgkmcnt(6)
    v_mfma_f32_32x32x16_bf16 v[192:207], v[28:31], v[36:39], v[192:207]
    ds_read2_b64 v[28:31], v14 offset0:148 offset1:149
    ds_read_b128 v[36:39], v11 offset:3632
    s_waitcnt lgkmcnt(6)
    v_mfma_f32_32x32x16_bf16 v[192:207], v[40:43], v[48:51], v[192:207]
    ds_read2_b64 v[40:43], v14 offset0:152 offset1:153
    ds_read_b128 v[48:51], v11 offset:3520
    s_waitcnt lgkmcnt(6)
    v_mfma_f32_32x32x16_bf16 v[192:207], v[52:55], v[60:63], v[192:207]
    ds_read2_b64 v[52:55], v14 offset0:156 offset1:157
    ds_read_b128 v[60:63], v11 offset:3552
    s_waitcnt lgkmcnt(6)
    v_mfma_f32_32x32x16_bf16 v[192:207], v[16:19], v[24:27], v[192:207]
    ds_read2_b64 v[16:19], v14 offset0:160 offset1:161
    ds_read_b128 v[24:27], v11 offset:3440
    s_waitcnt lgkmcnt(6)
    v_mfma_f32_32x32x16_bf16 v[192:207], v[28:31], v[36:39], v[192:207]
    ds_read2_b64 v[28:31], v14 offset0:164 offset1:165
    ds_read_b128 v[36:39], v11 offset:3472
    s_waitcnt lgkmcnt(6)
    v_mfma_f32_32x32x16_bf16 v[192:207], v[40:43], v[48:51], v[192:207]
    ds_read2_b64 v[40:43], v14 offset0:168 offset1:169
    ds_read_b128 v[48:51], v11 offset:3360
    s_waitcnt lgkmcnt(6)
    v_mfma_f32_32x32x16_bf16 v[192:207], v[52:55], v[60:63], v[192:207]
    ds_read2_b64 v[52:55], v14 offset0:172 offset1:173
    ds_read_b128 v[60:63], v11 offset:3392
    s_waitcnt lgkmcnt(6)
    v_mfma_f32_32x32x16_bf16 v[192:207], v[16:19], v[24:27], v[192:207]
    ds_read2_b64 v[16:19], v14 offset0:176 offset1:177
    ds_read_b128 v[24:27], v11 offset:3280
    s_waitcnt lgkmcnt(6)
    v_mfma_f32_32x32x16_bf16 v[192:207], v[28:31], v[36:39], v[192:207]
    ds_read2_b64 v[28:31], v14 offset0:180 offset1:181
    ds_read_b128 v[36:39], v11 offset:3312
    s_waitcnt lgkmcnt(6)
    v_mfma_f32_32x32x16_bf16 v[192:207], v[40:43], v[48:51], v[192:207]
    ds_read2_b64 v[40:43], v14 offset0:184 offset1:185
    ds_read_b128 v[48:51], v11 offset:3200
    s_waitcnt lgkmcnt(6)
    v_mfma_f32_32x32x16_bf16 v[192:207], v[52:55], v[60:63], v[192:207]
    ds_read2_b64 v[52:55], v14 offset0:188 offset1:189
    ds_read_b128 v[60:63], v11 offset:3232
    s_waitcnt lgkmcnt(6)
    v_mfma_f32_32x32x16_bf16 v[192:207], v[16:19], v[24:27], v[192:207]
    ds_read2_b64 v[16:19], v14 offset0:192 offset1:193
    ds_read_b128 v[24:27], v11 offset:3120
    s_waitcnt lgkmcnt(6)
    v_mfma_f32_32x32x16_bf16 v[192:207], v[28:31], v[36:39], v[192:207]
    ds_read2_b64 v[28:31], v14 offset0:196 offset1:197
    ds_read_b128 v[36:39], v11 offset:3152
    s_waitcnt lgkmcnt(6)
    v_mfma_f32_32x32x16_bf16 v[192:207], v[40:43], v[48:51], v[192:207]
    ds_read2_b64 v[40:43], v14 offset0:200 offset1:201
    ds_read_b128 v[48:51], v11 offset:3040
    s_waitcnt lgkmcnt(6)
    v_mfma_f32_32x32x16_bf16 v[192:207], v[52:55], v[60:63], v[192:207]
    ds_read2_b64 v[52:55], v14 offset0:204 offset1:205
    ds_read_b128 v[60:63], v11 offset:3072
    s_waitcnt lgkmcnt(6)
    v_mfma_f32_32x32x16_bf16 v[192:207], v[16:19], v[24:27], v[192:207]
    ds_read2_b64 v[16:19], v14 offset0:208 offset1:209
    ds_read_b128 v[24:27], v11 offset:2960
    s_waitcnt lgkmcnt(6)
    v_mfma_f32_32x32x16_bf16 v[192:207], v[28:31], v[36:39], v[192:207]
    ds_read2_b64 v[28:31], v14 offset0:212 offset1:213
    ds_read_b128 v[36:39], v11 offset:2992
    s_waitcnt lgkmcnt(6)
    v_mfma_f32_32x32x16_bf16 v[192:207], v[40:43], v[48:51], v[192:207]
    ds_read2_b64 v[40:43], v14 offset0:216 offset1:217
    ds_read_b128 v[48:51], v11 offset:2880
    s_waitcnt lgkmcnt(6)
    v_mfma_f32_32x32x16_bf16 v[192:207], v[52:55], v[60:63], v[192:207]
    ds_read2_b64 v[52:55], v14 offset0:220 offset1:221
    ds_read_b128 v[60:63], v11 offset:2912
    s_waitcnt lgkmcnt(6)
    v_mfma_f32_32x32x16_bf16 v[192:207], v[16:19], v[24:27], v[192:207]
    ds_read2_b64 v[16:19], v14 offset0:224 offset1:225
    ds_read_b128 v[24:27], v11 offset:2800
    s_waitcnt lgkmcnt(6)
    v_mfma_f32_32x32x16_bf16 v[192:207], v[28:31], v[36:39], v[192:207]
    ds_read2_b64 v[28:31], v14 offset0:228 offset1:229
    ds_read_b128 v[36:39], v11 offset:2832
    s_waitcnt lgkmcnt(6)
    v_mfma_f32_32x32x16_bf16 v[192:207], v[40:43], v[48:51], v[192:207]
    ds_read2_b64 v[40:43], v14 offset0:232 offset1:233
    ds_read_b128 v[48:51], v11 offset:2720
    s_waitcnt lgkmcnt(6)
    v_mfma_f32_32x32x16_bf16 v[192:207], v[52:55], v[60:63], v[192:207]
    ds_read2_b64 v[52:55], v14 offset0:236 offset1:237
    ds_read_b128 v[60:63], v11 offset:2752
    s_waitcnt lgkmcnt(6)
    v_mfma_f32_32x32x16_bf16 v[192:207], v[16:19], v[24:27], v[192:207]
    ds_read2_b64 v[16:19], v14 offset0:240 offset1:241
    ds_read_b128 v[24:27], v11 offset:2640
    s_waitcnt lgkmcnt(6)
    v_mfma_f32_32x32x16_bf16 v[192:207], v[28:31], v[36:39], v[192:207]
    ds_read2_b64 v[28:31], v14 offset0:244 offset1:245
    ds_read_b128 v[36:39], v11 offset:2672
    s_waitcnt lgkmcnt(6)
    v_mfma_f32_32x32x16_bf16 v[192:207], v[40:43], v[48:51], v[192:207]
    ds_read2_b64 v[40:43], v14 offset0:248 offset1:249
    ds_read_b128 v[48:51], v11 offset:2560
    s_waitcnt lgkmcnt(6)
    v_mfma_f32_32x32x16_bf16 v[192:207], v[52:55], v[60:63], v[192:207]
    ds_read2_b64 v[52:55], v14 offset0:252 offset1:253
    ds_read_b128 v[60:63], v11 offset:2592
    s_waitcnt lgkmcnt(6)
    v_mfma_f32_32x32x16_bf16 v[192:207], v[16:19], v[24:27], v[192:207]
    s_waitcnt lgkmcnt(4)
    v_mfma_f32_32x32x16_bf16 v[192:207], v[28:31], v[36:39], v[192:207]
    s_waitcnt lgkmcnt(2)
    v_mfma_f32_32x32x16_bf16 v[192:207], v[40:43], v[48:51], v[192:207]
    s_waitcnt lgkmcnt(0)
    v_mfma_f32_32x32x16_bf16 v[192:207], v[52:55], v[60:63], v[192:207]
    s_nop 15
    v_cvt_pk_bf16_f32 v176, v176, v177
    v_cvt_pk_bf16_f32 v177, v178, v179
    ds_write_b64 v10, v[176:177] offset:2560
    v_cvt_pk_bf16_f32 v180, v180, v181
    v_cvt_pk_bf16_f32 v181, v182, v183
    ds_write_b64 v10, v[180:181] offset:2576
    v_cvt_pk_bf16_f32 v184, v184, v185
    v_cvt_pk_bf16_f32 v185, v186, v187
    ds_write_b64 v10, v[184:185] offset:2592
    v_cvt_pk_bf16_f32 v188, v188, v189
    v_cvt_pk_bf16_f32 v189, v190, v191
    ds_write_b64 v10, v[188:189] offset:2608
    v_cvt_pk_bf16_f32 v192, v192, v193
    v_cvt_pk_bf16_f32 v193, v194, v195
    ds_write_b64 v10, v[192:193] offset:5120
    v_cvt_pk_bf16_f32 v196, v196, v197
    v_cvt_pk_bf16_f32 v197, v198, v199
    ds_write_b64 v10, v[196:197] offset:5136
    v_cvt_pk_bf16_f32 v200, v200, v201
    v_cvt_pk_bf16_f32 v201, v202, v203
    ds_write_b64 v10, v[200:201] offset:5152
    v_cvt_pk_bf16_f32 v204, v204, v205
    v_cvt_pk_bf16_f32 v205, v206, v207
    ds_write_b64 v10, v[204:205] offset:5168
    s_add_u32 s53, s53, 4
    s_cmp_lt_u32 s53, 8
    s_cbranch_scc1 L_cv_round
    s_waitcnt lgkmcnt(0)
    s_barrier
    ds_read_b128 v[16:19], v6 offset:5120
    ds_read_b128 v[20:23], v6 offset:12800
    ds_read_b128 v[24:27], v6 offset:20480
    ds_read_b128 v[28:31], v6 offset:28160
    ds_read_b128 v[32:35], v6 offset:35840
    ds_read_b128 v[36:39], v6 offset:43520
    ds_read_b128 v[40:43], v6 offset:51200
    ds_read_b128 v[44:47], v6 offset:58880
    v_lshlrev_b32 v2, 14, v0
    v_add_u32 v2, s42, v2
    s_waitcnt lgkmcnt(0)
    v_and_b32 v216, s43, v99
    v_lshlrev_b32 v200, 16, v16
    v_mul_f32 v216, s44, v216
    v_and_b32 v217, s43, v103
    v_lshlrev_b32 v201, 16, v20
    v_mul_f32 v217, s45, v217
    v_lshlrev_b32 v218, 16, v99
    v_and_b32 v202, s43, v16
    v_mul_f32 v218, s44, v218
    v_lshlrev_b32 v219, 16, v103
    v_and_b32 v203, s43, v20
    v_mul_f32 v219, s45, v219
    v_and_b32 v220, s43, v98
    v_lshlrev_b32 v204, 16, v17
    v_mul_f32 v220, s44, v220
    v_and_b32 v221, s43, v102
    v_lshlrev_b32 v205, 16, v21
    v_mul_f32 v221, s45, v221
    v_lshlrev_b32 v222, 16, v98
    v_and_b32 v206, s43, v17
    v_mul_f32 v222, s44, v222
    v_lshlrev_b32 v223, 16, v102
    v_and_b32 v207, s43, v21
    v_mul_f32 v223, s45, v223
    v_and_b32 v224, s43, v97
    v_lshlrev_b32 v208, 16, v18
    v_mul_f32 v224, s44, v224
    v_and_b32 v225, s43, v101
    v_lshlrev_b32 v209, 16, v22
    v_mul_f32 v225, s45, v225
    v_lshlrev_b32 v226, 16, v97
    v_and_b32 v210, s43, v18
    v_mul_f32 v226, s44, v226
    v_lshlrev_b32 v227, 16, v101
    v_and_b32 v211, s43, v22
    v_mul_f32 v227, s45, v227
    v_and_b32 v228, s43, v96
    v_lshlrev_b32 v212, 16, v19
    v_mul_f32 v228, s44, v228
    v_and_b32 v229, s43, v100
    v_lshlrev_b32 v213, 16, v23
    v_mul_f32 v229, s45, v229
    v_lshlrev_b32 v230, 16, v96
    v_and_b32 v214, s43, v19
    v_mul_f32 v230, s44, v230
    v_lshlrev_b32 v231, 16, v100
    v_and_b32 v215, s43, v23
    v_mul_f32 v231, s45, v231
    v_cvt_pk_bf16_f32 v217, v216, v217
    v_lshlrev_b32 v216, 16, v217
    v_and_b32 v217, s43, v217
    v_cvt_pk_bf16_f32 v219, v218, v219
    v_lshlrev_b32 v218, 16, v219
    v_and_b32 v219, s43, v219
    v_cvt_pk_bf16_f32 v221, v220, v221
    v_lshlrev_b32 v220, 16, v221
    v_and_b32 v221, s43, v221
    v_cvt_pk_bf16_f32 v223, v222, v223
    v_lshlrev_b32 v222, 16, v223
    v_and_b32 v223, s43, v223
    v_cvt_pk_bf16_f32 v225, v224, v225
    v_lshlrev_b32 v224, 16, v225
    v_and_b32 v225, s43, v225
    v_cvt_pk_bf16_f32 v227, v226, v227
    v_lshlrev_b32 v226, 16, v227
    v_and_b32 v227, s43, v227
    v_cvt_pk_bf16_f32 v229, v228, v229
    v_lshlrev_b32 v228, 16, v229
    v_and_b32 v229, s43, v229
    v_cvt_pk_bf16_f32 v231, v230, v231
    v_lshlrev_b32 v230, 16, v231
    v_and_b32 v231, s43, v231
    v_add_f32 v200, v200, v216
    v_add_f32 v201, v201, v217
    v_add_f32 v202, v202, v218
    v_add_f32 v203, v203, v219
    v_add_f32 v204, v204, v220
    v_add_f32 v205, v205, v221
    v_add_f32 v206, v206, v222
    v_add_f32 v207, v207, v223
    v_add_f32 v208, v208, v224
    v_add_f32 v209, v209, v225
    v_add_f32 v210, v210, v226
    v_add_f32 v211, v211, v227
    v_add_f32 v212, v212, v228
    v_add_f32 v213, v213, v229
    v_add_f32 v214, v214, v230
    v_add_f32 v215, v215, v231
    v_cvt_pk_bf16_f32 v201, v200, v201
    v_lshlrev_b32 v200, 16, v201
    v_and_b32 v201, s43, v201
    v_cvt_pk_bf16_f32 v203, v202, v203
    v_lshlrev_b32 v202, 16, v203
    v_and_b32 v203, s43, v203
    v_cvt_pk_bf16_f32 v205, v204, v205
    v_lshlrev_b32 v204, 16, v205
    v_and_b32 v205, s43, v205
    v_cvt_pk_bf16_f32 v207, v206, v207
    v_lshlrev_b32 v206, 16, v207
    v_and_b32 v207, s43, v207
    v_cvt_pk_bf16_f32 v209, v208, v209
    v_lshlrev_b32 v208, 16, v209
    v_and_b32 v209, s43, v209
    v_cvt_pk_bf16_f32 v211, v210, v211
    v_lshlrev_b32 v210, 16, v211
    v_and_b32 v211, s43, v211
    v_cvt_pk_bf16_f32 v213, v212, v213
    v_lshlrev_b32 v212, 16, v213
    v_and_b32 v213, s43, v213
    v_cvt_pk_bf16_f32 v215, v214, v215
    v_lshlrev_b32 v214, 16, v215
    v_and_b32 v215, s43, v215
    v_lshlrev_b32 v216, 16, v128
    v_and_b32 v217, s43, v128
    v_lshlrev_b32 v218, 16, v132
    v_and_b32 v219, s43, v132
    v_lshlrev_b32 v220, 16, v136
    v_and_b32 v221, s43, v136
    v_lshlrev_b32 v222, 16, v140
    v_and_b32 v223, s43, v140
    v_lshlrev_b32 v224, 16, v144
    v_and_b32 v225, s43, v144
    v_lshlrev_b32 v226, 16, v148
    v_and_b32 v227, s43, v148
    v_lshlrev_b32 v228, 16, v152
    v_and_b32 v229, s43, v152
    v_lshlrev_b32 v230, 16, v156
    v_and_b32 v231, s43, v156
    v_mul_f32 v200, v200, v216
    v_mul_f32 v201, v201, v217
    v_mul_f32 v202, v202, v218
    v_mul_f32 v203, v203, v219
    v_mul_f32 v204, v204, v220
    v_mul_f32 v205, v205, v221
    v_mul_f32 v206, v206, v222
    v_mul_f32 v207, v207, v223
    v_mul_f32 v208, v208, v224
    v_mul_f32 v209, v209, v225
    v_mul_f32 v210, v210, v226
    v_mul_f32 v211, v211, v227
    v_mul_f32 v212, v212, v228
    v_mul_f32 v213, v213, v229
    v_mul_f32 v214, v214, v230
    v_mul_f32 v215, v215, v231
    v_cvt_pk_bf16_f32 v64, v200, v201
    v_cvt_pk_bf16_f32 v68, v202, v203
    v_cvt_pk_bf16_f32 v72, v204, v205
    v_cvt_pk_bf16_f32 v76, v206, v207
    v_cvt_pk_bf16_f32 v80, v208, v209
    v_cvt_pk_bf16_f32 v84, v210, v211
    v_cvt_pk_bf16_f32 v88, v212, v213
    v_cvt_pk_bf16_f32 v92, v214, v215
    v_and_b32 v216, s43, v107
    v_lshlrev_b32 v200, 16, v24
    v_mul_f32 v216, s46, v216
    v_and_b32 v217, s43, v111
    v_lshlrev_b32 v201, 16, v28
    v_mul_f32 v217, s47, v217
    v_lshlrev_b32 v218, 16, v107
    v_and_b32 v202, s43, v24
    v_mul_f32 v218, s46, v218
    v_lshlrev_b32 v219, 16, v111
    v_and_b32 v203, s43, v28
    v_mul_f32 v219, s47, v219
    v_and_b32 v220, s43, v106
    v_lshlrev_b32 v204, 16, v25
    v_mul_f32 v220, s46, v220
    v_and_b32 v221, s43, v110
    v_lshlrev_b32 v205, 16, v29
    v_mul_f32 v221, s47, v221
    v_lshlrev_b32 v222, 16, v106
    v_and_b32 v206, s43, v25
    v_mul_f32 v222, s46, v222
    v_lshlrev_b32 v223, 16, v110
    v_and_b32 v207, s43, v29
    v_mul_f32 v223, s47, v223
    v_and_b32 v224, s43, v105
    v_lshlrev_b32 v208, 16, v26
    v_mul_f32 v224, s46, v224
    v_and_b32 v225, s43, v109
    v_lshlrev_b32 v209, 16, v30
    v_mul_f32 v225, s47, v225
    v_lshlrev_b32 v226, 16, v105
    v_and_b32 v210, s43, v26
    v_mul_f32 v226, s46, v226
    v_lshlrev_b32 v227, 16, v109
    v_and_b32 v211, s43, v30
    v_mul_f32 v227, s47, v227
    v_and_b32 v228, s43, v104
    v_lshlrev_b32 v212, 16, v27
    v_mul_f32 v228, s46, v228
    v_and_b32 v229, s43, v108
    v_lshlrev_b32 v213, 16, v31
    v_mul_f32 v229, s47, v229
    v_lshlrev_b32 v230, 16, v104
    v_and_b32 v214, s43, v27
    v_mul_f32 v230, s46, v230
    v_lshlrev_b32 v231, 16, v108
    v_and_b32 v215, s43, v31
    v_mul_f32 v231, s47, v231
    v_cvt_pk_bf16_f32 v217, v216, v217
    v_lshlrev_b32 v216, 16, v217
    v_and_b32 v217, s43, v217
    v_cvt_pk_bf16_f32 v219, v218, v219
    v_lshlrev_b32 v218, 16, v219
    v_and_b32 v219, s43, v219
    v_cvt_pk_bf16_f32 v221, v220, v221
    v_lshlrev_b32 v220, 16, v221
    v_and_b32 v221, s43, v221
    v_cvt_pk_bf16_f32 v223, v222, v223
    v_lshlrev_b32 v222, 16, v223
    v_and_b32 v223, s43, v223
    v_cvt_pk_bf16_f32 v225, v224, v225
    v_lshlrev_b32 v224, 16, v225
    v_and_b32 v225, s43, v225
    v_cvt_pk_bf16_f32 v227, v226, v227
    v_lshlrev_b32 v226, 16, v227
    v_and_b32 v227, s43, v227
    v_cvt_pk_bf16_f32 v229, v228, v229
    v_lshlrev_b32 v228, 16, v229
    v_and_b32 v229, s43, v229
    v_cvt_pk_bf16_f32 v231, v230, v231
    v_lshlrev_b32 v230, 16, v231
    v_and_b32 v231, s43, v231
    v_add_f32 v200, v200, v216
    v_add_f32 v201, v201, v217
    v_add_f32 v202, v202, v218
    v_add_f32 v203, v203, v219
    v_add_f32 v204, v204, v220
    v_add_f32 v205, v205, v221
    v_add_f32 v206, v206, v222
    v_add_f32 v207, v207, v223
    v_add_f32 v208, v208, v224
    v_add_f32 v209, v209, v225
    v_add_f32 v210, v210, v226
    v_add_f32 v211, v211, v227
    v_add_f32 v212, v212, v228
    v_add_f32 v213, v213, v229
    v_add_f32 v214, v214, v230
    v_add_f32 v215, v215, v231
    v_cvt_pk_bf16_f32 v201, v200, v201
    v_lshlrev_b32 v200, 16, v201
    v_and_b32 v201, s43, v201
    v_cvt_pk_bf16_f32 v203, v202, v203
    v_lshlrev_b32 v202, 16, v203
    v_and_b32 v203, s43, v203
    v_cvt_pk_bf16_f32 v205, v204, v205
    v_lshlrev_b32 v204, 16, v205
    v_and_b32 v205, s43, v205
    v_cvt_pk_bf16_f32 v207, v206, v207
    v_lshlrev_b32 v206, 16, v207
    v_and_b32 v207, s43, v207
    v_cvt_pk_bf16_f32 v209, v208, v209
    v_lshlrev_b32 v208, 16, v209
    v_and_b32 v209, s43, v209
    v_cvt_pk_bf16_f32 v211, v210, v211
    v_lshlrev_b32 v210, 16, v211
    v_and_b32 v211, s43, v211
    v_cvt_pk_bf16_f32 v213, v212, v213
    v_lshlrev_b32 v212, 16, v213
    v_and_b32 v213, s43, v213
    v_cvt_pk_bf16_f32 v215, v214, v215
    v_lshlrev_b32 v214, 16, v215
    v_and_b32 v215, s43, v215
    v_lshlrev_b32 v216, 16, v129
    v_and_b32 v217, s43, v129
    v_lshlrev_b32 v218, 16, v133
    v_and_b32 v219, s43, v133
    v_lshlrev_b32 v220, 16, v137
    v_and_b32 v221, s43, v137
    v_lshlrev_b32 v222, 16, v141
    v_and_b32 v223, s43, v141
    v_lshlrev_b32 v224, 16, v145
    v_and_b32 v225, s43, v145
    v_lshlrev_b32 v226, 16, v149
    v_and_b32 v227, s43, v149
    v_lshlrev_b32 v228, 16, v153
    v_and_b32 v229, s43, v153
    v_lshlrev_b32 v230, 16, v157
    v_and_b32 v231, s43, v157
    v_mul_f32 v200, v200, v216
    v_mul_f32 v201, v201, v217
    v_mul_f32 v202, v202, v218
    v_mul_f32 v203, v203, v219
    v_mul_f32 v204, v204, v220
    v_mul_f32 v205, v205, v221
    v_mul_f32 v206, v206, v222
    v_mul_f32 v207, v207, v223
    v_mul_f32 v208, v208, v224
    v_mul_f32 v209, v209, v225
    v_mul_f32 v210, v210, v226
    v_mul_f32 v211, v211, v227
    v_mul_f32 v212, v212, v228
    v_mul_f32 v213, v213, v229
    v_mul_f32 v214, v214, v230
    v_mul_f32 v215, v215, v231
    v_cvt_pk_bf16_f32 v65, v200, v201
    v_cvt_pk_bf16_f32 v69, v202, v203
    v_cvt_pk_bf16_f32 v73, v204, v205
    v_cvt_pk_bf16_f32 v77, v206, v207
    v_cvt_pk_bf16_f32 v81, v208, v209
    v_cvt_pk_bf16_f32 v85, v210, v211
    v_cvt_pk_bf16_f32 v89, v212, v213
    v_cvt_pk_bf16_f32 v93, v214, v215
    v_and_b32 v216, s43, v115
    v_lshlrev_b32 v200, 16, v32
    v_mul_f32 v216, s48, v216
    v_and_b32 v217, s43, v119
    v_lshlrev_b32 v201, 16, v36
    v_mul_f32 v217, s49, v217
    v_lshlrev_b32 v218, 16, v115
    v_and_b32 v202, s43, v32
    v_mul_f32 v218, s48, v218
    v_lshlrev_b32 v219, 16, v119
    v_and_b32 v203, s43, v36
    v_mul_f32 v219, s49, v219
    v_and_b32 v220, s43, v114
    v_lshlrev_b32 v204, 16, v33
    v_mul_f32 v220, s48, v220
    v_and_b32 v221, s43, v118
    v_lshlrev_b32 v205, 16, v37
    v_mul_f32 v221, s49, v221
    v_lshlrev_b32 v222, 16, v114
    v_and_b32 v206, s43, v33
    v_mul_f32 v222, s48, v222
    v_lshlrev_b32 v223, 16, v118
    v_and_b32 v207, s43, v37
    v_mul_f32 v223, s49, v223
    v_and_b32 v224, s43, v113
    v_lshlrev_b32 v208, 16, v34
    v_mul_f32 v224, s48, v224
    v_and_b32 v225, s43, v117
    v_lshlrev_b32 v209, 16, v38
    v_mul_f32 v225, s49, v225
    v_lshlrev_b32 v226, 16, v113
    v_and_b32 v210, s43, v34
    v_mul_f32 v226, s48, v226
    v_lshlrev_b32 v227, 16, v117
    v_and_b32 v211, s43, v38
    v_mul_f32 v227, s49, v227
    v_and_b32 v228, s43, v112
    v_lshlrev_b32 v212, 16, v35
    v_mul_f32 v228, s48, v228
    v_and_b32 v229, s43, v116
    v_lshlrev_b32 v213, 16, v39
    v_mul_f32 v229, s49, v229
    v_lshlrev_b32 v230, 16, v112
    v_and_b32 v214, s43, v35
    v_mul_f32 v230, s48, v230
    v_lshlrev_b32 v231, 16, v116
    v_and_b32 v215, s43, v39
    v_mul_f32 v231, s49, v231
    v_cvt_pk_bf16_f32 v217, v216, v217
    v_lshlrev_b32 v216, 16, v217
    v_and_b32 v217, s43, v217
    v_cvt_pk_bf16_f32 v219, v218, v219
    v_lshlrev_b32 v218, 16, v219
    v_and_b32 v219, s43, v219
    v_cvt_pk_bf16_f32 v221, v220, v221
    v_lshlrev_b32 v220, 16, v221
    v_and_b32 v221, s43, v221
    v_cvt_pk_bf16_f32 v223, v222, v223
    v_lshlrev_b32 v222, 16, v223
    v_and_b32 v223, s43, v223
    v_cvt_pk_bf16_f32 v225, v224, v225
    v_lshlrev_b32 v224, 16, v225
    v_and_b32 v225, s43, v225
    v_cvt_pk_bf16_f32 v227, v226, v227
    v_lshlrev_b32 v226, 16, v227
    v_and_b32 v227, s43, v227
    v_cvt_pk_bf16_f32 v229, v228, v229
    v_lshlrev_b32 v228, 16, v229
    v_and_b32 v229, s43, v229
    v_cvt_pk_bf16_f32 v231, v230, v231
    v_lshlrev_b32 v230, 16, v231
    v_and_b32 v231, s43, v231
    v_add_f32 v200, v200, v216
    v_add_f32 v201, v201, v217
    v_add_f32 v202, v202, v218
    v_add_f32 v203, v203, v219
    v_add_f32 v204, v204, v220
    v_add_f32 v205, v205, v221
    v_add_f32 v206, v206, v222
    v_add_f32 v207, v207, v223
    v_add_f32 v208, v208, v224
    v_add_f32 v209, v209, v225
    v_add_f32 v210, v210, v226
    v_add_f32 v211, v211, v227
    v_add_f32 v212, v212, v228
    v_add_f32 v213, v213, v229
    v_add_f32 v214, v214, v230
    v_add_f32 v215, v215, v231
    v_cvt_pk_bf16_f32 v201, v200, v201
    v_lshlrev_b32 v200, 16, v201
    v_and_b32 v201, s43, v201
    v_cvt_pk_bf16_f32 v203, v202, v203
    v_lshlrev_b32 v202, 16, v203
    v_and_b32 v203, s43, v203
    v_cvt_pk_bf16_f32 v205, v204, v205
    v_lshlrev_b32 v204, 16, v205
    v_and_b32 v205, s43, v205
    v_cvt_pk_bf16_f32 v207, v206, v207
    v_lshlrev_b32 v206, 16, v207
    v_and_b32 v207, s43, v207
    v_cvt_pk_bf16_f32 v209, v208, v209
    v_lshlrev_b32 v208, 16, v209
    v_and_b32 v209, s43, v209
    v_cvt_pk_bf16_f32 v211, v210, v211
    v_lshlrev_b32 v210, 16, v211
    v_and_b32 v211, s43, v211
    v_cvt_pk_bf16_f32 v213, v212, v213
    v_lshlrev_b32 v212, 16, v213
    v_and_b32 v213, s43, v213
    v_cvt_pk_bf16_f32 v215, v214, v215
    v_lshlrev_b32 v214, 16, v215
    v_and_b32 v215, s43, v215
    v_lshlrev_b32 v216, 16, v130
    v_and_b32 v217, s43, v130
    v_lshlrev_b32 v218, 16, v134
    v_and_b32 v219, s43, v134
    v_lshlrev_b32 v220, 16, v138
    v_and_b32 v221, s43, v138
    v_lshlrev_b32 v222, 16, v142
    v_and_b32 v223, s43, v142
    v_lshlrev_b32 v224, 16, v146
    v_and_b32 v225, s43, v146
    v_lshlrev_b32 v226, 16, v150
    v_and_b32 v227, s43, v150
    v_lshlrev_b32 v228, 16, v154
    v_and_b32 v229, s43, v154
    v_lshlrev_b32 v230, 16, v158
    v_and_b32 v231, s43, v158
    v_mul_f32 v200, v200, v216
    v_mul_f32 v201, v201, v217
    v_mul_f32 v202, v202, v218
    v_mul_f32 v203, v203, v219
    v_mul_f32 v204, v204, v220
    v_mul_f32 v205, v205, v221
    v_mul_f32 v206, v206, v222
    v_mul_f32 v207, v207, v223
    v_mul_f32 v208, v208, v224
    v_mul_f32 v209, v209, v225
    v_mul_f32 v210, v210, v226
    v_mul_f32 v211, v211, v227
    v_mul_f32 v212, v212, v228
    v_mul_f32 v213, v213, v229
    v_mul_f32 v214, v214, v230
    v_mul_f32 v215, v215, v231
    v_cvt_pk_bf16_f32 v66, v200, v201
    v_cvt_pk_bf16_f32 v70, v202, v203
    v_cvt_pk_bf16_f32 v74, v204, v205
    v_cvt_pk_bf16_f32 v78, v206, v207
    v_cvt_pk_bf16_f32 v82, v208, v209
    v_cvt_pk_bf16_f32 v86, v210, v211
    v_cvt_pk_bf16_f32 v90, v212, v213
    v_cvt_pk_bf16_f32 v94, v214, v215
    v_and_b32 v216, s43, v123
    v_lshlrev_b32 v200, 16, v40
    v_mul_f32 v216, s50, v216
    v_and_b32 v217, s43, v127
    v_lshlrev_b32 v201, 16, v44
    v_mul_f32 v217, s51, v217
    v_lshlrev_b32 v218, 16, v123
    v_and_b32 v202, s43, v40
    v_mul_f32 v218, s50, v218
    v_lshlrev_b32 v219, 16, v127
    v_and_b32 v203, s43, v44
    v_mul_f32 v219, s51, v219
    v_and_b32 v220, s43, v122
    v_lshlrev_b32 v204, 16, v41
    v_mul_f32 v220, s50, v220
    v_and_b32 v221, s43, v126
    v_lshlrev_b32 v205, 16, v45
    v_mul_f32 v221, s51, v221
    v_lshlrev_b32 v222, 16, v122
    v_and_b32 v206, s43, v41
    v_mul_f32 v222, s50, v222
    v_lshlrev_b32 v223, 16, v126
    v_and_b32 v207, s43, v45
    v_mul_f32 v223, s51, v223
    v_and_b32 v224, s43, v121
    v_lshlrev_b32 v208, 16, v42
    v_mul_f32 v224, s50, v224
    v_and_b32 v225, s43, v125
    v_lshlrev_b32 v209, 16, v46
    v_mul_f32 v225, s51, v225
    v_lshlrev_b32 v226, 16, v121
    v_and_b32 v210, s43, v42
    v_mul_f32 v226, s50, v226
    v_lshlrev_b32 v227, 16, v125
    v_and_b32 v211, s43, v46
    v_mul_f32 v227, s51, v227
    v_and_b32 v228, s43, v120
    v_lshlrev_b32 v212, 16, v43
    v_mul_f32 v228, s50, v228
    v_and_b32 v229, s43, v124
    v_lshlrev_b32 v213, 16, v47
    v_mul_f32 v229, s51, v229
    v_lshlrev_b32 v230, 16, v120
    v_and_b32 v214, s43, v43
    v_mul_f32 v230, s50, v230
    v_lshlrev_b32 v231, 16, v124
    v_and_b32 v215, s43, v47
    v_mul_f32 v231, s51, v231
    v_cvt_pk_bf16_f32 v217, v216, v217
    v_lshlrev_b32 v216, 16, v217
    v_and_b32 v217, s43, v217
    v_cvt_pk_bf16_f32 v219, v218, v219
    v_lshlrev_b32 v218, 16, v219
    v_and_b32 v219, s43, v219
    v_cvt_pk_bf16_f32 v221, v220, v221
    v_lshlrev_b32 v220, 16, v221
    v_and_b32 v221, s43, v221
    v_cvt_pk_bf16_f32 v223, v222, v223
    v_lshlrev_b32 v222, 16, v223
    v_and_b32 v223, s43, v223
    v_cvt_pk_bf16_f32 v225, v224, v225
    v_lshlrev_b32 v224, 16, v225
    v_and_b32 v225, s43, v225
    v_cvt_pk_bf16_f32 v227, v226, v227
    v_lshlrev_b32 v226, 16, v227
    v_and_b32 v227, s43, v227
    v_cvt_pk_bf16_f32 v229, v228, v229
    v_lshlrev_b32 v228, 16, v229
    v_and_b32 v229, s43, v229
    v_cvt_pk_bf16_f32 v231, v230, v231
    v_lshlrev_b32 v230, 16, v231
    v_and_b32 v231, s43, v231
    v_add_f32 v200, v200, v216
    v_add_f32 v201, v201, v217
    v_add_f32 v202, v202, v218
    v_add_f32 v203, v203, v219
    v_add_f32 v204, v204, v220
    v_add_f32 v205, v205, v221
    v_add_f32 v206, v206, v222
    v_add_f32 v207, v207, v223
    v_add_f32 v208, v208, v224
    v_add_f32 v209, v209, v225
    v_add_f32 v210, v210, v226
    v_add_f32 v211, v211, v227
    v_add_f32 v212, v212, v228
    v_add_f32 v213, v213, v229
    v_add_f32 v214, v214, v230
    v_add_f32 v215, v215, v231
    v_cvt_pk_bf16_f32 v201, v200, v201
    v_lshlrev_b32 v200, 16, v201
    v_and_b32 v201, s43, v201
    v_cvt_pk_bf16_f32 v203, v202, v203
    v_lshlrev_b32 v202, 16, v203
    v_and_b32 v203, s43, v203
    v_cvt_pk_bf16_f32 v205, v204, v205
    v_lshlrev_b32 v204, 16, v205
    v_and_b32 v205, s43, v205
    v_cvt_pk_bf16_f32 v207, v206, v207
    v_lshlrev_b32 v206, 16, v207
    v_and_b32 v207, s43, v207
    v_cvt_pk_bf16_f32 v209, v208, v209
    v_lshlrev_b32 v208, 16, v209
    v_and_b32 v209, s43, v209
    v_cvt_pk_bf16_f32 v211, v210, v211
    v_lshlrev_b32 v210, 16, v211
    v_and_b32 v211, s43, v211
    v_cvt_pk_bf16_f32 v213, v212, v213
    v_lshlrev_b32 v212, 16, v213
    v_and_b32 v213, s43, v213
    v_cvt_pk_bf16_f32 v215, v214, v215
    v_lshlrev_b32 v214, 16, v215
    v_and_b32 v215, s43, v215
    v_lshlrev_b32 v216, 16, v131
    v_and_b32 v217, s43, v131
    v_lshlrev_b32 v218, 16, v135
    v_and_b32 v219, s43, v135
    v_lshlrev_b32 v220, 16, v139
    v_and_b32 v221, s43, v139
    v_lshlrev_b32 v222, 16, v143
    v_and_b32 v223, s43, v143
    v_lshlrev_b32 v224, 16, v147
    v_and_b32 v225, s43, v147
    v_lshlrev_b32 v226, 16, v151
    v_and_b32 v227, s43, v151
    v_lshlrev_b32 v228, 16, v155
    v_and_b32 v229, s43, v155
    v_lshlrev_b32 v230, 16, v159
    v_and_b32 v231, s43, v159
    v_mul_f32 v200, v200, v216
    v_mul_f32 v201, v201, v217
    v_mul_f32 v202, v202, v218
    v_mul_f32 v203, v203, v219
    v_mul_f32 v204, v204, v220
    v_mul_f32 v205, v205, v221
    v_mul_f32 v206, v206, v222
    v_mul_f32 v207, v207, v223
    v_mul_f32 v208, v208, v224
    v_mul_f32 v209, v209, v225
    v_mul_f32 v210, v210, v226
    v_mul_f32 v211, v211, v227
    v_mul_f32 v212, v212, v228
    v_mul_f32 v213, v213, v229
    v_mul_f32 v214, v214, v230
    v_mul_f32 v215, v215, v231
    v_cvt_pk_bf16_f32 v67, v200, v201
    v_cvt_pk_bf16_f32 v71, v202, v203
    v_cvt_pk_bf16_f32 v75, v204, v205
    v_cvt_pk_bf16_f32 v79, v206, v207
    v_cvt_pk_bf16_f32 v83, v208, v209
    v_cvt_pk_bf16_f32 v87, v210, v211
    v_cvt_pk_bf16_f32 v91, v212, v213
    v_cvt_pk_bf16_f32 v95, v214, v215
    buffer_store_dwordx4 v[64:67], v2, s[24:27], 0 offen offset:1024
    buffer_store_dwordx4 v[68:71], v2, s[24:27], 0 offen offset:3072
    v_add_u32 v2, 4096, v2
    buffer_store_dwordx4 v[72:75], v2, s[24:27], 0 offen offset:1024
    buffer_store_dwordx4 v[76:79], v2, s[24:27], 0 offen offset:3072
    v_add_u32 v2, 4096, v2
    buffer_store_dwordx4 v[80:83], v2, s[24:27], 0 offen offset:1024
    buffer_store_dwordx4 v[84:87], v2, s[24:27], 0 offen offset:3072
    v_add_u32 v2, 4096, v2
    buffer_store_dwordx4 v[88:91], v2, s[24:27], 0 offen offset:1024
    buffer_store_dwordx4 v[92:95], v2, s[24:27], 0 offen offset:3072
    s_waitcnt vmcnt(0)
    s_sub_u32 s40, s30, 192
    s_cmp_ge_u32 s40, 32
    s_cbranch_scc1 L_attn
    s_sub_u32 s40, s30, 64
L_oproj:
    v_and_b32 v1, 63, v0
    v_and_b32 v2, 15, v1
    v_lshrrev_b32 v3, 4, v1
    v_lshlrev_b32 v4, 4, v1
    s_load_dwordx2 s[12:13], s[0:1], 40
    s_mov_b32 s14, 0x400000
    s_mov_b32 s15, 0x00020000
    s_load_dwordx2 s[16:17], s[0:1], 104
    s_mov_b32 s18, 0x400000
    s_mov_b32 s19, 0x00020000
    s_lshr_b32 s44, s40, 4
    s_and_b32 s42, s40, 15
    s_mov_b32 s64, 0x00ff00ff
    s_add_u32 s45, s44, 118
    s_cmp_ge_u32 s44, 8
    s_cselect_b32 s44, s45, s44
    s_cselect_b32 s64, 0xff00ff00, s64
    s_cselect_b32 s66, 128, 0
    s_mov_b32 s65, s64
    v_lshlrev_b32 v6, 13, v3
    v_lshl_add_u32 v6, v2, 2, v6
    s_lshl_b32 s46, s29, 20
    s_lshl_b32 s47, s42, 6
    s_add_u32 s46, s46, s47
    v_lshlrev_b32 v5, 11, v2
    v_lshl_add_u32 v5, v3, 4, v5
    v_add_u32 v5, s47, v5
    s_waitcnt lgkmcnt(0)
    s_mov_b32 s60, 0x05040100
    s_mov_b32 s61, 0x07060302
    s_add_u32 s63, s46, 0
    buffer_load_dword v16, v6, s[12:15], s63 offen
    s_add_u32 s63, s46, 1024
    buffer_load_dword v17, v6, s[12:15], s63 offen
    s_add_u32 s63, s46, 2048
    buffer_load_dword v18, v6, s[12:15], s63 offen
    s_add_u32 s63, s46, 3072
    buffer_load_dword v19, v6, s[12:15], s63 offen
    s_add_u32 s63, s46, 4096
    buffer_load_dword v20, v6, s[12:15], s63 offen
    s_add_u32 s63, s46, 5120
    buffer_load_dword v21, v6, s[12:15], s63 offen
    s_add_u32 s63, s46, 6144
    buffer_load_dword v22, v6, s[12:15], s63 offen
    s_add_u32 s63, s46, 7168
    buffer_load_dword v23, v6, s[12:15], s63 offen
    s_add_u32 s63, s46, 32768
    buffer_load_dword v24, v6, s[12:15], s63 offen
    s_add_u32 s63, s46, 33792
    buffer_load_dword v25, v6, s[12:15], s63 offen
    s_add_u32 s63, s46, 34816
    buffer_load_dword v26, v6, s[12:15], s63 offen
    s_add_u32 s63, s46, 35840
    buffer_load_dword v27, v6, s[12:15], s63 offen
    s_add_u32 s63, s46, 36864
    buffer_load_dword v28, v6, s[12:15], s63 offen
    s_add_u32 s63, s46, 37888
    buffer_load_dword v29, v6, s[12:15], s63 offen
    s_add_u32 s63, s46, 38912
    buffer_load_dword v30, v6, s[12:15], s63 offen
    s_add_u32 s63, s46, 39936
    buffer_load_dword v31, v6, s[12:15], s63 offen
    s_add_u32 s63, s46, 65536
    buffer_load_dword v32, v6, s[12:15], s63 offen
    s_add_u32 s63, s46, 66560
    buffer_load_dword v33, v6, s[12:15], s63 offen
    s_add_u32 s63, s46, 67584
    buffer_load_dword v34, v6, s[12:15], s63 offen
    s_add_u32 s63, s46, 68608
    buffer_load_dword v35, v6, s[12:15], s63 offen
    s_add_u32 s63, s46, 69632
    buffer_load_dword v36, v6, s[12:15], s63 offen
    s_add_u32 s63, s46, 70656
    buffer_load_dword v37, v6, s[12:15], s63 offen
    s_add_u32 s63, s46, 71680
    buffer_load_dword v38, v6, s[12:15], s63 offen
    s_add_u32 s63, s46, 72704
    buffer_load_dword v39, v6, s[12:15], s63 offen
    s_add_u32 s63, s46, 98304
    buffer_load_dword v40, v6, s[12:15], s63 offen
    s_add_u32 s63, s46, 99328
    buffer_load_dword v41, v6, s[12:15], s63 offen
    s_add_u32 s63, s46, 100352
    buffer_load_dword v42, v6, s[12:15], s63 offen
    s_add_u32 s63, s46, 101376
    buffer_load_dword v43, v6, s[12:15], s63 offen
    s_add_u32 s63, s46, 102400
    buffer_load_dword v44, v6, s[12:15], s63 offen
    s_add_u32 s63, s46, 103424
    buffer_load_dword v45, v6, s[12:15], s63 offen
    s_add_u32 s63, s46, 104448
    buffer_load_dword v46, v6, s[12:15], s63 offen
    s_add_u32 s63, s46, 105472
    buffer_load_dword v47, v6, s[12:15], s63 offen
    s_add_u32 s63, s46, 131072
    buffer_load_dword v48, v6, s[12:15], s63 offen
    s_add_u32 s63, s46, 132096
    buffer_load_dword v49, v6, s[12:15], s63 offen
    s_add_u32 s63, s46, 133120
    buffer_load_dword v50, v6, s[12:15], s63 offen
    s_add_u32 s63, s46, 134144
    buffer_load_dword v51, v6, s[12:15], s63 offen
    s_add_u32 s63, s46, 135168
    buffer_load_dword v52, v6, s[12:15], s63 offen
    s_add_u32 s63, s46, 136192
    buffer_load_dword v53, v6, s[12:15], s63 offen
    s_add_u32 s63, s46, 137216
    buffer_load_dword v54, v6, s[12:15], s63 offen
    s_add_u32 s63, s46, 138240
    buffer_load_dword v55, v6, s[12:15], s63 offen
    s_add_u32 s63, s46, 163840
    buffer_load_dword v56, v6, s[12:15], s63 offen
    s_add_u32 s63, s46, 164864
    buffer_load_dword v57, v6, s[12:15], s63 offen
    s_add_u32 s63, s46, 165888
    buffer_load_dword v58, v6, s[12:15], s63 offen
    s_add_u32 s63, s46, 166912
    buffer_load_dword v59, v6, s[12:15], s63 offen
    s_add_u32 s63, s46, 167936
    buffer_load_dword v60, v6, s[12:15], s63 offen
    s_add_u32 s63, s46, 168960
    buffer_load_dword v61, v6, s[12:15], s63 offen
    s_add_u32 s63, s46, 169984
    buffer_load_dword v62, v6, s[12:15], s63 offen
    s_add_u32 s63, s46, 171008
    buffer_load_dword v63, v6, s[12:15], s63 offen
    s_waitcnt vmcnt(32)
    v_perm_b32 v8, v17, v16, s60
    v_accvgpr_write_b32 a0, v8
    v_perm_b32 v9, v19, v18, s60
    v_accvgpr_write_b32 a1, v9
    v_perm_b32 v10, v21, v20, s60
    v_accvgpr_write_b32 a2, v10
    v_perm_b32 v11, v23, v22, s60
    v_accvgpr_write_b32 a3, v11
    v_perm_b32 v8, v17, v16, s61
    v_accvgpr_write_b32 a4, v8
    v_perm_b32 v9, v19, v18, s61
    v_accvgpr_write_b32 a5, v9
    v_perm_b32 v10, v21, v20, s61
    v_accvgpr_write_b32 a6, v10
    v_perm_b32 v11, v23, v22, s61
    v_accvgpr_write_b32 a7, v11
    v_perm_b32 v8, v25, v24, s60
    v_accvgpr_write_b32 a8, v8
    v_perm_b32 v9, v27, v26, s60
    v_accvgpr_write_b32 a9, v9
    v_perm_b32 v10, v29, v28, s60
    v_accvgpr_write_b32 a10, v10
    v_perm_b32 v11, v31, v30, s60
    v_accvgpr_write_b32 a11, v11
    v_perm_b32 v8, v25, v24, s61
    v_accvgpr_write_b32 a12, v8
    v_perm_b32 v9, v27, v26, s61
    v_accvgpr_write_b32 a13, v9
    v_perm_b32 v10, v29, v28, s61
    v_accvgpr_write_b32 a14, v10
    v_perm_b32 v11, v31, v30, s61
    v_accvgpr_write_b32 a15, v11
    s_add_u32 s63, s46, 196608
    buffer_load_dword v16, v6, s[12:15], s63 offen
    s_add_u32 s63, s46, 197632
    buffer_load_dword v17, v6, s[12:15], s63 offen
    s_add_u32 s63, s46, 198656
    buffer_load_dword v18, v6, s[12:15], s63 offen
    s_add_u32 s63, s46, 199680
    buffer_load_dword v19, v6, s[12:15], s63 offen
    s_add_u32 s63, s46, 200704
    buffer_load_dword v20, v6, s[12:15], s63 offen
    s_add_u32 s63, s46, 201728
    buffer_load_dword v21, v6, s[12:15], s63 offen
    s_add_u32 s63, s46, 202752
    buffer_load_dword v22, v6, s[12:15], s63 offen
    s_add_u32 s63, s46, 203776
    buffer_load_dword v23, v6, s[12:15], s63 offen
    s_add_u32 s63, s46, 229376
    buffer_load_dword v24, v6, s[12:15], s63 offen
    s_add_u32 s63, s46, 230400
    buffer_load_dword v25, v6, s[12:15], s63 offen
    s_add_u32 s63, s46, 231424
    buffer_load_dword v26, v6, s[12:15], s63 offen
    s_add_u32 s63, s46, 232448
    buffer_load_dword v27, v6, s[12:15], s63 offen
    s_add_u32 s63, s46, 233472
    buffer_load_dword v28, v6, s[12:15], s63 offen
    s_add_u32 s63, s46, 234496
    buffer_load_dword v29, v6, s[12:15], s63 offen
    s_add_u32 s63, s46, 235520
    buffer_load_dword v30, v6, s[12:15], s63 offen
    s_add_u32 s63, s46, 236544
    buffer_load_dword v31, v6, s[12:15], s63 offen
    s_waitcnt vmcnt(32)
    v_perm_b32 v8, v33, v32, s60
    v_accvgpr_write_b32 a16, v8
    v_perm_b32 v9, v35, v34, s60
    v_accvgpr_write_b32 a17, v9
    v_perm_b32 v10, v37, v36, s60
    v_accvgpr_write_b32 a18, v10
    v_perm_b32 v11, v39, v38, s60
    v_accvgpr_write_b32 a19, v11
    v_perm_b32 v8, v33, v32, s61
    v_accvgpr_write_b32 a20, v8
    v_perm_b32 v9, v35, v34, s61
    v_accvgpr_write_b32 a21, v9
    v_perm_b32 v10, v37, v36, s61
    v_accvgpr_write_b32 a22, v10
    v_perm_b32 v11, v39, v38, s61
    v_accvgpr_write_b32 a23, v11
    v_perm_b32 v8, v41, v40, s60
    v_accvgpr_write_b32 a24, v8
    v_perm_b32 v9, v43, v42, s60
    v_accvgpr_write_b32 a25, v9
    v_perm_b32 v10, v45, v44, s60
    v_accvgpr_write_b32 a26, v10
    v_perm_b32 v11, v47, v46, s60
    v_accvgpr_write_b32 a27, v11
    v_perm_b32 v8, v41, v40, s61
    v_accvgpr_write_b32 a28, v8
    v_perm_b32 v9, v43, v42, s61
    v_accvgpr_write_b32 a29, v9
    v_perm_b32 v10, v45, v44, s61
    v_accvgpr_write_b32 a30, v10
    v_perm_b32 v11, v47, v46, s61
    v_accvgpr_write_b32 a31, v11
    s_add_u32 s63, s46, 262144
    buffer_load_dword v32, v6, s[12:15], s63 offen
    s_add_u32 s63, s46, 263168
    buffer_load_dword v33, v6, s[12:15], s63 offen
    s_add_u32 s63, s46, 264192
    buffer_load_dword v34, v6, s[12:15], s63 offen
    s_add_u32 s63, s46, 265216
    buffer_load_dword v35, v6, s[12:15], s63 offen
    s_add_u32 s63, s46, 266240
    buffer_load_dword v36, v6, s[12:15], s63 offen
    s_add_u32 s63, s46, 267264
    buffer_load_dword v37, v6, s[12:15], s63 offen
    s_add_u32 s63, s46, 268288
    buffer_load_dword v38, v6, s[12:15], s63 offen
    s_add_u32 s63, s46, 269312
    buffer_load_dword v39, v6, s[12:15], s63 offen
    s_add_u32 s63, s46, 294912
    buffer_load_dword v40, v6, s[12:15], s63 offen
    s_add_u32 s63, s46, 295936
    buffer_load_dword v41, v6, s[12:15], s63 offen
    s_add_u32 s63, s46, 296960
    buffer_load_dword v42, v6, s[12:15], s63 offen
    s_add_u32 s63, s46, 297984
    buffer_load_dword v43, v6, s[12:15], s63 offen
    s_add_u32 s63, s46, 299008
    buffer_load_dword v44, v6, s[12:15], s63 offen
    s_add_u32 s63, s46, 300032
    buffer_load_dword v45, v6, s[12:15], s63 offen
    s_add_u32 s63, s46, 301056
    buffer_load_dword v46, v6, s[12:15], s63 offen
    s_add_u32 s63, s46, 302080
    buffer_load_dword v47, v6, s[12:15], s63 offen
    s_waitcnt vmcnt(32)
    v_perm_b32 v8, v49, v48, s60
    v_accvgpr_write_b32 a32, v8
    v_perm_b32 v9, v51, v50, s60
    v_accvgpr_write_b32 a33, v9
    v_perm_b32 v10, v53, v52, s60
    v_accvgpr_write_b32 a34, v10
    v_perm_b32 v11, v55, v54, s60
    v_accvgpr_write_b32 a35, v11
    v_perm_b32 v8, v49, v48, s61
    v_accvgpr_write_b32 a36, v8
    v_perm_b32 v9, v51, v50, s61
    v_accvgpr_write_b32 a37, v9
    v_perm_b32 v10, v53, v52, s61
    v_accvgpr_write_b32 a38, v10
    v_perm_b32 v11, v55, v54, s61
    v_accvgpr_write_b32 a39, v11
    v_perm_b32 v8, v57, v56, s60
    v_accvgpr_write_b32 a40, v8
    v_perm_b32 v9, v59, v58, s60
    v_accvgpr_write_b32 a41, v9
    v_perm_b32 v10, v61, v60, s60
    v_accvgpr_write_b32 a42, v10
    v_perm_b32 v11, v63, v62, s60
    v_accvgpr_write_b32 a43, v11
    v_perm_b32 v8, v57, v56, s61
    v_accvgpr_write_b32 a44, v8
    v_perm_b32 v9, v59, v58, s61
    v_accvgpr_write_b32 a45, v9
    v_perm_b32 v10, v61, v60, s61
    v_accvgpr_write_b32 a46, v10
    v_perm_b32 v11, v63, v62, s61
    v_accvgpr_write_b32 a47, v11
    s_add_u32 s63, s46, 327680
    buffer_load_dword v48, v6, s[12:15], s63 offen
    s_add_u32 s63, s46, 328704
    buffer_load_dword v49, v6, s[12:15], s63 offen
    s_add_u32 s63, s46, 329728
    buffer_load_dword v50, v6, s[12:15], s63 offen
    s_add_u32 s63, s46, 330752
    buffer_load_dword v51, v6, s[12:15], s63 offen
    s_add_u32 s63, s46, 331776
    buffer_load_dword v52, v6, s[12:15], s63 offen
    s_add_u32 s63, s46, 332800
    buffer_load_dword v53, v6, s[12:15], s63 offen
    s_add_u32 s63, s46, 333824
    buffer_load_dword v54, v6, s[12:15], s63 offen
    s_add_u32 s63, s46, 334848
    buffer_load_dword v55, v6, s[12:15], s63 offen
    s_add_u32 s63, s46, 360448
    buffer_load_dword v56, v6, s[12:15], s63 offen
    s_add_u32 s63, s46, 361472
    buffer_load_dword v57, v6, s[12:15], s63 offen
    s_add_u32 s63, s46, 362496
    buffer_load_dword v58, v6, s[12:15], s63 offen
    s_add_u32 s63, s46, 363520
    buffer_load_dword v59, v6, s[12:15], s63 offen
    s_add_u32 s63, s46, 364544
    buffer_load_dword v60, v6, s[12:15], s63 offen
    s_add_u32 s63, s46, 365568
    buffer_load_dword v61, v6, s[12:15], s63 offen
    s_add_u32 s63, s46, 366592
    buffer_load_dword v62, v6, s[12:15], s63 offen
    s_add_u32 s63, s46, 367616
    buffer_load_dword v63, v6, s[12:15], s63 offen
    s_waitcnt vmcnt(32)
    v_perm_b32 v8, v17, v16, s60
    v_accvgpr_write_b32 a48, v8
    v_perm_b32 v9, v19, v18, s60
    v_accvgpr_write_b32 a49, v9
    v_perm_b32 v10, v21, v20, s60
    v_accvgpr_write_b32 a50, v10
    v_perm_b32 v11, v23, v22, s60
    v_accvgpr_write_b32 a51, v11
    v_perm_b32 v8, v17, v16, s61
    v_accvgpr_write_b32 a52, v8
    v_perm_b32 v9, v19, v18, s61
    v_accvgpr_write_b32 a53, v9
    v_perm_b32 v10, v21, v20, s61
    v_accvgpr_write_b32 a54, v10
    v_perm_b32 v11, v23, v22, s61
    v_accvgpr_write_b32 a55, v11
    v_perm_b32 v8, v25, v24, s60
    v_accvgpr_write_b32 a56, v8
    v_perm_b32 v9, v27, v26, s60
    v_accvgpr_write_b32 a57, v9
    v_perm_b32 v10, v29, v28, s60
    v_accvgpr_write_b32 a58, v10
    v_perm_b32 v11, v31, v30, s60
    v_accvgpr_write_b32 a59, v11
    v_perm_b32 v8, v25, v24, s61
    v_accvgpr_write_b32 a60, v8
    v_perm_b32 v9, v27, v26, s61
    v_accvgpr_write_b32 a61, v9
    v_perm_b32 v10, v29, v28, s61
    v_accvgpr_write_b32 a62, v10
    v_perm_b32 v11, v31, v30, s61
    v_accvgpr_write_b32 a63, v11
    s_add_u32 s63, s46, 393216
    buffer_load_dword v16, v6, s[12:15], s63 offen
    s_add_u32 s63, s46, 394240
    buffer_load_dword v17, v6, s[12:15], s63 offen
    s_add_u32 s63, s46, 395264
    buffer_load_dword v18, v6, s[12:15], s63 offen
    s_add_u32 s63, s46, 396288
    buffer_load_dword v19, v6, s[12:15], s63 offen
    s_add_u32 s63, s46, 397312
    buffer_load_dword v20, v6, s[12:15], s63 offen
    s_add_u32 s63, s46, 398336
    buffer_load_dword v21, v6, s[12:15], s63 offen
    s_add_u32 s63, s46, 399360
    buffer_load_dword v22, v6, s[12:15], s63 offen
    s_add_u32 s63, s46, 400384
    buffer_load_dword v23, v6, s[12:15], s63 offen
    s_add_u32 s63, s46, 425984
    buffer_load_dword v24, v6, s[12:15], s63 offen
    s_add_u32 s63, s46, 427008
    buffer_load_dword v25, v6, s[12:15], s63 offen
    s_add_u32 s63, s46, 428032
    buffer_load_dword v26, v6, s[12:15], s63 offen
    s_add_u32 s63, s46, 429056
    buffer_load_dword v27, v6, s[12:15], s63 offen
    s_add_u32 s63, s46, 430080
    buffer_load_dword v28, v6, s[12:15], s63 offen
    s_add_u32 s63, s46, 431104
    buffer_load_dword v29, v6, s[12:15], s63 offen
    s_add_u32 s63, s46, 432128
    buffer_load_dword v30, v6, s[12:15], s63 offen
    s_add_u32 s63, s46, 433152
    buffer_load_dword v31, v6, s[12:15], s63 offen
    s_waitcnt vmcnt(32)
    v_perm_b32 v8, v33, v32, s60
    v_accvgpr_write_b32 a64, v8
    v_perm_b32 v9, v35, v34, s60
    v_accvgpr_write_b32 a65, v9
    v_perm_b32 v10, v37, v36, s60
    v_accvgpr_write_b32 a66, v10
    v_perm_b32 v11, v39, v38, s60
    v_accvgpr_write_b32 a67, v11
    v_perm_b32 v8, v33, v32, s61
    v_accvgpr_write_b32 a68, v8
    v_perm_b32 v9, v35, v34, s61
    v_accvgpr_write_b32 a69, v9
    v_perm_b32 v10, v37, v36, s61
    v_accvgpr_write_b32 a70, v10
    v_perm_b32 v11, v39, v38, s61
    v_accvgpr_write_b32 a71, v11
    v_perm_b32 v8, v41, v40, s60
    v_accvgpr_write_b32 a72, v8
    v_perm_b32 v9, v43, v42, s60
    v_accvgpr_write_b32 a73, v9
    v_perm_b32 v10, v45, v44, s60
    v_accvgpr_write_b32 a74, v10
    v_perm_b32 v11, v47, v46, s60
    v_accvgpr_write_b32 a75, v11
    v_perm_b32 v8, v41, v40, s61
    v_accvgpr_write_b32 a76, v8
    v_perm_b32 v9, v43, v42, s61
    v_accvgpr_write_b32 a77, v9
    v_perm_b32 v10, v45, v44, s61
    v_accvgpr_write_b32 a78, v10
    v_perm_b32 v11, v47, v46, s61
    v_accvgpr_write_b32 a79, v11
    s_add_u32 s63, s46, 458752
    buffer_load_dword v32, v6, s[12:15], s63 offen
    s_add_u32 s63, s46, 459776
    buffer_load_dword v33, v6, s[12:15], s63 offen
    s_add_u32 s63, s46, 460800
    buffer_load_dword v34, v6, s[12:15], s63 offen
    s_add_u32 s63, s46, 461824
    buffer_load_dword v35, v6, s[12:15], s63 offen
    s_add_u32 s63, s46, 462848
    buffer_load_dword v36, v6, s[12:15], s63 offen
    s_add_u32 s63, s46, 463872
    buffer_load_dword v37, v6, s[12:15], s63 offen
    s_add_u32 s63, s46, 464896
    buffer_load_dword v38, v6, s[12:15], s63 offen
    s_add_u32 s63, s46, 465920
    buffer_load_dword v39, v6, s[12:15], s63 offen
    s_add_u32 s63, s46, 491520
    buffer_load_dword v40, v6, s[12:15], s63 offen
    s_add_u32 s63, s46, 492544
    buffer_load_dword v41, v6, s[12:15], s63 offen
    s_add_u32 s63, s46, 493568
    buffer_load_dword v42, v6, s[12:15], s63 offen
    s_add_u32 s63, s46, 494592
    buffer_load_dword v43, v6, s[12:15], s63 offen
    s_add_u32 s63, s46, 495616
    buffer_load_dword v44, v6, s[12:15], s63 offen
    s_add_u32 s63, s46, 496640
    buffer_load_dword v45, v6, s[12:15], s63 offen
    s_add_u32 s63, s46, 497664
    buffer_load_dword v46, v6, s[12:15], s63 offen
    s_add_u32 s63, s46, 498688
    buffer_load_dword v47, v6, s[12:15], s63 offen
    s_waitcnt vmcnt(32)
    v_perm_b32 v8, v49, v48, s60
    v_accvgpr_write_b32 a80, v8
    v_perm_b32 v9, v51, v50, s60
    v_accvgpr_write_b32 a81, v9
    v_perm_b32 v10, v53, v52, s60
    v_accvgpr_write_b32 a82, v10
    v_perm_b32 v11, v55, v54, s60
    v_accvgpr_write_b32 a83, v11
    v_perm_b32 v8, v49, v48, s61
    v_accvgpr_write_b32 a84, v8
    v_perm_b32 v9, v51, v50, s61
    v_accvgpr_write_b32 a85, v9
    v_perm_b32 v10, v53, v52, s61
    v_accvgpr_write_b32 a86, v10
    v_perm_b32 v11, v55, v54, s61
    v_accvgpr_write_b32 a87, v11
    v_perm_b32 v8, v57, v56, s60
    v_accvgpr_write_b32 a88, v8
    v_perm_b32 v9, v59, v58, s60
    v_accvgpr_write_b32 a89, v9
    v_perm_b32 v10, v61, v60, s60
    v_accvgpr_write_b32 a90, v10
    v_perm_b32 v11, v63, v62, s60
    v_accvgpr_write_b32 a91, v11
    v_perm_b32 v8, v57, v56, s61
    v_accvgpr_write_b32 a92, v8
    v_perm_b32 v9, v59, v58, s61
    v_accvgpr_write_b32 a93, v9
    v_perm_b32 v10, v61, v60, s61
    v_accvgpr_write_b32 a94, v10
    v_perm_b32 v11, v63, v62, s61
    v_accvgpr_write_b32 a95, v11
    s_add_u32 s63, s46, 524288
    buffer_load_dword v48, v6, s[12:15], s63 offen
    s_add_u32 s63, s46, 525312
    buffer_load_dword v49, v6, s[12:15], s63 offen
    s_add_u32 s63, s46, 526336
    buffer_load_dword v50, v6, s[12:15], s63 offen
    s_add_u32 s63, s46, 527360
    buffer_load_dword v51, v6, s[12:15], s63 offen
    s_add_u32 s63, s46, 528384
    buffer_load_dword v52, v6, s[12:15], s63 offen
    s_add_u32 s63, s46, 529408
    buffer_load_dword v53, v6, s[12:15], s63 offen
    s_add_u32 s63, s46, 530432
    buffer_load_dword v54, v6, s[12:15], s63 offen
    s_add_u32 s63, s46, 531456
    buffer_load_dword v55, v6, s[12:15], s63 offen
    s_add_u32 s63, s46, 557056
    buffer_load_dword v56, v6, s[12:15], s63 offen
    s_add_u32 s63, s46, 558080
    buffer_load_dword v57, v6, s[12:15], s63 offen
    s_add_u32 s63, s46, 559104
    buffer_load_dword v58, v6, s[12:15], s63 offen
    s_add_u32 s63, s46, 560128
    buffer_load_dword v59, v6, s[12:15], s63 offen
    s_add_u32 s63, s46, 561152
    buffer_load_dword v60, v6, s[12:15], s63 offen
    s_add_u32 s63, s46, 562176
    buffer_load_dword v61, v6, s[12:15], s63 offen
    s_add_u32 s63, s46, 563200
    buffer_load_dword v62, v6, s[12:15], s63 offen
    s_add_u32 s63, s46, 564224
    buffer_load_dword v63, v6, s[12:15], s63 offen
    s_waitcnt vmcnt(32)
    v_perm_b32 v8, v17, v16, s60
    v_accvgpr_write_b32 a96, v8
    v_perm_b32 v9, v19, v18, s60
    v_accvgpr_write_b32 a97, v9
    v_perm_b32 v10, v21, v20, s60
    v_accvgpr_write_b32 a98, v10
    v_perm_b32 v11, v23, v22, s60
    v_accvgpr_write_b32 a99, v11
    v_perm_b32 v8, v17, v16, s61
    v_accvgpr_write_b32 a100, v8
    v_perm_b32 v9, v19, v18, s61
    v_accvgpr_write_b32 a101, v9
    v_perm_b32 v10, v21, v20, s61
    v_accvgpr_write_b32 a102, v10
    v_perm_b32 v11, v23, v22, s61
    v_accvgpr_write_b32 a103, v11
    v_perm_b32 v8, v25, v24, s60
    v_accvgpr_write_b32 a104, v8
    v_perm_b32 v9, v27, v26, s60
    v_accvgpr_write_b32 a105, v9
    v_perm_b32 v10, v29, v28, s60
    v_accvgpr_write_b32 a106, v10
    v_perm_b32 v11, v31, v30, s60
    v_accvgpr_write_b32 a107, v11
    v_perm_b32 v8, v25, v24, s61
    v_accvgpr_write_b32 a108, v8
    v_perm_b32 v9, v27, v26, s61
    v_accvgpr_write_b32 a109, v9
    v_perm_b32 v10, v29, v28, s61
    v_accvgpr_write_b32 a110, v10
    v_perm_b32 v11, v31, v30, s61
    v_accvgpr_write_b32 a111, v11
    s_add_u32 s63, s46, 589824
    buffer_load_dword v16, v6, s[12:15], s63 offen
    s_add_u32 s63, s46, 590848
    buffer_load_dword v17, v6, s[12:15], s63 offen
    s_add_u32 s63, s46, 591872
    buffer_load_dword v18, v6, s[12:15], s63 offen
    s_add_u32 s63, s46, 592896
    buffer_load_dword v19, v6, s[12:15], s63 offen
    s_add_u32 s63, s46, 593920
    buffer_load_dword v20, v6, s[12:15], s63 offen
    s_add_u32 s63, s46, 594944
    buffer_load_dword v21, v6, s[12:15], s63 offen
    s_add_u32 s63, s46, 595968
    buffer_load_dword v22, v6, s[12:15], s63 offen
    s_add_u32 s63, s46, 596992
    buffer_load_dword v23, v6, s[12:15], s63 offen
    s_add_u32 s63, s46, 622592
    buffer_load_dword v24, v6, s[12:15], s63 offen
    s_add_u32 s63, s46, 623616
    buffer_load_dword v25, v6, s[12:15], s63 offen
    s_add_u32 s63, s46, 624640
    buffer_load_dword v26, v6, s[12:15], s63 offen
    s_add_u32 s63, s46, 625664
    buffer_load_dword v27, v6, s[12:15], s63 offen
    s_add_u32 s63, s46, 626688
    buffer_load_dword v28, v6, s[12:15], s63 offen
    s_add_u32 s63, s46, 627712
    buffer_load_dword v29, v6, s[12:15], s63 offen
    s_add_u32 s63, s46, 628736
    buffer_load_dword v30, v6, s[12:15], s63 offen
    s_add_u32 s63, s46, 629760
    buffer_load_dword v31, v6, s[12:15], s63 offen
    s_waitcnt vmcnt(32)
    v_perm_b32 v8, v33, v32, s60
    v_accvgpr_write_b32 a112, v8
    v_perm_b32 v9, v35, v34, s60
    v_accvgpr_write_b32 a113, v9
    v_perm_b32 v10, v37, v36, s60
    v_accvgpr_write_b32 a114, v10
    v_perm_b32 v11, v39, v38, s60
    v_accvgpr_write_b32 a115, v11
    v_perm_b32 v8, v33, v32, s61
    v_accvgpr_write_b32 a116, v8
    v_perm_b32 v9, v35, v34, s61
    v_accvgpr_write_b32 a117, v9
    v_perm_b32 v10, v37, v36, s61
    v_accvgpr_write_b32 a118, v10
    v_perm_b32 v11, v39, v38, s61
    v_accvgpr_write_b32 a119, v11
    v_perm_b32 v8, v41, v40, s60
    v_accvgpr_write_b32 a120, v8
    v_perm_b32 v9, v43, v42, s60
    v_accvgpr_write_b32 a121, v9
    v_perm_b32 v10, v45, v44, s60
    v_accvgpr_write_b32 a122, v10
    v_perm_b32 v11, v47, v46, s60
    v_accvgpr_write_b32 a123, v11
    v_perm_b32 v8, v41, v40, s61
    v_accvgpr_write_b32 a124, v8
    v_perm_b32 v9, v43, v42, s61
    v_accvgpr_write_b32 a125, v9
    v_perm_b32 v10, v45, v44, s61
    v_accvgpr_write_b32 a126, v10
    v_perm_b32 v11, v47, v46, s61
    v_accvgpr_write_b32 a127, v11
    s_add_u32 s63, s46, 655360
    buffer_load_dword v32, v6, s[12:15], s63 offen
    s_add_u32 s63, s46, 656384
    buffer_load_dword v33, v6, s[12:15], s63 offen
    s_add_u32 s63, s46, 657408
    buffer_load_dword v34, v6, s[12:15], s63 offen
    s_add_u32 s63, s46, 658432
    buffer_load_dword v35, v6, s[12:15], s63 offen
    s_add_u32 s63, s46, 659456
    buffer_load_dword v36, v6, s[12:15], s63 offen
    s_add_u32 s63, s46, 660480
    buffer_load_dword v37, v6, s[12:15], s63 offen
    s_add_u32 s63, s46, 661504
    buffer_load_dword v38, v6, s[12:15], s63 offen
    s_add_u32 s63, s46, 662528
    buffer_load_dword v39, v6, s[12:15], s63 offen
    s_add_u32 s63, s46, 688128
    buffer_load_dword v40, v6, s[12:15], s63 offen
    s_add_u32 s63, s46, 689152
    buffer_load_dword v41, v6, s[12:15], s63 offen
    s_add_u32 s63, s46, 690176
    buffer_load_dword v42, v6, s[12:15], s63 offen
    s_add_u32 s63, s46, 691200
    buffer_load_dword v43, v6, s[12:15], s63 offen
    s_add_u32 s63, s46, 692224
    buffer_load_dword v44, v6, s[12:15], s63 offen
    s_add_u32 s63, s46, 693248
    buffer_load_dword v45, v6, s[12:15], s63 offen
    s_add_u32 s63, s46, 694272
    buffer_load_dword v46, v6, s[12:15], s63 offen
    s_add_u32 s63, s46, 695296
    buffer_load_dword v47, v6, s[12:15], s63 offen
    s_waitcnt vmcnt(32)
    v_perm_b32 v8, v49, v48, s60
    v_accvgpr_write_b32 a128, v8
    v_perm_b32 v9, v51, v50, s60
    v_accvgpr_write_b32 a129, v9
    v_perm_b32 v10, v53, v52, s60
    v_accvgpr_write_b32 a130, v10
    v_perm_b32 v11, v55, v54, s60
    v_accvgpr_write_b32 a131, v11
    v_perm_b32 v8, v49, v48, s61
    v_accvgpr_write_b32 a132, v8
    v_perm_b32 v9, v51, v50, s61
    v_accvgpr_write_b32 a133, v9
    v_perm_b32 v10, v53, v52, s61
    v_accvgpr_write_b32 a134, v10
    v_perm_b32 v11, v55, v54, s61
    v_accvgpr_write_b32 a135, v11
    v_perm_b32 v8, v57, v56, s60
    v_accvgpr_write_b32 a136, v8
    v_perm_b32 v9, v59, v58, s60
    v_accvgpr_write_b32 a137, v9
    v_perm_b32 v10, v61, v60, s60
    v_accvgpr_write_b32 a138, v10
    v_perm_b32 v11, v63, v62, s60
    v_accvgpr_write_b32 a139, v11
    v_perm_b32 v8, v57, v56, s61
    v_accvgpr_write_b32 a140, v8
    v_perm_b32 v9, v59, v58, s61
    v_accvgpr_write_b32 a141, v9
    v_perm_b32 v10, v61, v60, s61
    v_accvgpr_write_b32 a142, v10
    v_perm_b32 v11, v63, v62, s61
    v_accvgpr_write_b32 a143, v11
    s_add_u32 s63, s46, 720896
    buffer_load_dword v48, v6, s[12:15], s63 offen
    s_add_u32 s63, s46, 721920
    buffer_load_dword v49, v6, s[12:15], s63 offen
    s_add_u32 s63, s46, 722944
    buffer_load_dword v50, v6, s[12:15], s63 offen
    s_add_u32 s63, s46, 723968
    buffer_load_dword v51, v6, s[12:15], s63 offen
    s_add_u32 s63, s46, 724992
    buffer_load_dword v52, v6, s[12:15], s63 offen
    s_add_u32 s63, s46, 726016
    buffer_load_dword v53, v6, s[12:15], s63 offen
    s_add_u32 s63, s46, 727040
    buffer_load_dword v54, v6, s[12:15], s63 offen
    s_add_u32 s63, s46, 728064
    buffer_load_dword v55, v6, s[12:15], s63 offen
    s_add_u32 s63, s46, 753664
    buffer_load_dword v56, v6, s[12:15], s63 offen
    s_add_u32 s63, s46, 754688
    buffer_load_dword v57, v6, s[12:15], s63 offen
    s_add_u32 s63, s46, 755712
    buffer_load_dword v58, v6, s[12:15], s63 offen
    s_add_u32 s63, s46, 756736
    buffer_load_dword v59, v6, s[12:15], s63 offen
    s_add_u32 s63, s46, 757760
    buffer_load_dword v60, v6, s[12:15], s63 offen
    s_add_u32 s63, s46, 758784
    buffer_load_dword v61, v6, s[12:15], s63 offen
    s_add_u32 s63, s46, 759808
    buffer_load_dword v62, v6, s[12:15], s63 offen
    s_add_u32 s63, s46, 760832
    buffer_load_dword v63, v6, s[12:15], s63 offen
    s_waitcnt vmcnt(32)
    v_perm_b32 v8, v17, v16, s60
    v_accvgpr_write_b32 a144, v8
    v_perm_b32 v9, v19, v18, s60
    v_accvgpr_write_b32 a145, v9
    v_perm_b32 v10, v21, v20, s60
    v_accvgpr_write_b32 a146, v10
    v_perm_b32 v11, v23, v22, s60
    v_accvgpr_write_b32 a147, v11
    v_perm_b32 v8, v17, v16, s61
    v_accvgpr_write_b32 a148, v8
    v_perm_b32 v9, v19, v18, s61
    v_accvgpr_write_b32 a149, v9
    v_perm_b32 v10, v21, v20, s61
    v_accvgpr_write_b32 a150, v10
    v_perm_b32 v11, v23, v22, s61
    v_accvgpr_write_b32 a151, v11
    v_perm_b32 v8, v25, v24, s60
    v_accvgpr_write_b32 a152, v8
    v_perm_b32 v9, v27, v26, s60
    v_accvgpr_write_b32 a153, v9
    v_perm_b32 v10, v29, v28, s60
    v_accvgpr_write_b32 a154, v10
    v_perm_b32 v11, v31, v30, s60
    v_accvgpr_write_b32 a155, v11
    v_perm_b32 v8, v25, v24, s61
    v_accvgpr_write_b32 a156, v8
    v_perm_b32 v9, v27, v26, s61
    v_accvgpr_write_b32 a157, v9
    v_perm_b32 v10, v29, v28, s61
    v_accvgpr_write_b32 a158, v10
    v_perm_b32 v11, v31, v30, s61
    v_accvgpr_write_b32 a159, v11
    s_add_u32 s63, s46, 786432
    buffer_load_dword v16, v6, s[12:15], s63 offen
    s_add_u32 s63, s46, 787456
    buffer_load_dword v17, v6, s[12:15], s63 offen
    s_add_u32 s63, s46, 788480
    buffer_load_dword v18, v6, s[12:15], s63 offen
    s_add_u32 s63, s46, 789504
    buffer_load_dword v19, v6, s[12:15], s63 offen
    s_add_u32 s63, s46, 790528
    buffer_load_dword v20, v6, s[12:15], s63 offen
    s_add_u32 s63, s46, 791552
    buffer_load_dword v21, v6, s[12:15], s63 offen
    s_add_u32 s63, s46, 792576
    buffer_load_dword v22, v6, s[12:15], s63 offen
    s_add_u32 s63, s46, 793600
    buffer_load_dword v23, v6, s[12:15], s63 offen
    s_add_u32 s63, s46, 819200
    buffer_load_dword v24, v6, s[12:15], s63 offen
    s_add_u32 s63, s46, 820224
    buffer_load_dword v25, v6, s[12:15], s63 offen
    s_add_u32 s63, s46, 821248
    buffer_load_dword v26, v6, s[12:15], s63 offen
    s_add_u32 s63, s46, 822272
    buffer_load_dword v27, v6, s[12:15], s63 offen
    s_add_u32 s63, s46, 823296
    buffer_load_dword v28, v6, s[12:15], s63 offen
    s_add_u32 s63, s46, 824320
    buffer_load_dword v29, v6, s[12:15], s63 offen
    s_add_u32 s63, s46, 825344
    buffer_load_dword v30, v6, s[12:15], s63 offen
    s_add_u32 s63, s46, 826368
    buffer_load_dword v31, v6, s[12:15], s63 offen
    s_waitcnt vmcnt(32)
    v_perm_b32 v8, v33, v32, s60
    v_accvgpr_write_b32 a160, v8
    v_perm_b32 v9, v35, v34, s60
    v_accvgpr_write_b32 a161, v9
    v_perm_b32 v10, v37, v36, s60
    v_accvgpr_write_b32 a162, v10
    v_perm_b32 v11, v39, v38, s60
    v_accvgpr_write_b32 a163, v11
    v_perm_b32 v8, v33, v32, s61
    v_accvgpr_write_b32 a164, v8
    v_perm_b32 v9, v35, v34, s61
    v_accvgpr_write_b32 a165, v9
    v_perm_b32 v10, v37, v36, s61
    v_accvgpr_write_b32 a166, v10
    v_perm_b32 v11, v39, v38, s61
    v_accvgpr_write_b32 a167, v11
    v_perm_b32 v8, v41, v40, s60
    v_accvgpr_write_b32 a168, v8
    v_perm_b32 v9, v43, v42, s60
    v_accvgpr_write_b32 a169, v9
    v_perm_b32 v10, v45, v44, s60
    v_accvgpr_write_b32 a170, v10
    v_perm_b32 v11, v47, v46, s60
    v_accvgpr_write_b32 a171, v11
    v_perm_b32 v8, v41, v40, s61
    v_accvgpr_write_b32 a172, v8
    v_perm_b32 v9, v43, v42, s61
    v_accvgpr_write_b32 a173, v9
    v_perm_b32 v10, v45, v44, s61
    v_accvgpr_write_b32 a174, v10
    v_perm_b32 v11, v47, v46, s61
    v_accvgpr_write_b32 a175, v11
    s_add_u32 s63, s46, 851968
    buffer_load_dword v32, v6, s[12:15], s63 offen
    s_add_u32 s63, s46, 852992
    buffer_load_dword v33, v6, s[12:15], s63 offen
    s_add_u32 s63, s46, 854016
    buffer_load_dword v34, v6, s[12:15], s63 offen
    s_add_u32 s63, s46, 855040
    buffer_load_dword v35, v6, s[12:15], s63 offen
    s_add_u32 s63, s46, 856064
    buffer_load_dword v36, v6, s[12:15], s63 offen
    s_add_u32 s63, s46, 857088
    buffer_load_dword v37, v6, s[12:15], s63 offen
    s_add_u32 s63, s46, 858112
    buffer_load_dword v38, v6, s[12:15], s63 offen
    s_add_u32 s63, s46, 859136
    buffer_load_dword v39, v6, s[12:15], s63 offen
    s_add_u32 s63, s46, 884736
    buffer_load_dword v40, v6, s[12:15], s63 offen
    s_add_u32 s63, s46, 885760
    buffer_load_dword v41, v6, s[12:15], s63 offen
    s_add_u32 s63, s46, 886784
    buffer_load_dword v42, v6, s[12:15], s63 offen
    s_add_u32 s63, s46, 887808
    buffer_load_dword v43, v6, s[12:15], s63 offen
    s_add_u32 s63, s46, 888832
    buffer_load_dword v44, v6, s[12:15], s63 offen
    s_add_u32 s63, s46, 889856
    buffer_load_dword v45, v6, s[12:15], s63 offen
    s_add_u32 s63, s46, 890880
    buffer_load_dword v46, v6, s[12:15], s63 offen
    s_add_u32 s63, s46, 891904
    buffer_load_dword v47, v6, s[12:15], s63 offen
    s_waitcnt vmcnt(32)
    v_perm_b32 v8, v49, v48, s60
    v_accvgpr_write_b32 a176, v8
    v_perm_b32 v9, v51, v50, s60
    v_accvgpr_write_b32 a177, v9
    v_perm_b32 v10, v53, v52, s60
    v_accvgpr_write_b32 a178, v10
    v_perm_b32 v11, v55, v54, s60
    v_accvgpr_write_b32 a179, v11
    v_perm_b32 v8, v49, v48, s61
    v_accvgpr_write_b32 a180, v8
    v_perm_b32 v9, v51, v50, s61
    v_accvgpr_write_b32 a181, v9
    v_perm_b32 v10, v53, v52, s61
    v_accvgpr_write_b32 a182, v10
    v_perm_b32 v11, v55, v54, s61
    v_accvgpr_write_b32 a183, v11
    v_perm_b32 v8, v57, v56, s60
    v_accvgpr_write_b32 a184, v8
    v_perm_b32 v9, v59, v58, s60
    v_accvgpr_write_b32 a185, v9
    v_perm_b32 v10, v61, v60, s60
    v_accvgpr_write_b32 a186, v10
    v_perm_b32 v11, v63, v62, s60
    v_accvgpr_write_b32 a187, v11
    v_perm_b32 v8, v57, v56, s61
    v_accvgpr_write_b32 a188, v8
    v_perm_b32 v9, v59, v58, s61
    v_accvgpr_write_b32 a189, v9
    v_perm_b32 v10, v61, v60, s61
    v_accvgpr_write_b32 a190, v10
    v_perm_b32 v11, v63, v62, s61
    v_accvgpr_write_b32 a191, v11
    s_add_u32 s63, s46, 917504
    buffer_load_dword v48, v6, s[12:15], s63 offen
    s_add_u32 s63, s46, 918528
    buffer_load_dword v49, v6, s[12:15], s63 offen
    s_add_u32 s63, s46, 919552
    buffer_load_dword v50, v6, s[12:15], s63 offen
    s_add_u32 s63, s46, 920576
    buffer_load_dword v51, v6, s[12:15], s63 offen
    s_add_u32 s63, s46, 921600
    buffer_load_dword v52, v6, s[12:15], s63 offen
    s_add_u32 s63, s46, 922624
    buffer_load_dword v53, v6, s[12:15], s63 offen
    s_add_u32 s63, s46, 923648
    buffer_load_dword v54, v6, s[12:15], s63 offen
    s_add_u32 s63, s46, 924672
    buffer_load_dword v55, v6, s[12:15], s63 offen
    s_add_u32 s63, s46, 950272
    buffer_load_dword v56, v6, s[12:15], s63 offen
    s_add_u32 s63, s46, 951296
    buffer_load_dword v57, v6, s[12:15], s63 offen
    s_add_u32 s63, s46, 952320
    buffer_load_dword v58, v6, s[12:15], s63 offen
    s_add_u32 s63, s46, 953344
    buffer_load_dword v59, v6, s[12:15], s63 offen
    s_add_u32 s63, s46, 954368
    buffer_load_dword v60, v6, s[12:15], s63 offen
    s_add_u32 s63, s46, 955392
    buffer_load_dword v61, v6, s[12:15], s63 offen
    s_add_u32 s63, s46, 956416
    buffer_load_dword v62, v6, s[12:15], s63 offen
    s_add_u32 s63, s46, 957440
    buffer_load_dword v63, v6, s[12:15], s63 offen
    s_waitcnt vmcnt(32)
    v_perm_b32 v8, v17, v16, s60
    v_accvgpr_write_b32 a192, v8
    v_perm_b32 v9, v19, v18, s60
    v_accvgpr_write_b32 a193, v9
    v_perm_b32 v10, v21, v20, s60
    v_accvgpr_write_b32 a194, v10
    v_perm_b32 v11, v23, v22, s60
    v_accvgpr_write_b32 a195, v11
    v_perm_b32 v8, v17, v16, s61
    v_accvgpr_write_b32 a196, v8
    v_perm_b32 v9, v19, v18, s61
    v_accvgpr_write_b32 a197, v9
    v_perm_b32 v10, v21, v20, s61
    v_accvgpr_write_b32 a198, v10
    v_perm_b32 v11, v23, v22, s61
    v_accvgpr_write_b32 a199, v11
    v_perm_b32 v8, v25, v24, s60
    v_accvgpr_write_b32 a200, v8
    v_perm_b32 v9, v27, v26, s60
    v_accvgpr_write_b32 a201, v9
    v_perm_b32 v10, v29, v28, s60
    v_accvgpr_write_b32 a202, v10
    v_perm_b32 v11, v31, v30, s60
    v_accvgpr_write_b32 a203, v11
    v_perm_b32 v8, v25, v24, s61
    v_accvgpr_write_b32 a204, v8
    v_perm_b32 v9, v27, v26, s61
    v_accvgpr_write_b32 a205, v9
    v_perm_b32 v10, v29, v28, s61
    v_accvgpr_write_b32 a206, v10
    v_perm_b32 v11, v31, v30, s61
    v_accvgpr_write_b32 a207, v11
    s_add_u32 s63, s46, 983040
    buffer_load_dword v16, v6, s[12:15], s63 offen
    s_add_u32 s63, s46, 984064
    buffer_load_dword v17, v6, s[12:15], s63 offen
    s_add_u32 s63, s46, 985088
    buffer_load_dword v18, v6, s[12:15], s63 offen
    s_add_u32 s63, s46, 986112
    buffer_load_dword v19, v6, s[12:15], s63 offen
    s_add_u32 s63, s46, 987136
    buffer_load_dword v20, v6, s[12:15], s63 offen
    s_add_u32 s63, s46, 988160
    buffer_load_dword v21, v6, s[12:15], s63 offen
    s_add_u32 s63, s46, 989184
    buffer_load_dword v22, v6, s[12:15], s63 offen
    s_add_u32 s63, s46, 990208
    buffer_load_dword v23, v6, s[12:15], s63 offen
    s_add_u32 s63, s46, 1015808
    buffer_load_dword v24, v6, s[12:15], s63 offen
    s_add_u32 s63, s46, 1016832
    buffer_load_dword v25, v6, s[12:15], s63 offen
    s_add_u32 s63, s46, 1017856
    buffer_load_dword v26, v6, s[12:15], s63 offen
    s_add_u32 s63, s46, 1018880
    buffer_load_dword v27, v6, s[12:15], s63 offen
    s_add_u32 s63, s46, 1019904
    buffer_load_dword v28, v6, s[12:15], s63 offen
    s_add_u32 s63, s46, 1020928
    buffer_load_dword v29, v6, s[12:15], s63 offen
    s_add_u32 s63, s46, 1021952
    buffer_load_dword v30, v6, s[12:15], s63 offen
    s_add_u32 s63, s46, 1022976
    buffer_load_dword v31, v6, s[12:15], s63 offen
    s_waitcnt vmcnt(32)
    v_perm_b32 v8, v33, v32, s60
    v_accvgpr_write_b32 a208, v8
    v_perm_b32 v9, v35, v34, s60
    v_accvgpr_write_b32 a209, v9
    v_perm_b32 v10, v37, v36, s60
    v_accvgpr_write_b32 a210, v10
    v_perm_b32 v11, v39, v38, s60
    v_accvgpr_write_b32 a211, v11
    v_perm_b32 v8, v33, v32, s61
    v_accvgpr_write_b32 a212, v8
    v_perm_b32 v9, v35, v34, s61
    v_accvgpr_write_b32 a213, v9
    v_perm_b32 v10, v37, v36, s61
    v_accvgpr_write_b32 a214, v10
    v_perm_b32 v11, v39, v38, s61
    v_accvgpr_write_b32 a215, v11
    v_perm_b32 v8, v41, v40, s60
    v_accvgpr_write_b32 a216, v8
    v_perm_b32 v9, v43, v42, s60
    v_accvgpr_write_b32 a217, v9
    v_perm_b32 v10, v45, v44, s60
    v_accvgpr_write_b32 a218, v10
    v_perm_b32 v11, v47, v46, s60
    v_accvgpr_write_b32 a219, v11
    v_perm_b32 v8, v41, v40, s61
    v_accvgpr_write_b32 a220, v8
    v_perm_b32 v9, v43, v42, s61
    v_accvgpr_write_b32 a221, v9
    v_perm_b32 v10, v45, v44, s61
    v_accvgpr_write_b32 a222, v10
    v_perm_b32 v11, v47, v46, s61
    v_accvgpr_write_b32 a223, v11
    s_waitcnt vmcnt(16)
    v_perm_b32 v8, v49, v48, s60
    v_accvgpr_write_b32 a224, v8
    v_perm_b32 v9, v51, v50, s60
    v_accvgpr_write_b32 a225, v9
    v_perm_b32 v10, v53, v52, s60
    v_accvgpr_write_b32 a226, v10
    v_perm_b32 v11, v55, v54, s60
    v_accvgpr_write_b32 a227, v11
    v_perm_b32 v8, v49, v48, s61
    v_accvgpr_write_b32 a228, v8
    v_perm_b32 v9, v51, v50, s61
    v_accvgpr_write_b32 a229, v9
    v_perm_b32 v10, v53, v52, s61
    v_accvgpr_write_b32 a230, v10
    v_perm_b32 v11, v55, v54, s61
    v_accvgpr_write_b32 a231, v11
    v_perm_b32 v8, v57, v56, s60
    v_accvgpr_write_b32 a232, v8
    v_perm_b32 v9, v59, v58, s60
    v_accvgpr_write_b32 a233, v9
    v_perm_b32 v10, v61, v60, s60
    v_accvgpr_write_b32 a234, v10
    v_perm_b32 v11, v63, v62, s60
    v_accvgpr_write_b32 a235, v11
    v_perm_b32 v8, v57, v56, s61
    v_accvgpr_write_b32 a236, v8
    v_perm_b32 v9, v59, v58, s61
    v_accvgpr_write_b32 a237, v9
    v_perm_b32 v10, v61, v60, s61
    v_accvgpr_write_b32 a238, v10
    v_perm_b32 v11, v63, v62, s61
    v_accvgpr_write_b32 a239, v11
    s_waitcnt vmcnt(0)
    v_perm_b32 v8, v17, v16, s60
    v_accvgpr_write_b32 a240, v8
    v_perm_b32 v9, v19, v18, s60
    v_accvgpr_write_b32 a241, v9
    v_perm_b32 v10, v21, v20, s60
    v_accvgpr_write_b32 a242, v10
    v_perm_b32 v11, v23, v22, s60
    v_accvgpr_write_b32 a243, v11
    v_perm_b32 v8, v17, v16, s61
    v_accvgpr_write_b32 a244, v8
    v_perm_b32 v9, v19, v18, s61
    v_accvgpr_write_b32 a245, v9
    v_perm_b32 v10, v21, v20, s61
    v_accvgpr_write_b32 a246, v10
    v_perm_b32 v11, v23, v22, s61
    v_accvgpr_write_b32 a247, v11
    v_perm_b32 v8, v25, v24, s60
    v_accvgpr_write_b32 a248, v8
    v_perm_b32 v9, v27, v26, s60
    v_accvgpr_write_b32 a249, v9
    v_perm_b32 v10, v29, v28, s60
    v_accvgpr_write_b32 a250, v10
    v_perm_b32 v11, v31, v30, s60
    v_accvgpr_write_b32 a251, v11
    v_perm_b32 v8, v25, v24, s61
    v_accvgpr_write_b32 a252, v8
    v_perm_b32 v9, v27, v26, s61
    v_accvgpr_write_b32 a253, v9
    v_perm_b32 v10, v29, v28, s61
    v_accvgpr_write_b32 a254, v10
    v_perm_b32 v11, v31, v30, s61
    v_accvgpr_write_b32 a255, v11
    s_lshl_b32 s50, s29, 11
    s_mov_b32 s51, 0
    s_mov_b32 s46, 0
    s_mov_b32 s47, 0
    s_add_u32 s48, s66, 3952
    v_lshlrev_b32 v10, 12, v1
    v_add_u32 v10, s48, v10
    s_barrier
L_op_loop:
    s_lshr_b32 s45, s44, 1
    s_mov_b32 s54, s44
    s_cmp_ge_u32 s44, 126
    s_cselect_b64 s[52:53], s[64:65], -1
    s_and_b32 s48, s45, 7
    s_lshl_b32 s48, s48, 2
    s_add_u32 s48, s48, s29
    s_lshl_b32 s48, s48, 7
    s_add_u32 s48, s48, 0x4702000
    s_lshr_b32 s49, s45, 3
    s_cmp_ge_u32 s45, 62
    s_cselect_b32 s49, 6, s49
    s_cmp_gt_u32 s46, s49
    s_cbranch_scc1 L_op_sk
    s_mov_b32 s57, 400000
L_op_w:
    buffer_load_ushort v8, off, s[4:7], s48 sc1
    s_waitcnt vmcnt(0)
    v_readfirstlane_b32 s56, v8
    s_and_b32 s58, s56, 0xff
    s_lshr_b32 s56, s56, 8
    s_min_u32 s56, s56, s58
    s_cmp_gt_u32 s56, s49
    s_cbranch_scc1 L_op_w_ok
    s_sleep 16
    s_sub_u32 s57, s57, 1
    s_cbranch_scc0 L_op_w
L_op_w_ok:
    s_mov_b32 s46, s56
L_op_sk:
    s_lshl_b32 s55, s54, 17
    s_lshl_b32 s49, s29, 15
    s_add_u32 s55, s55, s49
    s_add_u32 s55, s55, 0x5000000
    s_cmp_lt_u32 s45, 62
    s_cselect_b32 s57, 0, 100000
    s_cbranch_scc1 L_op_ld
L_op_sp:
    s_mov_b64 exec, 0xff
    buffer_load_dword v8, v10, s[4:7], s55 offen sc1
    s_waitcnt vmcnt(0)
    v_cmp_eq_u32 vcc, -1, v8
    s_cbranch_vccz L_op_ld
    s_sub_u32 s57, s57, 1
    s_cbranch_scc0 L_op_sp
    s_mov_b32 s57, 0
L_op_ld:
    s_mov_b64 exec, s[52:53]
    s_mov_b32 s48, s55
    v_mov_b32 v11, 0
    s_cmp_ge_u32 s45, 62
    s_cbranch_scc1 L_op_l1
    buffer_load_dwordx4 v[128:131], v4, s[4:7], s48 offen offset:0
    buffer_load_dwordx4 v[132:135], v4, s[4:7], s48 offen offset:1024
    buffer_load_dwordx4 v[136:139], v4, s[4:7], s48 offen offset:2048
    buffer_load_dwordx4 v[140:143], v4, s[4:7], s48 offen offset:3072
    s_add_u32 s48, s48, 4096
    buffer_load_dwordx4 v[144:147], v4, s[4:7], s48 offen offset:0
    buffer_load_dwordx4 v[148:151], v4, s[4:7], s48 offen offset:1024
    buffer_load_dwordx4 v[152:155], v4, s[4:7], s48 offen offset:2048
    buffer_load_dwordx4 v[156:159], v4, s[4:7], s48 offen offset:3072
    s_add_u32 s48, s48, 4096
    buffer_load_dwordx4 v[160:163], v4, s[4:7], s48 offen offset:0
    buffer_load_dwordx4 v[164:167], v4, s[4:7], s48 offen offset:1024
    buffer_load_dwordx4 v[168:171], v4, s[4:7], s48 offen offset:2048
    buffer_load_dwordx4 v[172:175], v4, s[4:7], s48 offen offset:3072
    s_add_u32 s48, s48, 4096
    buffer_load_dwordx4 v[176:179], v4, s[4:7], s48 offen offset:0
    buffer_load_dwordx4 v[180:183], v4, s[4:7], s48 offen offset:1024
    buffer_load_dwordx4 v[184:187], v4, s[4:7], s48 offen offset:2048
    buffer_load_dwordx4 v[188:191], v4, s[4:7], s48 offen offset:3072
    s_add_u32 s48, s48, 4096
    buffer_load_dwordx4 v[192:195], v4, s[4:7], s48 offen offset:0
    buffer_load_dwordx4 v[196:199], v4, s[4:7], s48 offen offset:1024
    buffer_load_dwordx4 v[200:203], v4, s[4:7], s48 offen offset:2048
    buffer_load_dwordx4 v[204:207], v4, s[4:7], s48 offen offset:3072
    s_add_u32 s48, s48, 4096
    buffer_load_dwordx4 v[208:211], v4, s[4:7], s48 offen offset:0
    buffer_load_dwordx4 v[212:215], v4, s[4:7], s48 offen offset:1024
    buffer_load_dwordx4 v[216:219], v4, s[4:7], s48 offen offset:2048
    buffer_load_dwordx4 v[220:223], v4, s[4:7], s48 offen offset:3072
    s_add_u32 s48, s48, 4096
    buffer_load_dwordx4 v[224:227], v4, s[4:7], s48 offen offset:0
    buffer_load_dwordx4 v[228:231], v4, s[4:7], s48 offen offset:1024
    buffer_load_dwordx4 v[232:235], v4, s[4:7], s48 offen offset:2048
    buffer_load_dwordx4 v[236:239], v4, s[4:7], s48 offen offset:3072
    s_add_u32 s48, s48, 4096
    buffer_load_dwordx4 v[240:243], v4, s[4:7], s48 offen offset:0
    buffer_load_dwordx4 v[244:247], v4, s[4:7], s48 offen offset:1024
    buffer_load_dwordx4 v[248:251], v4, s[4:7], s48 offen offset:2048
    buffer_load_dwordx4 v[252:255], v4, s[4:7], s48 offen offset:3072
    s_branch L_op_l2
L_op_l1:
    buffer_load_dwordx4 v[128:131], v4, s[4:7], s48 offen offset:0 sc1
    buffer_load_dwordx4 v[132:135], v4, s[4:7], s48 offen offset:1024 sc1
    buffer_load_dwordx4 v[136:139], v4, s[4:7], s48 offen offset:2048 sc1
    buffer_load_dwordx4 v[140:143], v4, s[4:7], s48 offen offset:3072 sc1
    s_add_u32 s48, s48, 4096
    buffer_load_dwordx4 v[144:147], v4, s[4:7], s48 offen offset:0 sc1
    buffer_load_dwordx4 v[148:151], v4, s[4:7], s48 offen offset:1024 sc1
    buffer_load_dwordx4 v[152:155], v4, s[4:7], s48 offen offset:2048 sc1
    buffer_load_dwordx4 v[156:159], v4, s[4:7], s48 offen offset:3072 sc1
    s_add_u32 s48, s48, 4096
    buffer_load_dwordx4 v[160:163], v4, s[4:7], s48 offen offset:0 sc1
    buffer_load_dwordx4 v[164:167], v4, s[4:7], s48 offen offset:1024 sc1
    buffer_load_dwordx4 v[168:171], v4, s[4:7], s48 offen offset:2048 sc1
    buffer_load_dwordx4 v[172:175], v4, s[4:7], s48 offen offset:3072 sc1
    s_add_u32 s48, s48, 4096
    buffer_load_dwordx4 v[176:179], v4, s[4:7], s48 offen offset:0 sc1
    buffer_load_dwordx4 v[180:183], v4, s[4:7], s48 offen offset:1024 sc1
    buffer_load_dwordx4 v[184:187], v4, s[4:7], s48 offen offset:2048 sc1
    buffer_load_dwordx4 v[188:191], v4, s[4:7], s48 offen offset:3072 sc1
    s_add_u32 s48, s48, 4096
    buffer_load_dwordx4 v[192:195], v4, s[4:7], s48 offen offset:0 sc1
    buffer_load_dwordx4 v[196:199], v4, s[4:7], s48 offen offset:1024 sc1
    buffer_load_dwordx4 v[200:203], v4, s[4:7], s48 offen offset:2048 sc1
    buffer_load_dwordx4 v[204:207], v4, s[4:7], s48 offen offset:3072 sc1
    s_add_u32 s48, s48, 4096
    buffer_load_dwordx4 v[208:211], v4, s[4:7], s48 offen offset:0 sc1
    buffer_load_dwordx4 v[212:215], v4, s[4:7], s48 offen offset:1024 sc1
    buffer_load_dwordx4 v[216:219], v4, s[4:7], s48 offen offset:2048 sc1
    buffer_load_dwordx4 v[220:223], v4, s[4:7], s48 offen offset:3072 sc1
    s_add_u32 s48, s48, 4096
    buffer_load_dwordx4 v[224:227], v4, s[4:7], s48 offen offset:0 sc1
    buffer_load_dwordx4 v[228:231], v4, s[4:7], s48 offen offset:1024 sc1
    buffer_load_dwordx4 v[232:235], v4, s[4:7], s48 offen offset:2048 sc1
    buffer_load_dwordx4 v[236:239], v4, s[4:7], s48 offen offset:3072 sc1
    s_add_u32 s48, s48, 4096
    buffer_load_dwordx4 v[240:243], v4, s[4:7], s48 offen offset:0 sc1
    buffer_load_dwordx4 v[244:247], v4, s[4:7], s48 offen offset:1024 sc1
    buffer_load_dwordx4 v[248:251], v4, s[4:7], s48 offen offset:2048 sc1
    buffer_load_dwordx4 v[252:255], v4, s[4:7], s48 offen offset:3072 sc1
L_op_l2:
    s_waitcnt vmcnt(31)
    v_mfma_f32_16x16x32_bf16 v[16:19], a[0:3], v[128:131], 0
    v_max3_u32 v11, v11, v128, v129
    v_mfma_f32_16x16x32_bf16 v[20:23], a[4:7], v[128:131], 0
    v_max3_u32 v11, v11, v130, v131
    s_waitcnt vmcnt(30)
    v_mfma_f32_16x16x32_bf16 v[16:19], a[8:11], v[132:135], v[16:19]
    v_max3_u32 v11, v11, v132, v133
    v_mfma_f32_16x16x32_bf16 v[20:23], a[12:15], v[132:135], v[20:23]
    v_max3_u32 v11, v11, v134, v135
    s_waitcnt vmcnt(29)
    v_mfma_f32_16x16x32_bf16 v[16:19], a[16:19], v[136:139], v[16:19]
    v_max3_u32 v11, v11, v136, v137
    v_mfma_f32_16x16x32_bf16 v[20:23], a[20:23], v[136:139], v[20:23]
    v_max3_u32 v11, v11, v138, v139
    s_waitcnt vmcnt(28)
    v_mfma_f32_16x16x32_bf16 v[16:19], a[24:27], v[140:143], v[16:19]
    v_max3_u32 v11, v11, v140, v141
    v_mfma_f32_16x16x32_bf16 v[20:23], a[28:31], v[140:143], v[20:23]
    v_max3_u32 v11, v11, v142, v143
    s_waitcnt vmcnt(27)
    v_mfma_f32_16x16x32_bf16 v[16:19], a[32:35], v[144:147], v[16:19]
    v_max3_u32 v11, v11, v144, v145
    v_mfma_f32_16x16x32_bf16 v[20:23], a[36:39], v[144:147], v[20:23]
    v_max3_u32 v11, v11, v146, v147
    s_waitcnt vmcnt(26)
    v_mfma_f32_16x16x32_bf16 v[16:19], a[40:43], v[148:151], v[16:19]
    v_max3_u32 v11, v11, v148, v149
    v_mfma_f32_16x16x32_bf16 v[20:23], a[44:47], v[148:151], v[20:23]
    v_max3_u32 v11, v11, v150, v151
    s_waitcnt vmcnt(25)
    v_mfma_f32_16x16x32_bf16 v[16:19], a[48:51], v[152:155], v[16:19]
    v_max3_u32 v11, v11, v152, v153
    v_mfma_f32_16x16x32_bf16 v[20:23], a[52:55], v[152:155], v[20:23]
    v_max3_u32 v11, v11, v154, v155
    s_waitcnt vmcnt(24)
    v_mfma_f32_16x16x32_bf16 v[16:19], a[56:59], v[156:159], v[16:19]
    v_max3_u32 v11, v11, v156, v157
    v_mfma_f32_16x16x32_bf16 v[20:23], a[60:63], v[156:159], v[20:23]
    v_max3_u32 v11, v11, v158, v159
    s_waitcnt vmcnt(23)
    v_mfma_f32_16x16x32_bf16 v[16:19], a[64:67], v[160:163], v[16:19]
    v_max3_u32 v11, v11, v160, v161
    v_mfma_f32_16x16x32_bf16 v[20:23], a[68:71], v[160:163], v[20:23]
    v_max3_u32 v11, v11, v162, v163
    s_waitcnt vmcnt(22)
    v_mfma_f32_16x16x32_bf16 v[16:19], a[72:75], v[164:167], v[16:19]
    v_max3_u32 v11, v11, v164, v165
    v_mfma_f32_16x16x32_bf16 v[20:23], a[76:79], v[164:167], v[20:23]
    v_max3_u32 v11, v11, v166, v167
    s_waitcnt vmcnt(21)
    v_mfma_f32_16x16x32_bf16 v[16:19], a[80:83], v[168:171], v[16:19]
    v_max3_u32 v11, v11, v168, v169
    v_mfma_f32_16x16x32_bf16 v[20:23], a[84:87], v[168:171], v[20:23]
    v_max3_u32 v11, v11, v170, v171
    s_waitcnt vmcnt(20)
    v_mfma_f32_16x16x32_bf16 v[16:19], a[88:91], v[172:175], v[16:19]
    v_max3_u32 v11, v11, v172, v173
    v_mfma_f32_16x16x32_bf16 v[20:23], a[92:95], v[172:175], v[20:23]
    v_max3_u32 v11, v11, v174, v175
    s_waitcnt vmcnt(19)
    v_mfma_f32_16x16x32_bf16 v[16:19], a[96:99], v[176:179], v[16:19]
    v_max3_u32 v11, v11, v176, v177
    v_mfma_f32_16x16x32_bf16 v[20:23], a[100:103], v[176:179], v[20:23]
    v_max3_u32 v11, v11, v178, v179
    s_waitcnt vmcnt(18)
    v_mfma_f32_16x16x32_bf16 v[16:19], a[104:107], v[180:183], v[16:19]
    v_max3_u32 v11, v11, v180, v181
    v_mfma_f32_16x16x32_bf16 v[20:23], a[108:111], v[180:183], v[20:23]
    v_max3_u32 v11, v11, v182, v183
    s_waitcnt vmcnt(17)
    v_mfma_f32_16x16x32_bf16 v[16:19], a[112:115], v[184:187], v[16:19]
    v_max3_u32 v11, v11, v184, v185
    v_mfma_f32_16x16x32_bf16 v[20:23], a[116:119], v[184:187], v[20:23]
    v_max3_u32 v11, v11, v186, v187
    s_waitcnt vmcnt(16)
    v_mfma_f32_16x16x32_bf16 v[16:19], a[120:123], v[188:191], v[16:19]
    v_max3_u32 v11, v11, v188, v189
    v_mfma_f32_16x16x32_bf16 v[20:23], a[124:127], v[188:191], v[20:23]
    v_max3_u32 v11, v11, v190, v191
    s_waitcnt vmcnt(15)
    v_mfma_f32_16x16x32_bf16 v[16:19], a[128:131], v[192:195], v[16:19]
    v_max3_u32 v11, v11, v192, v193
    v_mfma_f32_16x16x32_bf16 v[20:23], a[132:135], v[192:195], v[20:23]
    v_max3_u32 v11, v11, v194, v195
    s_waitcnt vmcnt(14)
    v_mfma_f32_16x16x32_bf16 v[16:19], a[136:139], v[196:199], v[16:19]
    v_max3_u32 v11, v11, v196, v197
    v_mfma_f32_16x16x32_bf16 v[20:23], a[140:143], v[196:199], v[20:23]
    v_max3_u32 v11, v11, v198, v199
    s_waitcnt vmcnt(13)
    v_mfma_f32_16x16x32_bf16 v[16:19], a[144:147], v[200:203], v[16:19]
    v_max3_u32 v11, v11, v200, v201
    v_mfma_f32_16x16x32_bf16 v[20:23], a[148:151], v[200:203], v[20:23]
    v_max3_u32 v11, v11, v202, v203
    s_waitcnt vmcnt(12)
    v_mfma_f32_16x16x32_bf16 v[16:19], a[152:155], v[204:207], v[16:19]
    v_max3_u32 v11, v11, v204, v205
    v_mfma_f32_16x16x32_bf16 v[20:23], a[156:159], v[204:207], v[20:23]
    v_max3_u32 v11, v11, v206, v207
    s_waitcnt vmcnt(11)
    v_mfma_f32_16x16x32_bf16 v[16:19], a[160:163], v[208:211], v[16:19]
    v_max3_u32 v11, v11, v208, v209
    v_mfma_f32_16x16x32_bf16 v[20:23], a[164:167], v[208:211], v[20:23]
    v_max3_u32 v11, v11, v210, v211
    s_waitcnt vmcnt(10)
    v_mfma_f32_16x16x32_bf16 v[16:19], a[168:171], v[212:215], v[16:19]
    v_max3_u32 v11, v11, v212, v213
    v_mfma_f32_16x16x32_bf16 v[20:23], a[172:175], v[212:215], v[20:23]
    v_max3_u32 v11, v11, v214, v215
    s_waitcnt vmcnt(9)
    v_mfma_f32_16x16x32_bf16 v[16:19], a[176:179], v[216:219], v[16:19]
    v_max3_u32 v11, v11, v216, v217
    v_mfma_f32_16x16x32_bf16 v[20:23], a[180:183], v[216:219], v[20:23]
    v_max3_u32 v11, v11, v218, v219
    s_waitcnt vmcnt(8)
    v_mfma_f32_16x16x32_bf16 v[16:19], a[184:187], v[220:223], v[16:19]
    v_max3_u32 v11, v11, v220, v221
    v_mfma_f32_16x16x32_bf16 v[20:23], a[188:191], v[220:223], v[20:23]
    v_max3_u32 v11, v11, v222, v223
    s_waitcnt vmcnt(7)
    v_mfma_f32_16x16x32_bf16 v[16:19], a[192:195], v[224:227], v[16:19]
    v_max3_u32 v11, v11, v224, v225
    v_mfma_f32_16x16x32_bf16 v[20:23], a[196:199], v[224:227], v[20:23]
    v_max3_u32 v11, v11, v226, v227
    s_waitcnt vmcnt(6)
    v_mfma_f32_16x16x32_bf16 v[16:19], a[200:203], v[228:231], v[16:19]
    v_max3_u32 v11, v11, v228, v229
    v_mfma_f32_16x16x32_bf16 v[20:23], a[204:207], v[228:231], v[20:23]
    v_max3_u32 v11, v11, v230, v231
    s_waitcnt vmcnt(5)
    v_mfma_f32_16x16x32_bf16 v[16:19], a[208:211], v[232:235], v[16:19]
    v_max3_u32 v11, v11, v232, v233
    v_mfma_f32_16x16x32_bf16 v[20:23], a[212:215], v[232:235], v[20:23]
    v_max3_u32 v11, v11, v234, v235
    s_waitcnt vmcnt(4)
    v_mfma_f32_16x16x32_bf16 v[16:19], a[216:219], v[236:239], v[16:19]
    v_max3_u32 v11, v11, v236, v237
    v_mfma_f32_16x16x32_bf16 v[20:23], a[220:223], v[236:239], v[20:23]
    v_max3_u32 v11, v11, v238, v239
    s_waitcnt vmcnt(3)
    v_mfma_f32_16x16x32_bf16 v[16:19], a[224:227], v[240:243], v[16:19]
    v_max3_u32 v11, v11, v240, v241
    v_mfma_f32_16x16x32_bf16 v[20:23], a[228:231], v[240:243], v[20:23]
    v_max3_u32 v11, v11, v242, v243
    s_waitcnt vmcnt(2)
    v_mfma_f32_16x16x32_bf16 v[16:19], a[232:235], v[244:247], v[16:19]
    v_max3_u32 v11, v11, v244, v245
    v_mfma_f32_16x16x32_bf16 v[20:23], a[236:239], v[244:247], v[20:23]
    v_max3_u32 v11, v11, v246, v247
    s_waitcnt vmcnt(1)
    v_mfma_f32_16x16x32_bf16 v[16:19], a[240:243], v[248:251], v[16:19]
    v_max3_u32 v11, v11, v248, v249
    v_mfma_f32_16x16x32_bf16 v[20:23], a[244:247], v[248:251], v[20:23]
    v_max3_u32 v11, v11, v250, v251
    s_waitcnt vmcnt(0)
    v_mfma_f32_16x16x32_bf16 v[16:19], a[248:251], v[252:255], v[16:19]
    v_max3_u32 v11, v11, v252, v253
    v_mfma_f32_16x16x32_bf16 v[20:23], a[252:255], v[252:255], v[20:23]
    v_max3_u32 v11, v11, v254, v255
    v_cmp_eq_u32 vcc, -1, v11
    s_cbranch_vccz L_op_go
    s_sub_u32 s57, s57, 1
    s_cbranch_scc0 L_op_sp
L_op_go:
    v_add_u32 v7, s51, v4
    v_add_u32 v9, s50, v7
    s_xor_b32 s51, s51, 0x2000
    s_nop 5
    ds_write_b128 v9, v[16:19]
    ds_write_b128 v9, v[20:23] offset:1024
    s_waitcnt lgkmcnt(0)
    s_barrier
    s_cmp_lg_u32 s29, 0
    s_cbranch_scc1 L_op_next
    ds_read_b128 v[24:27], v7 offset:2048
    ds_read_b128 v[28:31], v7 offset:3072
    ds_read_b128 v[32:35], v7 offset:4096
    ds_read_b128 v[36:39], v7 offset:5120
    ds_read_b128 v[40:43], v7 offset:6144
    ds_read_b128 v[44:47], v7 offset:7168
    s_waitcnt lgkmcnt(0)
    v_add_f32 v16, v16, v24
    v_add_f32 v17, v17, v25
    v_add_f32 v18, v18, v26
    v_add_f32 v19, v19, v27
    v_add_f32 v20, v20, v28
    v_add_f32 v21, v21, v29
    v_add_f32 v22, v22, v30
    v_add_f32 v23, v23, v31
    v_add_f32 v16, v16, v32
    v_add_f32 v17, v17, v33
    v_add_f32 v18, v18, v34
    v_add_f32 v19, v19, v35
    v_add_f32 v20, v20, v36
    v_add_f32 v21, v21, v37
    v_add_f32 v22, v22, v38
    v_add_f32 v23, v23, v39
    v_add_f32 v16, v16, v40
    v_add_f32 v17, v17, v41
    v_add_f32 v18, v18, v42
    v_add_f32 v19, v19, v43
    v_add_f32 v20, v20, v44
    v_add_f32 v21, v21, v45
    v_add_f32 v22, v22, v46
    v_add_f32 v23, v23, v47
    v_cvt_pk_bf16_f32 v48, v16, v20
    v_cvt_pk_bf16_f32 v49, v17, v21
    v_cvt_pk_bf16_f32 v50, v18, v22
    v_cvt_pk_bf16_f32 v51, v19, v23
    s_lshl_b32 s48, s54, 15
    buffer_store_dwordx4 v[48:51], v5, s[16:19], s48 offen
L_op_next:
    s_mov_b32 s58, s46
    s_mov_b32 s46, s47
    s_mov_b32 s47, s58
    s_mov_b64 exec, -1
    s_add_u32 s44, s44, 8
    s_cmp_lt_u32 s44, 128
    s_cbranch_scc1 L_op_loop
    s_waitcnt vmcnt(0)
    s_endpgm
L_attn:
    v_and_b32 v1, 63, v0
    v_and_b32 v2, 15, v1
    v_lshrrev_b32 v3, 4, v1
    v_lshlrev_b32 v4, 4, v1
    s_lshr_b32 s41, s40, 3
    s_and_b32 s42, s40, 7
    s_lshl_b32 s43, s42, 2
    s_add_u32 s43, s43, s29
    s_mov_b32 s44, s41
    s_lshl_b32 s50, s43, 7
    s_add_u32 s50, s50, 0x4700000
    s_lshr_b32 s51, s40, 1
    s_lshl_b32 s51, s51, 7
    s_and_b32 s48, s40, 1
    s_add_u32 s51, s51, s48
    s_add_u32 s51, s51, 0x4702000
    s_mov_b32 s58, 0x3db504f3
    s_mov_b32 s59, 0x3fb8aa3b
    s_mov_b32 s62, 0xffff0000
    v_lshlrev_b32 v5, 2, v3
    v_mov_b32 v7, 0xce6e6b28
    v_add_u32 v6, 0, v5
    v_cmp_le_u32 s[64:65], v6, v2
    v_add_u32 v6, 1, v5
    v_cmp_le_u32 s[66:67], v6, v2
    v_add_u32 v6, 2, v5
    v_cmp_le_u32 s[68:69], v6, v2
    v_add_u32 v6, 3, v5
    v_cmp_le_u32 s[70:71], v6, v2
    s_add_u32 s48, s44, 56
    s_lshl_b32 s48, s48, 18
    s_lshl_b32 s49, s43, 12
    s_add_u32 s48, s48, s49
    s_add_u32 s48, s48, 0x5000000
    s_add_u32 s49, s48, 0x20000
    v_mov_b32 v16, -1
    v_mov_b32 v17, -1
    v_mov_b32 v18, -1
    v_mov_b32 v19, -1
    buffer_store_dwordx4 v[16:19], v4, s[4:7], s48 offen offset:0 sc1
    buffer_store_dwordx4 v[16:19], v4, s[4:7], s48 offen offset:1024 sc1
    buffer_store_dwordx4 v[16:19], v4, s[4:7], s48 offen offset:2048 sc1
    buffer_store_dwordx4 v[16:19], v4, s[4:7], s48 offen offset:3072 sc1
    buffer_store_dwordx4 v[16:19], v4, s[4:7], s49 offen offset:0 sc1
    buffer_store_dwordx4 v[16:19], v4, s[4:7], s49 offen offset:1024 sc1
    buffer_store_dwordx4 v[16:19], v4, s[4:7], s49 offen offset:2048 sc1
    buffer_store_dwordx4 v[16:19], v4, s[4:7], s49 offen offset:3072 sc1
    s_mov_b32 s57, 400000
L_at_pd:
    buffer_load_dword v8, off, s[8:11], 0 offset:36 sc1
    s_waitcnt vmcnt(0)
    v_readfirstlane_b32 s56, v8
    s_cmp_ge_u32 s56, 192
    s_cbranch_scc1 L_at_pd_ok
    s_sleep 8
    s_sub_u32 s57, s57, 1
    s_cbranch_scc0 L_at_pd
L_at_pd_ok:
    s_lshl_b32 s45, s44, 5
    s_add_u32 s45, s45, s43
    s_lshl_b32 s46, s45, 13
    s_lshl_b32 s47, s45, 12
    s_add_u32 s48, s46, 0x0
    buffer_load_dwordx4 v[16:19], v4, s[4:7], s48 offen offset:0 sc1
    buffer_load_dwordx4 v[20:23], v4, s[4:7], s48 offen offset:1024 sc1
    buffer_load_dwordx4 v[24:27], v4, s[4:7], s48 offen offset:2048 sc1
    buffer_load_dwordx4 v[28:31], v4, s[4:7], s48 offen offset:3072 sc1
    s_add_u32 s48, s46, 0x1000
    buffer_load_dwordx4 v[32:35], v4, s[4:7], s48 offen offset:0 sc1
    buffer_load_dwordx4 v[36:39], v4, s[4:7], s48 offen offset:1024 sc1
    buffer_load_dwordx4 v[40:43], v4, s[4:7], s48 offen offset:2048 sc1
    buffer_load_dwordx4 v[44:47], v4, s[4:7], s48 offen offset:3072 sc1
    s_add_u32 s48, s46, 0x1000000
    buffer_load_dwordx4 v[48:51], v4, s[4:7], s48 offen offset:0 sc1
    buffer_load_dwordx4 v[52:55], v4, s[4:7], s48 offen offset:1024 sc1
    buffer_load_dwordx4 v[56:59], v4, s[4:7], s48 offen offset:2048 sc1
    buffer_load_dwordx4 v[60:63], v4, s[4:7], s48 offen offset:3072 sc1
    s_add_u32 s48, s46, 0x1001000
    buffer_load_dwordx4 v[64:67], v4, s[4:7], s48 offen offset:0 sc1
    buffer_load_dwordx4 v[68:71], v4, s[4:7], s48 offen offset:1024 sc1
    buffer_load_dwordx4 v[72:75], v4, s[4:7], s48 offen offset:2048 sc1
    buffer_load_dwordx4 v[76:79], v4, s[4:7], s48 offen offset:3072 sc1
    s_add_u32 s48, s46, 0x2000000
    buffer_load_dwordx4 v[96:99], v4, s[4:7], s48 offen offset:0 sc1
    buffer_load_dwordx4 v[100:103], v4, s[4:7], s48 offen offset:1024 sc1
    buffer_load_dwordx4 v[104:107], v4, s[4:7], s48 offen offset:2048 sc1
    buffer_load_dwordx4 v[108:111], v4, s[4:7], s48 offen offset:3072 sc1
    s_add_u32 s48, s46, 0x2001000
    buffer_load_dwordx4 v[112:115], v4, s[4:7], s48 offen offset:0 sc1
    buffer_load_dwordx4 v[116:119], v4, s[4:7], s48 offen offset:1024 sc1
    buffer_load_dwordx4 v[120:123], v4, s[4:7], s48 offen offset:2048 sc1
    buffer_load_dwordx4 v[124:127], v4, s[4:7], s48 offen offset:3072 sc1
    s_mov_b32 s56, 0
L_at_loop:
    s_min_u32 s52, s44, 60
    s_cmp_eq_u32 s44, 61
    s_cselect_b32 s52, 59, s52
    s_cmp_gt_u32 s56, s52
    s_cbranch_scc0 L_at_slow
    s_add_u32 s48, s47, 0x3100000
    buffer_load_dwordx4 v[80:83], v4, s[4:7], s48 offen offset:0 sc1
    buffer_load_dwordx4 v[84:87], v4, s[4:7], s48 offen offset:1024 sc1
    buffer_load_dwordx4 v[88:91], v4, s[4:7], s48 offen offset:2048 sc1
    buffer_load_dwordx4 v[92:95], v4, s[4:7], s48 offen offset:3072 sc1
    s_add_u32 s48, s47, 0x3a00000
    buffer_load_dwordx4 v[128:131], v4, s[4:7], s48 offen offset:0 sc1
    buffer_load_dwordx4 v[132:135], v4, s[4:7], s48 offen offset:1024 sc1
    buffer_load_dwordx4 v[136:139], v4, s[4:7], s48 offen offset:2048 sc1
    buffer_load_dwordx4 v[140:143], v4, s[4:7], s48 offen offset:3072 sc1
    s_waitcnt vmcnt(8)
    v_mfma_f32_16x16x32_bf16 v[144:147], v[48:51], v[16:19], 0
    v_mfma_f32_16x16x32_bf16 v[156:159], v[48:51], v[32:35], 0
    v_mfma_f32_16x16x32_bf16 v[160:163], v[64:67], v[32:35], 0
    v_mfma_f32_16x16x32_bf16 v[144:147], v[52:55], v[20:23], v[144:147]
    v_mfma_f32_16x16x32_bf16 v[156:159], v[52:55], v[36:39], v[156:159]
    v_mfma_f32_16x16x32_bf16 v[160:163], v[68:71], v[36:39], v[160:163]
    v_mfma_f32_16x16x32_bf16 v[144:147], v[56:59], v[24:27], v[144:147]
    v_mfma_f32_16x16x32_bf16 v[156:159], v[56:59], v[40:43], v[156:159]
    v_mfma_f32_16x16x32_bf16 v[160:163], v[72:75], v[40:43], v[160:163]
    v_mfma_f32_16x16x32_bf16 v[144:147], v[60:63], v[28:31], v[144:147]
    v_mfma_f32_16x16x32_bf16 v[156:159], v[60:63], v[44:47], v[156:159]
    v_mfma_f32_16x16x32_bf16 v[160:163], v[76:79], v[44:47], v[160:163]
    s_cmp_ge_u32 s44, 61
    s_cselect_b32 s57, 100000, 0
    s_branch L_at_chk
L_at_slow:
    s_waitcnt vmcnt(0)
    v_mfma_f32_16x16x32_bf16 v[144:147], v[48:51], v[16:19], 0
    v_mfma_f32_16x16x32_bf16 v[156:159], v[48:51], v[32:35], 0
    v_mfma_f32_16x16x32_bf16 v[160:163], v[64:67], v[32:35], 0
    v_mfma_f32_16x16x32_bf16 v[144:147], v[52:55], v[20:23], v[144:147]
    v_mfma_f32_16x16x32_bf16 v[156:159], v[52:55], v[36:39], v[156:159]
    v_mfma_f32_16x16x32_bf16 v[160:163], v[68:71], v[36:39], v[160:163]
    v_mfma_f32_16x16x32_bf16 v[144:147], v[56:59], v[24:27], v[144:147]
    v_mfma_f32_16x16x32_bf16 v[156:159], v[56:59], v[40:43], v[156:159]
    v_mfma_f32_16x16x32_bf16 v[160:163], v[72:75], v[40:43], v[160:163]
    v_mfma_f32_16x16x32_bf16 v[144:147], v[60:63], v[28:31], v[144:147]
    v_mfma_f32_16x16x32_bf16 v[156:159], v[60:63], v[44:47], v[156:159]
    v_mfma_f32_16x16x32_bf16 v[160:163], v[76:79], v[44:47], v[160:163]
    s_mov_b32 s57, 400000
L_at_cp:
    buffer_load_ubyte v8, off, s[4:7], s50 sc1
    s_waitcnt vmcnt(0)
    v_readfirstlane_b32 s56, v8
    s_cmp_gt_u32 s56, s52
    s_cbranch_scc1 L_at_cp_ok
    s_sleep 8
    s_sub_u32 s57, s57, 1
    s_cbranch_scc0 L_at_cp
L_at_cp_ok:
    s_cmp_ge_u32 s44, 61
    s_cselect_b32 s57, 100000, 0
L_at_ld:
    s_add_u32 s48, s47, 0x3100000
    buffer_load_dwordx4 v[80:83], v4, s[4:7], s48 offen offset:0 sc1
    buffer_load_dwordx4 v[84:87], v4, s[4:7], s48 offen offset:1024 sc1
    buffer_load_dwordx4 v[88:91], v4, s[4:7], s48 offen offset:2048 sc1
    buffer_load_dwordx4 v[92:95], v4, s[4:7], s48 offen offset:3072 sc1
    s_add_u32 s48, s47, 0x3a00000
    buffer_load_dwordx4 v[128:131], v4, s[4:7], s48 offen offset:0 sc1
    buffer_load_dwordx4 v[132:135], v4, s[4:7], s48 offen offset:1024 sc1
    buffer_load_dwordx4 v[136:139], v4, s[4:7], s48 offen offset:2048 sc1
    buffer_load_dwordx4 v[140:143], v4, s[4:7], s48 offen offset:3072 sc1
L_at_chk:
    v_mov_b32 v9, 0
    s_waitcnt vmcnt(7)
    v_max3_u32 v9, v9, v80, v81
    v_max3_u32 v9, v9, v82, v83
    s_waitcnt vmcnt(6)
    v_max3_u32 v9, v9, v84, v85
    v_max3_u32 v9, v9, v86, v87
    s_waitcnt vmcnt(5)
    v_max3_u32 v9, v9, v88, v89
    v_max3_u32 v9, v9, v90, v91
    s_waitcnt vmcnt(4)
    v_max3_u32 v9, v9, v92, v93
    v_max3_u32 v9, v9, v94, v95
    s_waitcnt vmcnt(3)
    v_max3_u32 v9, v9, v128, v129
    v_max3_u32 v9, v9, v130, v131
    s_waitcnt vmcnt(2)
    v_max3_u32 v9, v9, v132, v133
    v_max3_u32 v9, v9, v134, v135
    s_waitcnt vmcnt(1)
    v_max3_u32 v9, v9, v136, v137
    v_max3_u32 v9, v9, v138, v139
    s_waitcnt vmcnt(0)
    v_max3_u32 v9, v9, v140, v141
    v_max3_u32 v9, v9, v142, v143
    v_cmp_eq_u32 vcc, -1, v9
    s_cbranch_vccz L_at_go
    s_sub_u32 s57, s57, 1
    s_cbranch_scc0 L_at_ld
L_at_go:
    v_mfma_f32_16x16x32_bf16 v[152:155], v[80:83], v[16:19], 0
    v_mfma_f32_16x16x32_bf16 v[164:167], v[80:83], v[32:35], 0
    v_mfma_f32_16x16x32_bf16 v[152:155], v[84:87], v[20:23], v[152:155]
    v_mfma_f32_16x16x32_bf16 v[164:167], v[84:87], v[36:39], v[164:167]
    v_mfma_f32_16x16x32_bf16 v[152:155], v[88:91], v[24:27], v[152:155]
    v_mfma_f32_16x16x32_bf16 v[164:167], v[88:91], v[40:43], v[164:167]
    v_mfma_f32_16x16x32_bf16 v[152:155], v[92:95], v[28:31], v[152:155]
    v_mfma_f32_16x16x32_bf16 v[164:167], v[92:95], v[44:47], v[164:167]
    s_nop 7
    v_cvt_pk_bf16_f32 v145, v144, v145
    v_lshlrev_b32 v144, 16, v145
    v_and_b32 v145, s62, v145
    v_cvt_pk_bf16_f32 v147, v146, v147
    v_lshlrev_b32 v146, 16, v147
    v_and_b32 v147, s62, v147
    v_cvt_pk_bf16_f32 v153, v152, v153
    v_lshlrev_b32 v152, 16, v153
    v_and_b32 v153, s62, v153
    v_cvt_pk_bf16_f32 v155, v154, v155
    v_lshlrev_b32 v154, 16, v155
    v_and_b32 v155, s62, v155
    v_mul_f32 v144, s58, v144
    v_mul_f32 v145, s58, v145
    v_mul_f32 v146, s58, v146
    v_mul_f32 v147, s58, v147
    v_mul_f32 v152, s58, v152
    v_mul_f32 v153, s58, v153
    v_mul_f32 v154, s58, v154
    v_mul_f32 v155, s58, v155
    v_cvt_pk_bf16_f32 v145, v144, v145
    v_lshlrev_b32 v144, 16, v145
    v_and_b32 v145, s62, v145
    v_cvt_pk_bf16_f32 v147, v146, v147
    v_lshlrev_b32 v146, 16, v147
    v_and_b32 v147, s62, v147
    v_cvt_pk_bf16_f32 v153, v152, v153
    v_lshlrev_b32 v152, 16, v153
    v_and_b32 v153, s62, v153
    v_cvt_pk_bf16_f32 v155, v154, v155
    v_lshlrev_b32 v154, 16, v155
    v_and_b32 v155, s62, v155
    v_cndmask_b32 v144, v7, v144, s[64:65]
    v_cndmask_b32 v145, v7, v145, s[66:67]
    v_cndmask_b32 v146, v7, v146, s[68:69]
    v_cndmask_b32 v147, v7, v147, s[70:71]
    v_max_f32 v9, v144, v145
    v_max3_f32 v9, v9, v146, v147
    v_max3_f32 v9, v9, v152, v153
    v_max3_f32 v9, v9, v154, v155
    v_mov_b32 v10, v9
    s_nop 1
    v_permlane16_swap_b32 v9, v10
    s_nop 1
    v_max_f32 v9, v9, v10
    v_mov_b32 v10, v9
    s_nop 1
    v_permlane32_swap_b32 v9, v10
    s_nop 1
    v_max_f32 v9, v9, v10
    v_sub_f32 v144, v144, v9
    v_sub_f32 v145, v145, v9
    v_sub_f32 v146, v146, v9
    v_sub_f32 v147, v147, v9
    v_sub_f32 v152, v152, v9
    v_sub_f32 v153, v153, v9
    v_sub_f32 v154, v154, v9
    v_sub_f32 v155, v155, v9
    v_mul_f32 v144, s59, v144
    v_mul_f32 v145, s59, v145
    v_mul_f32 v146, s59, v146
    v_mul_f32 v147, s59, v147
    v_mul_f32 v152, s59, v152
    v_mul_f32 v153, s59, v153
    v_mul_f32 v154, s59, v154
    v_mul_f32 v155, s59, v155
    v_exp_f32 v144, v144
    v_exp_f32 v145, v145
    v_exp_f32 v146, v146
    v_exp_f32 v147, v147
    v_exp_f32 v152, v152
    v_exp_f32 v153, v153
    v_exp_f32 v154, v154
    v_exp_f32 v155, v155
    v_add_f32 v9, v152, v153
    v_add_f32 v9, v9, v154
    v_add_f32 v9, v9, v155
    v_mul_f32 v9, 0.5, v9
    v_add_f32 v9, v9, v144
    v_add_f32 v9, v9, v145
    v_add_f32 v9, v9, v146
    v_add_f32 v9, v9, v147
    v_mov_b32 v10, v9
    s_nop 1
    v_permlane16_swap_b32 v9, v10
    s_nop 1
    v_add_f32 v9, v9, v10
    v_mov_b32 v10, v9
    s_nop 1
    v_permlane32_swap_b32 v9, v10
    s_nop 1
    v_add_f32 v9, v9, v10
    v_rcp_f32 v9, v9
    s_nop 0
    v_mul_f32 v144, v144, v9
    v_mul_f32 v145, v145, v9
    v_mul_f32 v146, v146, v9
    v_mul_f32 v147, v147, v9
    v_mul_f32 v152, v152, v9
    v_mul_f32 v153, v153, v9
    v_mul_f32 v154, v154, v9
    v_mul_f32 v155, v155, v9
    v_cvt_pk_bf16_f32 v168, v144, v145
    v_cvt_pk_bf16_f32 v169, v146, v147
    v_mov_b32 v170, 0
    v_mov_b32 v171, 0
    v_cvt_pk_bf16_f32 v172, v152, v153
    v_cvt_pk_bf16_f32 v173, v154, v155
    v_cvt_pk_bf16_f32 v157, v156, v157
    v_lshlrev_b32 v156, 16, v157
    v_and_b32 v157, s62, v157
    v_cvt_pk_bf16_f32 v159, v158, v159
    v_lshlrev_b32 v158, 16, v159
    v_and_b32 v159, s62, v159
    v_cvt_pk_bf16_f32 v161, v160, v161
    v_lshlrev_b32 v160, 16, v161
    v_and_b32 v161, s62, v161
    v_cvt_pk_bf16_f32 v163, v162, v163
    v_lshlrev_b32 v162, 16, v163
    v_and_b32 v163, s62, v163
    v_cvt_pk_bf16_f32 v165, v164, v165
    v_lshlrev_b32 v164, 16, v165
    v_and_b32 v165, s62, v165
    v_cvt_pk_bf16_f32 v167, v166, v167
    v_lshlrev_b32 v166, 16, v167
    v_and_b32 v167, s62, v167
    v_mul_f32 v156, s58, v156
    v_mul_f32 v157, s58, v157
    v_mul_f32 v158, s58, v158
    v_mul_f32 v159, s58, v159
    v_mul_f32 v160, s58, v160
    v_mul_f32 v161, s58, v161
    v_mul_f32 v162, s58, v162
    v_mul_f32 v163, s58, v163
    v_mul_f32 v164, s58, v164
    v_mul_f32 v165, s58, v165
    v_mul_f32 v166, s58, v166
    v_mul_f32 v167, s58, v167
    v_cvt_pk_bf16_f32 v157, v156, v157
    v_lshlrev_b32 v156, 16, v157
    v_and_b32 v157, s62, v157
    v_cvt_pk_bf16_f32 v159, v158, v159
    v_lshlrev_b32 v158, 16, v159
    v_and_b32 v159, s62, v159
    v_cvt_pk_bf16_f32 v161, v160, v161
    v_lshlrev_b32 v160, 16, v161
    v_and_b32 v161, s62, v161
    v_cvt_pk_bf16_f32 v163, v162, v163
    v_lshlrev_b32 v162, 16, v163
    v_and_b32 v163, s62, v163
    v_cvt_pk_bf16_f32 v165, v164, v165
    v_lshlrev_b32 v164, 16, v165
    v_and_b32 v165, s62, v165
    v_cvt_pk_bf16_f32 v167, v166, v167
    v_lshlrev_b32 v166, 16, v167
    v_and_b32 v167, s62, v167
    v_cndmask_b32 v160, v7, v160, s[64:65]
    v_cndmask_b32 v161, v7, v161, s[66:67]
    v_cndmask_b32 v162, v7, v162, s[68:69]
    v_cndmask_b32 v163, v7, v163, s[70:71]
    v_max_f32 v9, v156, v157
    v_max3_f32 v9, v9, v158, v159
    v_max3_f32 v9, v9, v160, v161
    v_max3_f32 v9, v9, v162, v163
    v_max3_f32 v9, v9, v164, v165
    v_max3_f32 v9, v9, v166, v167
    v_mov_b32 v10, v9
    s_nop 1
    v_permlane16_swap_b32 v9, v10
    s_nop 1
    v_max_f32 v9, v9, v10
    v_mov_b32 v10, v9
    s_nop 1
    v_permlane32_swap_b32 v9, v10
    s_nop 1
    v_max_f32 v9, v9, v10
    v_sub_f32 v156, v156, v9
    v_sub_f32 v157, v157, v9
    v_sub_f32 v158, v158, v9
    v_sub_f32 v159, v159, v9
    v_sub_f32 v160, v160, v9
    v_sub_f32 v161, v161, v9
    v_sub_f32 v162, v162, v9
    v_sub_f32 v163, v163, v9
    v_sub_f32 v164, v164, v9
    v_sub_f32 v165, v165, v9
    v_sub_f32 v166, v166, v9
    v_sub_f32 v167, v167, v9
    v_mul_f32 v156, s59, v156
    v_mul_f32 v157, s59, v157
    v_mul_f32 v158, s59, v158
    v_mul_f32 v159, s59, v159
    v_mul_f32 v160, s59, v160
    v_mul_f32 v161, s59, v161
    v_mul_f32 v162, s59, v162
    v_mul_f32 v163, s59, v163
    v_mul_f32 v164, s59, v164
    v_mul_f32 v165, s59, v165
    v_mul_f32 v166, s59, v166
    v_mul_f32 v167, s59, v167
    v_exp_f32 v156, v156
    v_exp_f32 v157, v157
    v_exp_f32 v158, v158
    v_exp_f32 v159, v159
    v_exp_f32 v160, v160
    v_exp_f32 v161, v161
    v_exp_f32 v162, v162
    v_exp_f32 v163, v163
    v_exp_f32 v164, v164
    v_exp_f32 v165, v165
    v_exp_f32 v166, v166
    v_exp_f32 v167, v167
    v_add_f32 v9, v164, v165
    v_add_f32 v9, v9, v166
    v_add_f32 v9, v9, v167
    v_mul_f32 v9, 0.5, v9
    v_add_f32 v9, v9, v156
    v_add_f32 v9, v9, v157
    v_add_f32 v9, v9, v158
    v_add_f32 v9, v9, v159
    v_add_f32 v9, v9, v160
    v_add_f32 v9, v9, v161
    v_add_f32 v9, v9, v162
    v_add_f32 v9, v9, v163
    v_mov_b32 v10, v9
    s_nop 1
    v_permlane16_swap_b32 v9, v10
    s_nop 1
    v_add_f32 v9, v9, v10
    v_mov_b32 v10, v9
    s_nop 1
    v_permlane32_swap_b32 v9, v10
    s_nop 1
    v_add_f32 v9, v9, v10
    v_rcp_f32 v9, v9
    s_nop 0
    v_mul_f32 v156, v156, v9
    v_mul_f32 v157, v157, v9
    v_mul_f32 v158, v158, v9
    v_mul_f32 v159, v159, v9
    v_mul_f32 v160, v160, v9
    v_mul_f32 v161, v161, v9
    v_mul_f32 v162, v162, v9
    v_mul_f32 v163, v163, v9
    v_mul_f32 v164, v164, v9
    v_mul_f32 v165, v165, v9
    v_mul_f32 v166, v166, v9
    v_mul_f32 v167, v167, v9
    v_cvt_pk_bf16_f32 v176, v156, v157
    v_cvt_pk_bf16_f32 v177, v158, v159
    v_cvt_pk_bf16_f32 v178, v160, v161
    v_cvt_pk_bf16_f32 v179, v162, v163
    v_cvt_pk_bf16_f32 v180, v164, v165
    v_cvt_pk_bf16_f32 v181, v166, v167
    s_lshl_b32 s48, s44, 18
    s_lshl_b32 s49, s43, 12
    s_add_u32 s48, s48, s49
    s_add_u32 s48, s48, 0x5000000
    s_add_u32 s49, s48, 0x20000
    s_waitcnt vmcnt(0)
    v_mfma_f32_16x16x32_bf16 v[184:187], v[96:99], v[168:171], 0
    v_mfma_f32_16x16x32_bf16 v[188:191], v[100:103], v[168:171], 0
    v_mfma_f32_16x16x32_bf16 v[192:195], v[104:107], v[168:171], 0
    v_mfma_f32_16x16x32_bf16 v[196:199], v[108:111], v[168:171], 0
    v_mfma_f32_16x16x32_bf16 v[200:203], v[112:115], v[168:171], 0
    v_mfma_f32_16x16x32_bf16 v[204:207], v[116:119], v[168:171], 0
    v_mfma_f32_16x16x32_bf16 v[208:211], v[120:123], v[168:171], 0
    v_mfma_f32_16x16x32_bf16 v[212:215], v[124:127], v[168:171], 0
    v_mfma_f32_16x16x16_bf16 v[184:187], v[128:129], v[172:173], v[184:187]
    v_mfma_f32_16x16x16_bf16 v[188:191], v[130:131], v[172:173], v[188:191]
    v_mfma_f32_16x16x16_bf16 v[192:195], v[132:133], v[172:173], v[192:195]
    v_mfma_f32_16x16x16_bf16 v[196:199], v[134:135], v[172:173], v[196:199]
    v_mfma_f32_16x16x16_bf16 v[200:203], v[136:137], v[172:173], v[200:203]
    v_mfma_f32_16x16x16_bf16 v[204:207], v[138:139], v[172:173], v[204:207]
    v_mfma_f32_16x16x16_bf16 v[208:211], v[140:141], v[172:173], v[208:211]
    v_mfma_f32_16x16x16_bf16 v[212:215], v[142:143], v[172:173], v[212:215]
    v_mfma_f32_16x16x32_bf16 v[216:219], v[96:99], v[176:179], 0
    v_mfma_f32_16x16x32_bf16 v[220:223], v[100:103], v[176:179], 0
    v_mfma_f32_16x16x32_bf16 v[224:227], v[104:107], v[176:179], 0
    v_mfma_f32_16x16x32_bf16 v[228:231], v[108:111], v[176:179], 0
    v_mfma_f32_16x16x32_bf16 v[232:235], v[112:115], v[176:179], 0
    v_mfma_f32_16x16x32_bf16 v[236:239], v[116:119], v[176:179], 0
    v_mfma_f32_16x16x32_bf16 v[240:243], v[120:123], v[176:179], 0
    v_mfma_f32_16x16x32_bf16 v[244:247], v[124:127], v[176:179], 0
    v_mfma_f32_16x16x16_bf16 v[216:219], v[128:129], v[180:181], v[216:219]
    v_mfma_f32_16x16x16_bf16 v[220:223], v[130:131], v[180:181], v[220:223]
    v_mfma_f32_16x16x16_bf16 v[224:227], v[132:133], v[180:181], v[224:227]
    v_mfma_f32_16x16x16_bf16 v[228:231], v[134:135], v[180:181], v[228:231]
    v_mfma_f32_16x16x16_bf16 v[232:235], v[136:137], v[180:181], v[232:235]
    v_mfma_f32_16x16x16_bf16 v[236:239], v[138:139], v[180:181], v[236:239]
    v_mfma_f32_16x16x16_bf16 v[240:243], v[140:141], v[180:181], v[240:243]
    v_mfma_f32_16x16x16_bf16 v[244:247], v[142:143], v[180:181], v[244:247]
    s_nop 7
    v_cvt_pk_bf16_f32 v184, v184, v188
    v_cvt_pk_bf16_f32 v185, v185, v189
    v_cvt_pk_bf16_f32 v186, v186, v190
    v_cvt_pk_bf16_f32 v187, v187, v191
    buffer_store_dwordx4 v[184:187], v4, s[4:7], s48 offen offset:0 sc1
    v_cvt_pk_bf16_f32 v192, v192, v196
    v_cvt_pk_bf16_f32 v193, v193, v197
    v_cvt_pk_bf16_f32 v194, v194, v198
    v_cvt_pk_bf16_f32 v195, v195, v199
    buffer_store_dwordx4 v[192:195], v4, s[4:7], s48 offen offset:1024 sc1
    v_cvt_pk_bf16_f32 v200, v200, v204
    v_cvt_pk_bf16_f32 v201, v201, v205
    v_cvt_pk_bf16_f32 v202, v202, v206
    v_cvt_pk_bf16_f32 v203, v203, v207
    buffer_store_dwordx4 v[200:203], v4, s[4:7], s48 offen offset:2048 sc1
    v_cvt_pk_bf16_f32 v208, v208, v212
    v_cvt_pk_bf16_f32 v209, v209, v213
    v_cvt_pk_bf16_f32 v210, v210, v214
    v_cvt_pk_bf16_f32 v211, v211, v215
    buffer_store_dwordx4 v[208:211], v4, s[4:7], s48 offen offset:3072 sc1
    v_cvt_pk_bf16_f32 v216, v216, v220
    v_cvt_pk_bf16_f32 v217, v217, v221
    v_cvt_pk_bf16_f32 v218, v218, v222
    v_cvt_pk_bf16_f32 v219, v219, v223
    buffer_store_dwordx4 v[216:219], v4, s[4:7], s49 offen offset:0 sc1
    v_cvt_pk_bf16_f32 v224, v224, v228
    v_cvt_pk_bf16_f32 v225, v225, v229
    v_cvt_pk_bf16_f32 v226, v226, v230
    v_cvt_pk_bf16_f32 v227, v227, v231
    buffer_store_dwordx4 v[224:227], v4, s[4:7], s49 offen offset:1024 sc1
    v_cvt_pk_bf16_f32 v232, v232, v236
    v_cvt_pk_bf16_f32 v233, v233, v237
    v_cvt_pk_bf16_f32 v234, v234, v238
    v_cvt_pk_bf16_f32 v235, v235, v239
    buffer_store_dwordx4 v[232:235], v4, s[4:7], s49 offen offset:2048 sc1
    v_cvt_pk_bf16_f32 v240, v240, v244
    v_cvt_pk_bf16_f32 v241, v241, v245
    v_cvt_pk_bf16_f32 v242, v242, v246
    v_cvt_pk_bf16_f32 v243, v243, v247
    buffer_store_dwordx4 v[240:243], v4, s[4:7], s49 offen offset:3072 sc1
    s_add_u32 s44, s44, 8
    s_cmp_lt_u32 s44, 64
    s_cbranch_scc1 L_at_nx
    s_waitcnt vmcnt(0)
    s_branch L_at_fl
L_at_nx:
    s_lshl_b32 s45, s44, 5
    s_add_u32 s45, s45, s43
    s_lshl_b32 s46, s45, 13
    s_lshl_b32 s47, s45, 12
    s_add_u32 s48, s46, 0x0
    buffer_load_dwordx4 v[16:19], v4, s[4:7], s48 offen offset:0 sc1
    buffer_load_dwordx4 v[20:23], v4, s[4:7], s48 offen offset:1024 sc1
    buffer_load_dwordx4 v[24:27], v4, s[4:7], s48 offen offset:2048 sc1
    buffer_load_dwordx4 v[28:31], v4, s[4:7], s48 offen offset:3072 sc1
    s_add_u32 s48, s46, 0x1000
    buffer_load_dwordx4 v[32:35], v4, s[4:7], s48 offen offset:0 sc1
    buffer_load_dwordx4 v[36:39], v4, s[4:7], s48 offen offset:1024 sc1
    buffer_load_dwordx4 v[40:43], v4, s[4:7], s48 offen offset:2048 sc1
    buffer_load_dwordx4 v[44:47], v4, s[4:7], s48 offen offset:3072 sc1
    s_add_u32 s48, s46, 0x1000000
    buffer_load_dwordx4 v[48:51], v4, s[4:7], s48 offen offset:0 sc1
    buffer_load_dwordx4 v[52:55], v4, s[4:7], s48 offen offset:1024 sc1
    buffer_load_dwordx4 v[56:59], v4, s[4:7], s48 offen offset:2048 sc1
    buffer_load_dwordx4 v[60:63], v4, s[4:7], s48 offen offset:3072 sc1
    s_add_u32 s48, s46, 0x1001000
    buffer_load_dwordx4 v[64:67], v4, s[4:7], s48 offen offset:0 sc1
    buffer_load_dwordx4 v[68:71], v4, s[4:7], s48 offen offset:1024 sc1
    buffer_load_dwordx4 v[72:75], v4, s[4:7], s48 offen offset:2048 sc1
    buffer_load_dwordx4 v[76:79], v4, s[4:7], s48 offen offset:3072 sc1
    s_add_u32 s48, s46, 0x2000000
    buffer_load_dwordx4 v[96:99], v4, s[4:7], s48 offen offset:0 sc1
    buffer_load_dwordx4 v[100:103], v4, s[4:7], s48 offen offset:1024 sc1
    buffer_load_dwordx4 v[104:107], v4, s[4:7], s48 offen offset:2048 sc1
    buffer_load_dwordx4 v[108:111], v4, s[4:7], s48 offen offset:3072 sc1
    s_add_u32 s48, s46, 0x2001000
    buffer_load_dwordx4 v[112:115], v4, s[4:7], s48 offen offset:0 sc1
    buffer_load_dwordx4 v[116:119], v4, s[4:7], s48 offen offset:1024 sc1
    buffer_load_dwordx4 v[120:123], v4, s[4:7], s48 offen offset:2048 sc1
    buffer_load_dwordx4 v[124:127], v4, s[4:7], s48 offen offset:3072 sc1
    s_waitcnt vmcnt(24)
L_at_fl:
    s_barrier
    s_cmp_lg_u32 s29, 0
    s_cbranch_scc1 L_at_nf
    s_lshr_b32 s48, s44, 3
    s_mov_b64 exec, 1
    v_mov_b32 v8, s48
    buffer_store_byte v8, off, s[4:7], s51 sc1
    s_mov_b64 exec, -1
L_at_nf:
    s_cmp_lt_u32 s44, 64
    s_cbranch_scc1 L_at_loop
    s_waitcnt vmcnt(0)
    s_endpgm
L_exit:
    s_endpgm
.section .rodata,"a"
.p2align 6
.amdhsa_kernel concat_heads__memory_aug_recurrent_mem_tr__ssm_conv_h3__prompt_kernel
  .amdhsa_next_free_vgpr 512
  .amdhsa_next_free_sgpr 102
  .amdhsa_accum_offset 256
  .amdhsa_group_segment_fixed_size 0
  .amdhsa_kernarg_size 128
  .amdhsa_user_sgpr_count 2
  .amdhsa_user_sgpr_kernarg_segment_ptr 1
  .amdhsa_system_sgpr_workgroup_id_x 1
.end_amdhsa_kernel
```
